```python
import torch

def _softmax(x, axis=-1):
    return torch.softmax(x, dim=axis)

def _gelu(x):
    return torch.nn.functional.gelu(x, approximate='tanh')

def _silu(x):
    return torch.nn.functional.silu(x)

def _sigmoid(x):
    return torch.sigmoid(x)

def _layernorm(x, axis=-1, eps=1e-05):
    m = x.mean(dim=axis, keepdim=True)
    v = x.var(dim=axis, keepdim=True, unbiased=False)
    return (x - m) / torch.sqrt(v + eps)

def _scatter_add(tgt, idx, src, axis=0):
    return tgt.clone().index_add_(axis, idx, src)

def _segment_sum(src, seg, n):
    out = torch.zeros((n,) + src.shape[1:], dtype=src.dtype)
    return out.index_add_(0, seg, src)

def _pad(x, pw):
    flat = tuple((v for pair in reversed(pw) for v in pair))
    return torch.nn.functional.pad(x, flat)
kernel_name = 'adaLN_cond__grouped_kv_mqa__mixer_channel_mlp__prompt'

def setup_inputs():

    _w = lambda a: (lambda t: t.to(torch.bfloat16) if t.is_floating_point() else t)(torch.as_tensor(a))

    def _A_setup():
        B, S, D, H = (1, 2048, 1024, 32)
        Dh = D // H
        return {'x': _w((lambda *s: torch.randn(*s, dtype=torch.bfloat16) * 0.05)(B, S, D)), 'wq': _w((lambda *s: torch.randn(*s, dtype=torch.bfloat16) * 0.05)(D, H * Dh)), 'wk': _w((lambda *s: torch.randn(*s, dtype=torch.bfloat16) * 0.05)(D, Dh)), 'wv': _w((lambda *s: torch.randn(*s, dtype=torch.bfloat16) * 0.05)(D, Dh)), 'wo': _w((lambda *s: torch.randn(*s, dtype=torch.bfloat16) * 0.05)(H * Dh, D))}
    _A_in = _A_setup()

    def _B_setup():
        B, S, D, F = (1, 2048, 1024, 3584)
        return {'x': _w((lambda *s: torch.randn(*s, dtype=torch.bfloat16) * 0.05)(B, S, D)), 'w1': _w((lambda *s: torch.randn(*s, dtype=torch.bfloat16) * 12.8)(D, F) * D ** (-0.5)), 'b1': _w((lambda *s: torch.randn(*s, dtype=torch.bfloat16) * 6.4)(F)), 'w2': _w((lambda *s: torch.randn(*s, dtype=torch.bfloat16) * 0.2)(F, D) * F ** (-0.5)), 'b2': _w((lambda *s: torch.randn(*s, dtype=torch.bfloat16) * 1.6)(D))}
    _B_in = _B_setup()
    return {'A_x': _A_in['x'], 'A_wq': _A_in['wq'], 'A_wk': _A_in['wk'], 'A_wv': _A_in['wv'], 'A_wo': _A_in['wo'], 'B_x': _B_in['x'], 'B_w1': _B_in['w1'], 'B_b1': _B_in['b1'], 'B_w2': _B_in['w2'], 'B_b2': _B_in['b2'], 'c': _w((lambda *s: torch.randn(*s, dtype=torch.bfloat16) * 0.1)(1, 1024) * 8.0), 'w_mod': _w((lambda *s: torch.randn(*s, dtype=torch.bfloat16) * 0.1)(1024, 6 * 1024) * 1024 ** (-0.5) * 8.0)}

def reference(A_x, A_wq, A_wk, A_wv, A_wo, B_x, B_w1, B_b1, B_w2, B_b2, c, w_mod):

    def _A_ref(x, wq, wk, wv, wo):
        B, S, D = x.shape
        H = 32
        Dh = D // H
        q = (lambda x, *d: x.permute(*d))((x @ wq).reshape(B, S, H, Dh), 0, 2, 1, 3)
        k = x @ wk
        v = x @ wv
        scores = torch.einsum('bhqd,bkd->bhqk', q, k) * Dh ** (-0.5)
        p = _softmax(scores, axis=-1)
        o = torch.einsum('bhqk,bkd->bhqd', p, v)
        return (lambda x, *d: x.permute(*d))(o, 0, 2, 1, 3).reshape(B, S, H * Dh) @ wo

    def _B_ref(x, w1, b1, w2, b2):
        y = _layernorm(x, axis=-1)
        h = _gelu(torch.einsum('bsd,df->bsf', y, w1) + b1)
        return torch.einsum('bsf,fd->bsd', h, w2) + b2
    x = A_x
    mod = (_silu(c) @ w_mod).reshape(c.shape[0], 6, 1, -1)
    sa, ca, ga, sb, cb, gb = (mod[:, 0].clone(), mod[:, 1].clone(), mod[:, 2].clone(), mod[:, 3].clone(), mod[:, 4].clone(), mod[:, 5].clone())
    h = _layernorm(x, axis=-1) * (1 + ca) + sa
    x = x + ga * _A_ref(h, A_wq, A_wk, A_wv, A_wo)
    h = _layernorm(x, axis=-1) * (1 + cb) + sb
    x = x + gb * _B_ref(h, B_w1, B_b1, B_w2, B_b2)
    return x
```

```asm
; @launch kernel=k1_mod_kernel grid=(256,1,1) block=(1024,1,1) lds=8192
; @launch kernel=k2_ln_kv_kernel grid=(256,1,1) block=(512,1,1) lds=118784
; @launch kernel=k3_attn_kernel grid=(256,1,1) block=(512,1,1) lds=163840
; @launch kernel=k4_wo_kernel grid=(256,1,1) block=(512,1,1) lds=149504
; @launch kernel=k5_g1_kernel grid=(256,1,1) block=(512,1,1) lds=149120
; @launch kernel=k6_g2_kernel grid=(256,1,1) block=(512,1,1) lds=131072
.amdgcn_target "amdgcn-amd-amdhsa--gfx950"
.text
.globl k1_mod_kernel
.p2align 8
.type k1_mod_kernel,@function
k1_mod_kernel:
  s_cmp_ge_u32 s2, 256
  s_cbranch_scc1 L_k1_mod_kernel_exit
  s_load_dwordx2 s[4:5], s[0:1], 80
  s_load_dwordx2 s[6:7], s[0:1], 88
  s_load_dwordx2 s[8:9], s[0:1], 112
  s_load_dwordx2 s[10:11], s[0:1], 0
  s_load_dwordx2 s[12:13], s[0:1], 8
  s_load_dwordx2 s[14:15], s[0:1], 16
  s_load_dwordx2 s[16:17], s[0:1], 24
  s_lshr_b32 s21, s2, 6
  s_and_b32 s18, s2, 7
  s_lshr_b32 s19, s2, 3
  s_and_b32 s19, s19, 7
  s_lshr_b32 s20, s19, 1
  s_lshl_b32 s20, s20, 4
  s_lshl_b32 s18, s18, 1
  s_add_u32 s20, s20, s18
  s_and_b32 s19, s19, 1
  s_add_u32 s20, s20, s19
  v_lshrrev_b32 v3, 2, v0
  v_mul_u32_u24 v1, 0x3000, v3
  v_and_b32 v2, 3, v0
  v_lshl_add_u32 v1, v2, 4, v1
  v_lshlrev_b32 v2, 1, v3
  s_mul_i32 s22, s21, 3145728
  s_lshl_b32 s3, s20, 6
  s_add_u32 s22, s22, s3
  s_lshl_b32 s23, s21, 9
  v_readfirstlane_b32 s24, v0
  s_nop 0
  s_lshr_b32 s25, s24, 6
  s_waitcnt lgkmcnt(0)
  s_mov_b32 s28, s6
  s_mov_b32 s29, s7
  s_mov_b32 s30, 0xc00000
  s_mov_b32 s31, 0x20000
  s_mov_b32 s32, s4
  s_mov_b32 s33, s5
  s_mov_b32 s34, 0x800
  s_mov_b32 s35, 0x20000
  s_add_u32 s36, s8, 0x130000
  s_addc_u32 s37, s9, 0
  s_mov_b32 s38, 0x8000
  s_mov_b32 s39, 0x20000
  v_mov_b32 v4, 0
  s_lshl_b32 s40, s2, 7
  s_cmp_eq_u32 s25, 15
  s_cbranch_scc0 L_k1_mod_kernel_noz_1
  s_mov_b64 exec, 1
  buffer_store_dword v4, v4, s[36:39], s40 offen
  buffer_store_dword v4, v4, s[36:39], s40 offen offset:64
  s_mov_b64 exec, -1
L_k1_mod_kernel_noz_1:
  buffer_load_dwordx4 v[8:11], v1, s[28:31], s22 offen
  buffer_load_ushort v12, v2, s[32:35], s23 offen
  s_lshl_b32 s44, s2, 3
  s_add_u32 s44, s44, s25
  s_lshl_b32 s44, s44, 11
  s_cmp_lt_u32 s25, 8
  s_cbranch_scc0 L_k1_mod_kernel_nox_2
  s_mov_b32 s48, s10
  s_mov_b32 s49, s11
  s_mov_b32 s50, 0x400000
  s_mov_b32 s51, 0x20000
  v_and_b32 v24, 63, v0
  v_lshlrev_b32 v24, 4, v24
  buffer_load_dwordx4 v[16:19], v24, s[48:51], s44 offen
  buffer_load_dwordx4 v[20:23], v24, s[48:51], s44 offen offset:1024
  s_waitcnt vmcnt(2)
  s_branch L_k1_mod_kernel_nopf_3
L_k1_mod_kernel_nox_2:
  s_mul_i32 s3, s2, 68
  v_subrev_u32 v26, 512, v0
  v_cmp_gt_u32 vcc, 68, v26
  v_add_u32 v26, s3, v26
  s_and_saveexec_b64 s[42:43], vcc
  s_cbranch_execz L_k1_mod_kernel_pfr_4
  v_mov_b32 v28, s12
  v_mov_b32 v29, s13
  v_mov_b32 v25, 0
  v_cmp_le_u32 vcc, 16384, v26
  v_mov_b32 v30, s14
  v_mov_b32 v31, s15
  v_cndmask_b32 v28, v28, v30, vcc
  v_cndmask_b32 v29, v29, v31, vcc
  v_mov_b32 v30, 16384
  v_cndmask_b32 v25, v25, v30, vcc
  v_cmp_le_u32 vcc, 16896, v26
  v_mov_b32 v30, s16
  v_mov_b32 v31, s17
  v_cndmask_b32 v28, v28, v30, vcc
  v_cndmask_b32 v29, v29, v31, vcc
  v_mov_b32 v30, 16896
  v_cndmask_b32 v25, v25, v30, vcc
  v_sub_u32 v26, v26, v25
  v_lshlrev_b32 v26, 7, v26
  v_add_co_u32 v28, vcc, v28, v26
  s_nop 1
  v_addc_co_u32 v29, vcc, 0, v29, vcc
  global_load_dword v25, v[28:29], off
L_k1_mod_kernel_pfr_4:
  s_mov_b64 exec, s[42:43]
  s_cmp_lt_u32 s2, 8
  s_cbranch_scc0 L_k1_mod_kernel_nocode_5
  s_getpc_b64 s[52:53]
L_k1_pc:
  s_add_u32 s52, s52, (CODE_BEGIN-L_k1_pc)
  s_addc_u32 s53, s53, 0
  v_subrev_u32 v33, 640, v0
  v_lshlrev_b32 v33, 7, v33
  v_cmp_gt_u32 vcc, (CODE_END-CODE_BEGIN), v33
  s_nop 0
  s_and_saveexec_b64 s[42:43], vcc
  s_cbranch_execz L_k1_mod_kernel_nocode_5_r
  v_mov_b32 v35, s53
  v_add_co_u32 v34, vcc, s52, v33
  s_nop 1
  v_addc_co_u32 v35, vcc, 0, v35, vcc
  global_load_dword v32, v[34:35], off
L_k1_mod_kernel_nocode_5_r:
  s_mov_b64 exec, s[42:43]
L_k1_mod_kernel_nocode_5:
  s_waitcnt vmcnt(0)
L_k1_mod_kernel_nopf_3:
  v_lshlrev_b32 v12, 16, v12
  v_mul_f32 v44, 0xbfb8aa3b, v12
  v_exp_f32 v44, v44
  s_nop 0
  v_add_f32 v44, 1.0, v44
  v_rcp_f32 v44, v44
  s_nop 0
  v_mul_f32 v12, v12, v44
  v_cvt_pk_bf16_f32 v12, v12, v12
  v_and_b32 v12, 0xffff0000, v12
  v_lshlrev_b32 v45, 16, v8
  v_and_b32 v46, 0xffff0000, v8
  v_mul_f32 v36, v12, v45
  v_mul_f32 v37, v12, v46
  v_lshlrev_b32 v45, 16, v9
  v_and_b32 v46, 0xffff0000, v9
  v_mul_f32 v38, v12, v45
  v_mul_f32 v39, v12, v46
  v_lshlrev_b32 v45, 16, v10
  v_and_b32 v46, 0xffff0000, v10
  v_mul_f32 v40, v12, v45
  v_mul_f32 v41, v12, v46
  v_lshlrev_b32 v45, 16, v11
  v_and_b32 v46, 0xffff0000, v11
  v_mul_f32 v42, v12, v45
  v_mul_f32 v43, v12, v46
  v_add_f32_dpp v36, v36, v36 row_ror:4 row_mask:0xf bank_mask:0xf
  v_add_f32_dpp v37, v37, v37 row_ror:4 row_mask:0xf bank_mask:0xf
  v_add_f32_dpp v38, v38, v38 row_ror:4 row_mask:0xf bank_mask:0xf
  v_add_f32_dpp v39, v39, v39 row_ror:4 row_mask:0xf bank_mask:0xf
  v_add_f32_dpp v40, v40, v40 row_ror:4 row_mask:0xf bank_mask:0xf
  v_add_f32_dpp v41, v41, v41 row_ror:4 row_mask:0xf bank_mask:0xf
  v_add_f32_dpp v42, v42, v42 row_ror:4 row_mask:0xf bank_mask:0xf
  v_add_f32_dpp v43, v43, v43 row_ror:4 row_mask:0xf bank_mask:0xf
  v_add_f32_dpp v36, v36, v36 row_ror:8 row_mask:0xf bank_mask:0xf
  v_add_f32_dpp v37, v37, v37 row_ror:8 row_mask:0xf bank_mask:0xf
  v_add_f32_dpp v38, v38, v38 row_ror:8 row_mask:0xf bank_mask:0xf
  v_add_f32_dpp v39, v39, v39 row_ror:8 row_mask:0xf bank_mask:0xf
  v_add_f32_dpp v40, v40, v40 row_ror:8 row_mask:0xf bank_mask:0xf
  v_add_f32_dpp v41, v41, v41 row_ror:8 row_mask:0xf bank_mask:0xf
  v_add_f32_dpp v42, v42, v42 row_ror:8 row_mask:0xf bank_mask:0xf
  v_add_f32_dpp v43, v43, v43 row_ror:8 row_mask:0xf bank_mask:0xf
  v_lshrrev_b32 v47, 4, v0
  v_lshlrev_b32 v47, 7, v47
  v_and_b32 v3, 3, v0
  v_lshl_add_u32 v47, v3, 5, v47
  v_and_b32 v3, 15, v0
  v_cmp_gt_u32 vcc, 4, v3
  s_nop 0
  s_and_saveexec_b64 s[42:43], vcc
  ds_write_b128 v47, v[36:39]
  ds_write_b128 v47, v[40:43] offset:16
  s_mov_b64 exec, s[42:43]
  s_waitcnt lgkmcnt(0)
  s_barrier
  s_cmp_ge_u32 s25, 8
  s_cbranch_scc1 L_k1_mod_kernel_end
  s_cmp_eq_u32 s25, 0
  s_cbranch_scc0 L_k1_mod_kernel_stat_7
  v_and_b32 v47, 31, v0
  v_lshlrev_b32 v47, 2, v47
  v_bfe_u32 v3, v0, 5, 1
  v_lshl_add_u32 v47, v3, 12, v47
  ds_read_b32 v48, v47 offset:0
  ds_read_b32 v49, v47 offset:128
  ds_read_b32 v50, v47 offset:256
  ds_read_b32 v51, v47 offset:384
  ds_read_b32 v52, v47 offset:512
  ds_read_b32 v53, v47 offset:640
  ds_read_b32 v54, v47 offset:768
  ds_read_b32 v55, v47 offset:896
  ds_read_b32 v56, v47 offset:1024
  ds_read_b32 v57, v47 offset:1152
  ds_read_b32 v58, v47 offset:1280
  ds_read_b32 v59, v47 offset:1408
  ds_read_b32 v60, v47 offset:1536
  ds_read_b32 v61, v47 offset:1664
  ds_read_b32 v62, v47 offset:1792
  ds_read_b32 v63, v47 offset:1920
  ds_read_b32 v64, v47 offset:2048
  ds_read_b32 v65, v47 offset:2176
  ds_read_b32 v66, v47 offset:2304
  ds_read_b32 v67, v47 offset:2432
  ds_read_b32 v68, v47 offset:2560
  ds_read_b32 v69, v47 offset:2688
  ds_read_b32 v70, v47 offset:2816
  ds_read_b32 v71, v47 offset:2944
  ds_read_b32 v72, v47 offset:3072
  ds_read_b32 v73, v47 offset:3200
  ds_read_b32 v74, v47 offset:3328
  ds_read_b32 v75, v47 offset:3456
  ds_read_b32 v76, v47 offset:3584
  ds_read_b32 v77, v47 offset:3712
  ds_read_b32 v78, v47 offset:3840
  ds_read_b32 v79, v47 offset:3968
  s_waitcnt lgkmcnt(0)
  v_add_f32 v48, v48, v64
  v_add_f32 v49, v49, v65
  v_add_f32 v50, v50, v66
  v_add_f32 v51, v51, v67
  v_add_f32 v52, v52, v68
  v_add_f32 v53, v53, v69
  v_add_f32 v54, v54, v70
  v_add_f32 v55, v55, v71
  v_add_f32 v56, v56, v72
  v_add_f32 v57, v57, v73
  v_add_f32 v58, v58, v74
  v_add_f32 v59, v59, v75
  v_add_f32 v60, v60, v76
  v_add_f32 v61, v61, v77
  v_add_f32 v62, v62, v78
  v_add_f32 v63, v63, v79
  v_add_f32 v48, v48, v56
  v_add_f32 v49, v49, v57
  v_add_f32 v50, v50, v58
  v_add_f32 v51, v51, v59
  v_add_f32 v52, v52, v60
  v_add_f32 v53, v53, v61
  v_add_f32 v54, v54, v62
  v_add_f32 v55, v55, v63
  v_add_f32 v48, v48, v52
  v_add_f32 v49, v49, v53
  v_add_f32 v50, v50, v54
  v_add_f32 v51, v51, v55
  v_add_f32 v48, v48, v50
  v_add_f32 v49, v49, v51
  v_add_f32 v48, v48, v49
  v_mov_b32 v49, v48
  s_nop 1
  v_permlane32_swap_b32 v48, v49
  v_add_f32 v48, v48, v49
  s_add_u32 s56, s8, 0x100000
  s_addc_u32 s57, s9, 0
  s_mov_b32 s58, 0x8000
  s_mov_b32 s59, 0x20000
  s_lshl_b32 s60, s21, 13
  s_lshl_b32 s3, s20, 7
  s_add_u32 s60, s60, s3
  v_and_b32 v47, 31, v0
  v_lshlrev_b32 v47, 2, v47
  v_cmp_gt_u32 vcc, 32, v0
  s_nop 0
  s_and_saveexec_b64 s[42:43], vcc
  buffer_store_dword v48, v47, s[56:59], s60 offen
  s_mov_b64 exec, s[42:43]
L_k1_mod_kernel_stat_7:
  s_waitcnt vmcnt(1)
  s_cmp_eq_u32 s25, 0
  s_cbranch_scc1 L_k1_mod_kernel_w0_8
  s_waitcnt vmcnt(0)
L_k1_mod_kernel_w0_8:
  v_lshlrev_b32 v80, 16, v16
  v_and_b32 v81, 0xffff0000, v16
  v_lshlrev_b32 v82, 16, v17
  v_and_b32 v83, 0xffff0000, v17
  v_lshlrev_b32 v84, 16, v18
  v_and_b32 v85, 0xffff0000, v18
  v_lshlrev_b32 v86, 16, v19
  v_and_b32 v87, 0xffff0000, v19
  v_lshlrev_b32 v88, 16, v20
  v_and_b32 v89, 0xffff0000, v20
  v_lshlrev_b32 v90, 16, v21
  v_and_b32 v91, 0xffff0000, v21
  v_lshlrev_b32 v92, 16, v22
  v_and_b32 v93, 0xffff0000, v22
  v_lshlrev_b32 v94, 16, v23
  v_and_b32 v95, 0xffff0000, v23
  v_add_f32 v96, v80, v81
  v_add_f32 v96, v96, v82
  v_add_f32 v96, v96, v83
  v_add_f32 v96, v96, v84
  v_add_f32 v96, v96, v85
  v_add_f32 v96, v96, v86
  v_add_f32 v96, v96, v87
  v_add_f32 v96, v96, v88
  v_add_f32 v96, v96, v89
  v_add_f32 v96, v96, v90
  v_add_f32 v96, v96, v91
  v_add_f32 v96, v96, v92
  v_add_f32 v96, v96, v93
  v_add_f32 v96, v96, v94
  v_add_f32 v96, v96, v95
  v_mul_f32 v96, 0x3a800000, v96
  s_nop 1
  v_add_f32_dpp v96, v96, v96 row_shr:1 row_mask:0xf bank_mask:0xf bound_ctrl:0
  s_nop 1
  v_add_f32_dpp v96, v96, v96 row_shr:2 row_mask:0xf bank_mask:0xf bound_ctrl:0
  s_nop 1
  v_add_f32_dpp v96, v96, v96 row_shr:4 row_mask:0xf bank_mask:0xf bound_ctrl:0
  s_nop 1
  v_add_f32_dpp v96, v96, v96 row_shr:8 row_mask:0xf bank_mask:0xf bound_ctrl:0
  s_nop 1
  v_add_f32_dpp v96, v96, v96 row_bcast:15 row_mask:0xa bank_mask:0xf
  s_nop 1
  v_add_f32_dpp v96, v96, v96 row_bcast:31 row_mask:0xc bank_mask:0xf
  s_nop 0
  v_readlane_b32 s61, v96, 63
  s_nop 1
  v_subrev_f32 v80, s61, v80
  v_subrev_f32 v81, s61, v81
  v_subrev_f32 v82, s61, v82
  v_subrev_f32 v83, s61, v83
  v_subrev_f32 v84, s61, v84
  v_subrev_f32 v85, s61, v85
  v_subrev_f32 v86, s61, v86
  v_subrev_f32 v87, s61, v87
  v_subrev_f32 v88, s61, v88
  v_subrev_f32 v89, s61, v89
  v_subrev_f32 v90, s61, v90
  v_subrev_f32 v91, s61, v91
  v_subrev_f32 v92, s61, v92
  v_subrev_f32 v93, s61, v93
  v_subrev_f32 v94, s61, v94
  v_subrev_f32 v95, s61, v95
  v_mul_f32 v96, v80, v80
  v_fmac_f32 v96, v81, v81
  v_fmac_f32 v96, v82, v82
  v_fmac_f32 v96, v83, v83
  v_fmac_f32 v96, v84, v84
  v_fmac_f32 v96, v85, v85
  v_fmac_f32 v96, v86, v86
  v_fmac_f32 v96, v87, v87
  v_fmac_f32 v96, v88, v88
  v_fmac_f32 v96, v89, v89
  v_fmac_f32 v96, v90, v90
  v_fmac_f32 v96, v91, v91
  v_fmac_f32 v96, v92, v92
  v_fmac_f32 v96, v93, v93
  v_fmac_f32 v96, v94, v94
  v_fmac_f32 v96, v95, v95
  v_mul_f32 v96, 0x3a800000, v96
  s_nop 1
  v_add_f32_dpp v96, v96, v96 row_shr:1 row_mask:0xf bank_mask:0xf bound_ctrl:0
  s_nop 1
  v_add_f32_dpp v96, v96, v96 row_shr:2 row_mask:0xf bank_mask:0xf bound_ctrl:0
  s_nop 1
  v_add_f32_dpp v96, v96, v96 row_shr:4 row_mask:0xf bank_mask:0xf bound_ctrl:0
  s_nop 1
  v_add_f32_dpp v96, v96, v96 row_shr:8 row_mask:0xf bank_mask:0xf bound_ctrl:0
  s_nop 1
  v_add_f32_dpp v96, v96, v96 row_bcast:15 row_mask:0xa bank_mask:0xf
  s_nop 1
  v_add_f32_dpp v96, v96, v96 row_bcast:31 row_mask:0xc bank_mask:0xf
  v_add_f32 v96, 0x3727c5ac, v96
  v_rsq_f32 v96, v96
  s_nop 0
  v_mul_f32 v97, s61, v96
  v_sub_f32 v97, 0, v97
  s_add_u32 s64, s8, 0x120000
  s_addc_u32 s65, s9, 0
  s_mov_b32 s66, 0x4000
  s_mov_b32 s67, 0x20000
  s_lshr_b32 s68, s44, 8
  v_mov_b32 v98, 0
  s_mov_b32 exec_lo, 0
  s_mov_b32 exec_hi, 0x80000000
  buffer_store_dwordx2 v[96:97], v98, s[64:67], s68 offen
  s_mov_b64 exec, -1
L_k1_mod_kernel_end:
L_k1_mod_kernel_exit:
  s_endpgm
.p2align 8
CODE_BEGIN:
.globl k2_ln_kv_kernel
.p2align 8
.type k2_ln_kv_kernel,@function
k2_ln_kv_kernel:
  s_cmp_ge_u32 s2, 256
  s_cbranch_scc1 L_k2_ln_kv_kernel_exit
  s_load_dwordx2 s[4:5], s[0:1], 0
  s_load_dwordx2 s[6:7], s[0:1], 112
  s_load_dwordx2 s[8:9], s[0:1], 16
  s_load_dwordx2 s[10:11], s[0:1], 24
  s_and_b32 s12, s2, 3
  s_lshl_b32 s12, s12, 5
  s_lshr_b32 s3, s2, 3
  s_add_u32 s12, s12, s3
  s_bfe_u32 s13, s2, 65538
  v_and_b32 v1, 63, v0
  v_lshrrev_b32 v2, 6, v0
  s_nop 0
  v_readfirstlane_b32 s15, v2
  v_lshlrev_b32 v3, 12, v2
  v_lshl_add_u32 v5, v1, 4, v3
  s_lshl_b32 s14, s12, 15
  s_waitcnt lgkmcnt(0)
  s_add_u32 s16, s4, s14
  s_addc_u32 s17, s5, 0
  s_mov_b32 s18, 0x8000
  s_mov_b32 s19, 0x20000
  buffer_load_dwordx4 v[8:11], v5, s[16:19], 0 offen offset:0
  buffer_load_dwordx4 v[12:15], v5, s[16:19], 0 offen offset:1024
  buffer_load_dwordx4 v[16:19], v5, s[16:19], 0 offen offset:2048
  buffer_load_dwordx4 v[20:23], v5, s[16:19], 0 offen offset:3072
  s_add_u32 s20, s6, 0x120000
  s_addc_u32 s21, s7, 0
  s_mov_b32 s22, 0x4000
  s_mov_b32 s23, 0x20000
  v_mov_b32 v28, 0
  s_lshl_b32 s24, s12, 7
  s_lshl_b32 s3, s15, 4
  s_add_u32 s24, s24, s3
  buffer_load_dwordx4 v[24:27], v28, s[20:23], s24 offen
  s_add_u32 s28, s6, 0x100000
  s_addc_u32 s29, s7, 0
  s_mov_b32 s30, 0x8000
  s_mov_b32 s31, 0x20000
  v_lshlrev_b32 v29, 4, v0
  s_mov_b32 s32, 0
  buffer_load_dwordx4 v[32:35], v29, s[28:31], s32 offen
  s_mov_b32 s33, 8192
  buffer_load_dwordx4 v[36:39], v29, s[28:31], s33 offen
  s_mov_b32 s34, 16384
  buffer_load_dwordx4 v[40:43], v29, s[28:31], s34 offen
  s_mov_b32 s35, 24576
  buffer_load_dwordx4 v[44:47], v29, s[28:31], s35 offen
  s_add_u32 s40, s6, 0x400000
  s_addc_u32 s41, s7, 0
  s_add_u32 s40, s40, s14
  s_addc_u32 s41, s41, 0
  s_mov_b32 s42, 0x8000
  s_mov_b32 s43, 0x20000
  s_cmp_eq_u32 s13, 0
  s_cselect_b32 s44, s8, s10
  s_cselect_b32 s45, s9, s11
  s_mov_b32 s48, s44
  s_mov_b32 s49, s45
  s_mov_b32 s50, 0x10000
  s_mov_b32 s51, 0x20000
  v_lshrrev_b32 v3, 2, v1
  v_lshlrev_b32 v48, 6, v3
  v_lshrrev_b32 v3, 5, v1
  v_lshlrev_b32 v3, 1, v3
  v_and_b32 v4, 3, v1
  v_xor_b32 v3, v3, v4
  v_lshl_add_u32 v48, v3, 4, v48
  v_lshlrev_b32 v49, 5, v1
  v_lshl_add_u32 v3, v2, 1, 0
  v_xor_b32 v4, v1, v3
  v_lshlrev_b32 v50, 11, v3
  v_lshl_add_u32 v50, v4, 4, v50
  v_add_u32 v50, 0x5000, v50
  v_lshl_add_u32 v3, v2, 1, 1
  v_xor_b32 v4, v1, v3
  v_lshlrev_b32 v51, 11, v3
  v_lshl_add_u32 v51, v4, 4, v51
  v_add_u32 v51, 0x5000, v51
  v_lshrrev_b32 v3, 4, v1
  v_lshlrev_b32 v52, 3, v3
  v_bfe_u32 v4, v1, 2, 2
  v_add_u32 v52, v52, v4
  v_lshl_add_u32 v52, v2, 7, v52
  v_lshlrev_b32 v52, 6, v52
  v_bfe_u32 v4, v1, 1, 1
  v_and_b32 v3, 1, v3
  v_lshlrev_b32 v3, 1, v3
  v_xor_b32 v3, v3, v4
  v_and_b32 v4, 1, v1
  v_lshlrev_b32 v4, 3, v4
  v_lshl_add_u32 v52, v3, 4, v52
  v_add_u32 v52, v52, v4
  v_xor_b32 v53, 32, v52
  v_and_b32 v55, 15, v1
  v_lshrrev_b32 v4, 4, v1
  v_lshl_add_u32 v54, v2, 4, v4
  v_add_u32 v56, 0, v54
  v_xor_b32 v56, v56, v55
  v_lshlrev_b32 v56, 4, v56
  v_lshl_add_u32 v56, v55, 11, v56
  v_add_u32 v56, 0x5000, v56
  v_add_u32 v57, 4, v54
  v_xor_b32 v57, v57, v55
  v_lshlrev_b32 v57, 4, v57
  v_lshl_add_u32 v57, v55, 11, v57
  v_add_u32 v57, 0x5000, v57
  v_add_u32 v58, 8, v54
  v_xor_b32 v58, v58, v55
  v_lshlrev_b32 v58, 4, v58
  v_lshl_add_u32 v58, v55, 11, v58
  v_add_u32 v58, 0x5000, v58
  v_add_u32 v59, 12, v54
  v_xor_b32 v59, v59, v55
  v_lshlrev_b32 v59, 4, v59
  v_lshl_add_u32 v59, v55, 11, v59
  v_add_u32 v59, 0x5000, v59
  v_lshlrev_b32 v60, 11, v2
  v_lshl_add_u32 v60, v55, 7, v60
  v_lshrrev_b32 v4, 4, v1
  v_lshl_add_u32 v60, v4, 4, v60
  v_add_u32 v60, 0, v60
  s_waitcnt vmcnt(4)
  v_lshlrev_b32 v64, 16, v8
  v_and_b32 v65, 0xffff0000, v8
  v_lshlrev_b32 v66, 16, v9
  v_and_b32 v67, 0xffff0000, v9
  v_lshlrev_b32 v68, 16, v10
  v_and_b32 v69, 0xffff0000, v10
  v_lshlrev_b32 v70, 16, v11
  v_and_b32 v71, 0xffff0000, v11
  v_lshlrev_b32 v72, 16, v12
  v_and_b32 v73, 0xffff0000, v12
  v_lshlrev_b32 v74, 16, v13
  v_and_b32 v75, 0xffff0000, v13
  v_lshlrev_b32 v76, 16, v14
  v_and_b32 v77, 0xffff0000, v14
  v_lshlrev_b32 v78, 16, v15
  v_and_b32 v79, 0xffff0000, v15
  v_lshlrev_b32 v80, 16, v16
  v_and_b32 v81, 0xffff0000, v16
  v_lshlrev_b32 v82, 16, v17
  v_and_b32 v83, 0xffff0000, v17
  v_lshlrev_b32 v84, 16, v18
  v_and_b32 v85, 0xffff0000, v18
  v_lshlrev_b32 v86, 16, v19
  v_and_b32 v87, 0xffff0000, v19
  v_lshlrev_b32 v88, 16, v20
  v_and_b32 v89, 0xffff0000, v20
  v_lshlrev_b32 v90, 16, v21
  v_and_b32 v91, 0xffff0000, v21
  v_lshlrev_b32 v92, 16, v22
  v_and_b32 v93, 0xffff0000, v22
  v_lshlrev_b32 v94, 16, v23
  v_and_b32 v95, 0xffff0000, v23
  v_fma_f32 v64, v64, v24, v25
  v_fma_f32 v65, v65, v24, v25
  v_fma_f32 v66, v66, v24, v25
  v_fma_f32 v67, v67, v24, v25
  v_fma_f32 v68, v68, v24, v25
  v_fma_f32 v69, v69, v24, v25
  v_fma_f32 v70, v70, v24, v25
  v_fma_f32 v71, v71, v24, v25
  v_fma_f32 v72, v72, v24, v25
  v_fma_f32 v73, v73, v24, v25
  v_fma_f32 v74, v74, v24, v25
  v_fma_f32 v75, v75, v24, v25
  v_fma_f32 v76, v76, v24, v25
  v_fma_f32 v77, v77, v24, v25
  v_fma_f32 v78, v78, v24, v25
  v_fma_f32 v79, v79, v24, v25
  v_fma_f32 v80, v80, v26, v27
  v_fma_f32 v81, v81, v26, v27
  v_fma_f32 v82, v82, v26, v27
  v_fma_f32 v83, v83, v26, v27
  v_fma_f32 v84, v84, v26, v27
  v_fma_f32 v85, v85, v26, v27
  v_fma_f32 v86, v86, v26, v27
  v_fma_f32 v87, v87, v26, v27
  v_fma_f32 v88, v88, v26, v27
  v_fma_f32 v89, v89, v26, v27
  v_fma_f32 v90, v90, v26, v27
  v_fma_f32 v91, v91, v26, v27
  v_fma_f32 v92, v92, v26, v27
  v_fma_f32 v93, v93, v26, v27
  v_fma_f32 v94, v94, v26, v27
  v_fma_f32 v95, v95, v26, v27
  s_lshl_b32 s53, s15, 13
  s_add_u32 m0, s53, 53248
  s_nop 0
  buffer_load_dwordx4 v48, s[48:51], s53 offen lds
  s_add_u32 m0, s53, 54272
  s_add_u32 s52, s53, 1024
  buffer_load_dwordx4 v48, s[48:51], s52 offen lds
  s_add_u32 m0, s53, 55296
  s_add_u32 s52, s53, 2048
  buffer_load_dwordx4 v48, s[48:51], s52 offen lds
  s_add_u32 m0, s53, 56320
  s_add_u32 s52, s53, 3072
  buffer_load_dwordx4 v48, s[48:51], s52 offen lds
  s_add_u32 m0, s53, 57344
  s_add_u32 s52, s53, 4096
  buffer_load_dwordx4 v48, s[48:51], s52 offen lds
  s_add_u32 m0, s53, 58368
  s_add_u32 s52, s53, 5120
  buffer_load_dwordx4 v48, s[48:51], s52 offen lds
  s_add_u32 m0, s53, 59392
  s_add_u32 s52, s53, 6144
  buffer_load_dwordx4 v48, s[48:51], s52 offen lds
  s_add_u32 m0, s53, 60416
  s_add_u32 s52, s53, 7168
  buffer_load_dwordx4 v48, s[48:51], s52 offen lds
  s_waitcnt vmcnt(8)
  v_add_f32 v32, v32, v36
  v_add_f32 v40, v40, v44
  v_add_f32 v32, v32, v40
  v_cvt_pk_bf16_f32 v32, v32, v32
  v_and_b32 v32, 0xffff0000, v32
  v_add_f32 v33, v33, v37
  v_add_f32 v41, v41, v45
  v_add_f32 v33, v33, v41
  v_cvt_pk_bf16_f32 v33, v33, v33
  v_and_b32 v33, 0xffff0000, v33
  v_add_f32 v34, v34, v38
  v_add_f32 v42, v42, v46
  v_add_f32 v34, v34, v42
  v_cvt_pk_bf16_f32 v34, v34, v34
  v_and_b32 v34, 0xffff0000, v34
  v_add_f32 v35, v35, v39
  v_add_f32 v43, v43, v47
  v_add_f32 v35, v35, v43
  v_cvt_pk_bf16_f32 v35, v35, v35
  v_and_b32 v35, 0xffff0000, v35
  s_cmp_ge_u32 s15, 4
  s_cbranch_scc0 L_k2_ln_kv_kernel_noadd_1
  v_add_f32 v32, 1.0, v32
  v_cvt_pk_bf16_f32 v32, v32, v32
  v_and_b32 v32, 0xffff0000, v32
  v_add_f32 v33, 1.0, v33
  v_cvt_pk_bf16_f32 v33, v33, v33
  v_and_b32 v33, 0xffff0000, v33
  v_add_f32 v34, 1.0, v34
  v_cvt_pk_bf16_f32 v34, v34, v34
  v_and_b32 v34, 0xffff0000, v34
  v_add_f32 v35, 1.0, v35
  v_cvt_pk_bf16_f32 v35, v35, v35
  v_and_b32 v35, 0xffff0000, v35
L_k2_ln_kv_kernel_noadd_1:
  ds_write_b128 v29, v[32:35] offset:0
  s_waitcnt lgkmcnt(0)
  s_barrier
  ds_read_b128 v[96:99], v49 offset:0
  ds_read_b128 v[100:103], v49 offset:16
  ds_read_b128 v[104:107], v49 offset:2048
  ds_read_b128 v[108:111], v49 offset:2064
  ds_read_b128 v[112:115], v49 offset:4096
  ds_read_b128 v[116:119], v49 offset:4112
  ds_read_b128 v[120:123], v49 offset:6144
  ds_read_b128 v[124:127], v49 offset:6160
  s_waitcnt lgkmcnt(0)
  v_fma_f32 v64, v64, v112, v96
  v_fma_f32 v65, v65, v113, v97
  v_fma_f32 v66, v66, v114, v98
  v_fma_f32 v67, v67, v115, v99
  v_fma_f32 v68, v68, v116, v100
  v_fma_f32 v69, v69, v117, v101
  v_fma_f32 v70, v70, v118, v102
  v_fma_f32 v71, v71, v119, v103
  v_fma_f32 v72, v72, v120, v104
  v_fma_f32 v73, v73, v121, v105
  v_fma_f32 v74, v74, v122, v106
  v_fma_f32 v75, v75, v123, v107
  v_fma_f32 v76, v76, v124, v108
  v_fma_f32 v77, v77, v125, v109
  v_fma_f32 v78, v78, v126, v110
  v_fma_f32 v79, v79, v127, v111
  v_cvt_pk_bf16_f32 v8, v64, v65
  v_cvt_pk_bf16_f32 v9, v66, v67
  v_cvt_pk_bf16_f32 v10, v68, v69
  v_cvt_pk_bf16_f32 v11, v70, v71
  v_cvt_pk_bf16_f32 v12, v72, v73
  v_cvt_pk_bf16_f32 v13, v74, v75
  v_cvt_pk_bf16_f32 v14, v76, v77
  v_cvt_pk_bf16_f32 v15, v78, v79
  v_fma_f32 v80, v80, v112, v96
  v_fma_f32 v81, v81, v113, v97
  v_fma_f32 v82, v82, v114, v98
  v_fma_f32 v83, v83, v115, v99
  v_fma_f32 v84, v84, v116, v100
  v_fma_f32 v85, v85, v117, v101
  v_fma_f32 v86, v86, v118, v102
  v_fma_f32 v87, v87, v119, v103
  v_fma_f32 v88, v88, v120, v104
  v_fma_f32 v89, v89, v121, v105
  v_fma_f32 v90, v90, v122, v106
  v_fma_f32 v91, v91, v123, v107
  v_fma_f32 v92, v92, v124, v108
  v_fma_f32 v93, v93, v125, v109
  v_fma_f32 v94, v94, v126, v110
  v_fma_f32 v95, v95, v127, v111
  v_cvt_pk_bf16_f32 v16, v80, v81
  v_cvt_pk_bf16_f32 v17, v82, v83
  v_cvt_pk_bf16_f32 v18, v84, v85
  v_cvt_pk_bf16_f32 v19, v86, v87
  v_cvt_pk_bf16_f32 v20, v88, v89
  v_cvt_pk_bf16_f32 v21, v90, v91
  v_cvt_pk_bf16_f32 v22, v92, v93
  v_cvt_pk_bf16_f32 v23, v94, v95
  ds_write_b128 v50, v[8:11]
  ds_write_b128 v50, v[12:15] offset:1024
  ds_write_b128 v51, v[16:19]
  ds_write_b128 v51, v[20:23] offset:1024
  s_lshr_b32 s3, s15, 2
  s_cmp_eq_u32 s3, s13
  s_cbranch_scc0 L_k2_ln_kv_kernel_nostore_2
  buffer_store_dwordx4 v[8:11], v5, s[40:43], 0 offen offset:0 sc1
  buffer_store_dwordx4 v[12:15], v5, s[40:43], 0 offen offset:1024 sc1
  buffer_store_dwordx4 v[16:19], v5, s[40:43], 0 offen offset:2048 sc1
  buffer_store_dwordx4 v[20:23], v5, s[40:43], 0 offen offset:3072 sc1
  s_waitcnt vmcnt(4)
  s_branch L_k2_ln_kv_kernel_wdone_3
L_k2_ln_kv_kernel_nostore_2:
  s_waitcnt vmcnt(0)
L_k2_ln_kv_kernel_wdone_3:
  s_waitcnt lgkmcnt(0)
  s_barrier
  ds_read_b128 v[96:99], v56
  ds_read_b64_tr_b16 v[64:65], v52 offset:53248
  ds_read_b64_tr_b16 v[66:67], v52 offset:53504
  ds_read_b64_tr_b16 v[68:69], v53 offset:53248
  ds_read_b64_tr_b16 v[70:71], v53 offset:53504
  ds_read_b128 v[100:103], v57
  ds_read_b64_tr_b16 v[72:73], v52 offset:55296
  ds_read_b64_tr_b16 v[74:75], v52 offset:55552
  ds_read_b64_tr_b16 v[76:77], v53 offset:55296
  ds_read_b64_tr_b16 v[78:79], v53 offset:55552
  ds_read_b128 v[104:107], v58
  ds_read_b64_tr_b16 v[80:81], v52 offset:57344
  ds_read_b64_tr_b16 v[82:83], v52 offset:57600
  ds_read_b64_tr_b16 v[84:85], v53 offset:57344
  ds_read_b64_tr_b16 v[86:87], v53 offset:57600
  ds_read_b128 v[108:111], v59
  ds_read_b64_tr_b16 v[88:89], v52 offset:59392
  ds_read_b64_tr_b16 v[90:91], v52 offset:59648
  ds_read_b64_tr_b16 v[92:93], v53 offset:59392
  ds_read_b64_tr_b16 v[94:95], v53 offset:59648
  s_waitcnt lgkmcnt(15)
  v_mfma_f32_16x16x32_bf16 v[112:115], v[64:67], v[96:99], 0
  v_mfma_f32_16x16x32_bf16 v[116:119], v[68:71], v[96:99], 0
  s_waitcnt lgkmcnt(10)
  v_mfma_f32_16x16x32_bf16 v[112:115], v[72:75], v[100:103], v[112:115]
  v_mfma_f32_16x16x32_bf16 v[116:119], v[76:79], v[100:103], v[116:119]
  s_waitcnt lgkmcnt(5)
  v_mfma_f32_16x16x32_bf16 v[112:115], v[80:83], v[104:107], v[112:115]
  v_mfma_f32_16x16x32_bf16 v[116:119], v[84:87], v[104:107], v[116:119]
  s_waitcnt lgkmcnt(0)
  v_mfma_f32_16x16x32_bf16 v[112:115], v[88:91], v[108:111], v[112:115]
  v_mfma_f32_16x16x32_bf16 v[116:119], v[92:95], v[108:111], v[116:119]
  s_nop 6
  ds_write_b128 v60, v[112:115]
  ds_write_b128 v60, v[116:119] offset:64
  s_waitcnt lgkmcnt(0)
  s_barrier
  v_lshlrev_b32 v128, 2, v0
  ds_read_b32 v120, v128 offset:0
  ds_read_b32 v121, v128 offset:2048
  ds_read_b32 v122, v128 offset:4096
  ds_read_b32 v123, v128 offset:6144
  ds_read_b32 v124, v128 offset:8192
  ds_read_b32 v125, v128 offset:10240
  ds_read_b32 v126, v128 offset:12288
  ds_read_b32 v127, v128 offset:14336
  s_waitcnt lgkmcnt(0)
  v_add_f32 v120, v120, v124
  v_add_f32 v121, v121, v125
  v_add_f32 v122, v122, v126
  v_add_f32 v123, v123, v127
  v_add_f32 v120, v120, v122
  v_add_f32 v121, v121, v123
  v_add_f32 v120, v120, v121
  v_cvt_pk_bf16_f32 v120, v120, v120
  v_and_b32 v120, 0xffff0000, v120
  ds_write_b32 v128, v120 offset:16384
  s_waitcnt lgkmcnt(0)
  s_barrier
  s_cmp_ge_u32 s15, 1
  s_cbranch_scc1 L_k2_ln_kv_kernel_end
  s_lshr_b32 s54, s12, 1
  s_lshl_b32 s54, s54, 11
  s_and_b32 s55, s12, 1
  s_cmp_eq_u32 s13, 0
  s_cbranch_scc0 L_k2_ln_kv_kernel_v_4
  s_add_u32 s16, s6, 0x200000
  s_addc_u32 s17, s7, 0
  s_mov_b32 s18, 0x20000
  s_mov_b32 s19, 0x20000
  v_and_b32 v3, 15, v1
  v_bfe_u32 v4, v1, 4, 1
  v_lshlrev_b32 v60, 7, v3
  v_lshl_add_u32 v60, v4, 6, v60
  v_lshrrev_b32 v129, 5, v1
  v_lshl_add_u32 v60, v129, 4, v60
  ds_read_b128 v[96:99], v60 offset:16384
  ds_read_b128 v[100:103], v60 offset:16416
  v_lshl_add_u32 v129, v129, 5, v3
  v_lshlrev_b32 v129, 4, v129
  v_lshl_add_u32 v129, v4, 10, v129
  s_lshl_b32 s55, s55, 8
  s_add_u32 s54, s54, s55
  s_waitcnt lgkmcnt(0)
  v_mul_f32 v130, v96, v96
  v_fmac_f32 v130, v97, v97
  v_fmac_f32 v130, v98, v98
  v_fmac_f32 v130, v99, v99
  v_fmac_f32 v130, v100, v100
  v_fmac_f32 v130, v101, v101
  v_fmac_f32 v130, v102, v102
  v_fmac_f32 v130, v103, v103
  v_cvt_pk_bf16_f32 v96, v96, v97
  v_cvt_pk_bf16_f32 v97, v98, v99
  v_cvt_pk_bf16_f32 v98, v100, v101
  v_cvt_pk_bf16_f32 v99, v102, v103
  buffer_store_dwordx4 v[96:99], v129, s[16:19], s54 offen sc1
  v_mov_b32 v131, v130
  s_nop 1
  v_permlane16_swap_b32 v130, v131
  v_add_f32 v130, v130, v131
  v_mov_b32 v131, v130
  s_nop 1
  v_permlane32_swap_b32 v130, v131
  v_add_f32 v130, v130, v131
  s_nop 1
  v_max_f32_dpp v130, v130, v130 row_ror:1 row_mask:0xf bank_mask:0xf
  s_nop 1
  v_max_f32_dpp v130, v130, v130 row_ror:2 row_mask:0xf bank_mask:0xf
  s_nop 1
  v_max_f32_dpp v130, v130, v130 row_ror:4 row_mask:0xf bank_mask:0xf
  s_nop 1
  v_max_f32_dpp v130, v130, v130 row_ror:8 row_mask:0xf bank_mask:0xf
  s_add_u32 s28, s6, 0x8000
  s_addc_u32 s29, s7, 0
  s_mov_b32 s30, 0x200
  s_mov_b32 s31, 0x20000
  s_lshl_b32 s55, s12, 2
  v_mov_b32 v60, 0
  v_cmp_eq_u32 vcc, 0, v1
  s_nop 0
  s_and_saveexec_b64 s[36:37], vcc
  buffer_store_dword v130, v60, s[28:31], s55 offen
  s_branch L_k2_ln_kv_kernel_end
L_k2_ln_kv_kernel_v_4:
  s_add_u32 s16, s6, 0x220000
  s_addc_u32 s17, s7, 0
  s_mov_b32 s18, 0x20000
  s_mov_b32 s19, 0x20000
  v_and_b32 v3, 31, v1
  v_lshrrev_b32 v4, 5, v1
  v_lshlrev_b32 v60, 2, v3
  v_lshl_add_u32 v60, v4, 9, v60
  ds_read_b32 v96, v60 offset:16384
  ds_read_b32 v97, v60 offset:16512
  ds_read_b32 v98, v60 offset:16640
  ds_read_b32 v99, v60 offset:16768
  ds_read_b32 v100, v60 offset:17408
  ds_read_b32 v101, v60 offset:17536
  ds_read_b32 v102, v60 offset:17664
  ds_read_b32 v103, v60 offset:17792
  v_lshlrev_b32 v129, 4, v1
  s_lshl_b32 s55, s55, 10
  s_add_u32 s54, s54, s55
  s_waitcnt lgkmcnt(0)
  v_cvt_pk_bf16_f32 v96, v96, v97
  v_cvt_pk_bf16_f32 v97, v98, v99
  v_cvt_pk_bf16_f32 v98, v100, v101
  v_cvt_pk_bf16_f32 v99, v102, v103
  buffer_store_dwordx4 v[96:99], v129, s[16:19], s54 offen sc1
L_k2_ln_kv_kernel_end:
L_k2_ln_kv_kernel_exit:
  s_endpgm
.globl k3_attn_kernel
.p2align 8
.type k3_attn_kernel,@function
k3_attn_kernel:
  s_cmp_ge_u32 s2, 256
  s_cbranch_scc1 L_k3_attn_kernel_exit
  s_load_dwordx2 s[4:5], s[0:1], 112
  s_load_dwordx2 s[6:7], s[0:1], 8
  s_and_b32 s8, s2, 7
  s_lshr_b32 s9, s2, 3
  s_and_b32 s10, s8, 3
  s_mul_i32 s10, s10, 4
  s_and_b32 s3, s9, 3
  s_add_u32 s10, s10, s3
  s_lshr_b32 s11, s8, 2
  s_mul_i32 s11, s11, 8
  s_lshr_b32 s3, s9, 2
  s_add_u32 s11, s11, s3
  v_and_b32 v1, 63, v0
  v_lshrrev_b32 v2, 6, v0
  v_and_b32 v3, 3, v2
  v_readfirstlane_b32 s12, v2
  s_nop 0
  s_and_b32 s13, s12, 3
  s_lshl_b32 s14, s10, 18
  s_lshl_b32 s15, s11, 7
  s_lshl_b32 s16, s12, 10
  s_waitcnt lgkmcnt(0)
  v_lshlrev_b32 v16, 4, v1
  s_add_u32 s20, s4, 0x200000
  s_addc_u32 s21, s5, 0
  s_mov_b32 s22, 0x20000
  s_mov_b32 s23, 0x20000
  s_add_u32 s24, s4, 0x220000
  s_addc_u32 s25, s5, 0
  s_mov_b32 s26, 0x20000
  s_mov_b32 s27, 0x20000
  v_lshlrev_b32 v17, 4, v0
  s_add_u32 s36, s4, 0x8000
  s_addc_u32 s37, s5, 0
  s_mov_b32 s38, 0x200
  s_mov_b32 s39, 0x20000
  v_lshlrev_b32 v4, 3, v1
  buffer_load_dwordx2 v[118:119], v4, s[36:39], 0 offen
  s_cmp_ge_u32 s12, 4
  s_cbranch_scc1 L_k3_attn_kernel_qload_1
  s_setprio 1
  v_and_b32 v5, 31, v1
  v_lshl_add_u32 v4, v3, 5, v5
  v_bfe_u32 v5, v4, 1, 3
  v_lshrrev_b32 v6, 5, v1
  v_add_u32 v120, 0, v6
  v_xor_b32 v120, v120, v5
  v_lshlrev_b32 v120, 4, v120
  v_lshl_add_u32 v120, v4, 7, v120
  v_add_u32 v121, 2, v6
  v_xor_b32 v121, v121, v5
  v_lshlrev_b32 v121, 4, v121
  v_lshl_add_u32 v121, v4, 7, v121
  v_add_u32 v122, 4, v6
  v_xor_b32 v122, v122, v5
  v_lshlrev_b32 v122, 4, v122
  v_lshl_add_u32 v122, v4, 7, v122
  v_add_u32 v123, 6, v6
  v_xor_b32 v123, v123, v5
  v_lshlrev_b32 v123, 4, v123
  v_lshl_add_u32 v123, v4, 7, v123
  v_lshrrev_b32 v4, 5, v1
  v_lshlrev_b32 v4, 3, v4
  v_bfe_u32 v5, v1, 2, 2
  v_add_u32 v127, v4, v5
  v_and_b32 v5, 2, v127
  v_lshlrev_b32 v5, 1, v5
  v_bfe_u32 v126, v1, 4, 1
  v_lshlrev_b32 v6, 1, v126
  v_bfe_u32 v126, v1, 1, 1
  v_add_u32 v6, v6, v126
  v_xor_b32 v6, v6, v5
  v_lshlrev_b32 v4, 7, v127
  v_lshl_add_u32 v4, v6, 4, v4
  v_and_b32 v5, 1, v1
  v_lshl_add_u32 v124, v5, 3, v4
  v_add_u32 v124, 0x4000, v124
  v_and_b32 v5, 2, v127
  v_lshlrev_b32 v5, 1, v5
  v_bfe_u32 v126, v1, 4, 1
  v_lshlrev_b32 v6, 1, v126
  v_bfe_u32 v126, v1, 1, 1
  v_add_u32 v6, v6, v126
  v_add_u32 v6, 4, v6
  v_xor_b32 v6, v6, v5
  v_lshlrev_b32 v4, 7, v127
  v_lshl_add_u32 v4, v6, 4, v4
  v_and_b32 v5, 1, v1
  v_lshl_add_u32 v125, v5, 3, v4
  v_add_u32 v125, 0x4000, v125
  v_mov_b32 v20, 0
  v_mov_b32 v36, 0
  v_mov_b32 v21, 0
  v_mov_b32 v37, 0
  v_mov_b32 v22, 0
  v_mov_b32 v38, 0
  v_mov_b32 v23, 0
  v_mov_b32 v39, 0
  v_mov_b32 v24, 0
  v_mov_b32 v40, 0
  v_mov_b32 v25, 0
  v_mov_b32 v41, 0
  v_mov_b32 v26, 0
  v_mov_b32 v42, 0
  v_mov_b32 v27, 0
  v_mov_b32 v43, 0
  v_mov_b32 v28, 0
  v_mov_b32 v44, 0
  v_mov_b32 v29, 0
  v_mov_b32 v45, 0
  v_mov_b32 v30, 0
  v_mov_b32 v46, 0
  v_mov_b32 v31, 0
  v_mov_b32 v47, 0
  v_mov_b32 v32, 0
  v_mov_b32 v48, 0
  v_mov_b32 v33, 0
  v_mov_b32 v49, 0
  v_mov_b32 v34, 0
  v_mov_b32 v50, 0
  v_mov_b32 v35, 0
  v_mov_b32 v51, 0
  s_mov_b32 s40, 65536
  v_add_u32 v130, s40, v120
  v_add_u32 v131, s40, v121
  v_add_u32 v132, s40, v122
  v_add_u32 v133, s40, v123
  v_add_u32 v128, s40, v124
  v_add_u32 v129, s40, v125
  s_barrier
  ds_read_b128 v[52:55], v130
  ds_read_b64_tr_b16 v[84:85], v128 offset:0
  ds_read_b64_tr_b16 v[86:87], v128 offset:512
  ds_read_b64_tr_b16 v[100:101], v129 offset:0
  ds_read_b64_tr_b16 v[102:103], v129 offset:512
  ds_read_b128 v[56:59], v131
  ds_read_b64_tr_b16 v[88:89], v128 offset:2048
  ds_read_b64_tr_b16 v[90:91], v128 offset:2560
  ds_read_b64_tr_b16 v[104:105], v129 offset:2048
  ds_read_b64_tr_b16 v[106:107], v129 offset:2560
  ds_read_b128 v[60:63], v132
  ds_read_b64_tr_b16 v[92:93], v128 offset:4096
  ds_read_b64_tr_b16 v[94:95], v128 offset:4608
  ds_read_b64_tr_b16 v[108:109], v129 offset:4096
  ds_read_b64_tr_b16 v[110:111], v129 offset:4608
  ds_read_b128 v[64:67], v133
  ds_read_b64_tr_b16 v[96:97], v128 offset:6144
  ds_read_b64_tr_b16 v[98:99], v128 offset:6656
  ds_read_b64_tr_b16 v[112:113], v129 offset:6144
  ds_read_b64_tr_b16 v[114:115], v129 offset:6656
  s_mov_b32 s31, 8
L_k3_attn_kernel_ql_3:
  s_waitcnt lgkmcnt(0)
  s_barrier
  s_add_u32 s40, s40, 24576
  s_cmp_ge_u32 s40, 163840
  s_cselect_b32 s3, 98304, 0
  s_sub_u32 s40, s40, s3
  v_add_u32 v130, s40, v120
  v_add_u32 v131, s40, v121
  v_add_u32 v132, s40, v122
  v_add_u32 v133, s40, v123
  v_add_u32 v128, s40, v124
  v_add_u32 v129, s40, v125
  v_mfma_f32_32x32x16_bf16 v[20:35], v[84:87], v[52:55], v[20:35]
  ds_read_b128 v[68:71], v130
  ds_read_b64_tr_b16 v[136:137], v128 offset:0
  ds_read_b64_tr_b16 v[138:139], v128 offset:512
  v_mfma_f32_32x32x16_bf16 v[36:51], v[100:103], v[52:55], v[36:51]
  ds_read_b64_tr_b16 v[152:153], v129 offset:0
  ds_read_b64_tr_b16 v[154:155], v129 offset:512
  ds_read_b128 v[72:75], v131
  v_mfma_f32_32x32x16_bf16 v[20:35], v[88:91], v[56:59], v[20:35]
  ds_read_b64_tr_b16 v[140:141], v128 offset:2048
  ds_read_b64_tr_b16 v[142:143], v128 offset:2560
  ds_read_b64_tr_b16 v[156:157], v129 offset:2048
  v_mfma_f32_32x32x16_bf16 v[36:51], v[104:107], v[56:59], v[36:51]
  ds_read_b64_tr_b16 v[158:159], v129 offset:2560
  ds_read_b128 v[76:79], v132
  ds_read_b64_tr_b16 v[144:145], v128 offset:4096
  v_mfma_f32_32x32x16_bf16 v[20:35], v[92:95], v[60:63], v[20:35]
  ds_read_b64_tr_b16 v[146:147], v128 offset:4608
  ds_read_b64_tr_b16 v[160:161], v129 offset:4096
  ds_read_b64_tr_b16 v[162:163], v129 offset:4608
  v_mfma_f32_32x32x16_bf16 v[36:51], v[108:111], v[60:63], v[36:51]
  ds_read_b128 v[80:83], v133
  ds_read_b64_tr_b16 v[148:149], v128 offset:6144
  ds_read_b64_tr_b16 v[150:151], v128 offset:6656
  v_mfma_f32_32x32x16_bf16 v[20:35], v[96:99], v[64:67], v[20:35]
  ds_read_b64_tr_b16 v[164:165], v129 offset:6144
  ds_read_b64_tr_b16 v[166:167], v129 offset:6656
  v_mfma_f32_32x32x16_bf16 v[36:51], v[112:115], v[64:67], v[36:51]
  s_waitcnt lgkmcnt(0)
  s_barrier
  s_add_u32 s40, s40, 24576
  s_cmp_ge_u32 s40, 163840
  s_cselect_b32 s3, 98304, 0
  s_sub_u32 s40, s40, s3
  v_add_u32 v130, s40, v120
  v_add_u32 v131, s40, v121
  v_add_u32 v132, s40, v122
  v_add_u32 v133, s40, v123
  v_add_u32 v128, s40, v124
  v_add_u32 v129, s40, v125
  v_mfma_f32_32x32x16_bf16 v[20:35], v[136:139], v[68:71], v[20:35]
  ds_read_b128 v[52:55], v130
  ds_read_b64_tr_b16 v[84:85], v128 offset:0
  ds_read_b64_tr_b16 v[86:87], v128 offset:512
  v_mfma_f32_32x32x16_bf16 v[36:51], v[152:155], v[68:71], v[36:51]
  ds_read_b64_tr_b16 v[100:101], v129 offset:0
  ds_read_b64_tr_b16 v[102:103], v129 offset:512
  ds_read_b128 v[56:59], v131
  v_mfma_f32_32x32x16_bf16 v[20:35], v[140:143], v[72:75], v[20:35]
  ds_read_b64_tr_b16 v[88:89], v128 offset:2048
  ds_read_b64_tr_b16 v[90:91], v128 offset:2560
  ds_read_b64_tr_b16 v[104:105], v129 offset:2048
  v_mfma_f32_32x32x16_bf16 v[36:51], v[156:159], v[72:75], v[36:51]
  ds_read_b64_tr_b16 v[106:107], v129 offset:2560
  ds_read_b128 v[60:63], v132
  ds_read_b64_tr_b16 v[92:93], v128 offset:4096
  v_mfma_f32_32x32x16_bf16 v[20:35], v[144:147], v[76:79], v[20:35]
  ds_read_b64_tr_b16 v[94:95], v128 offset:4608
  ds_read_b64_tr_b16 v[108:109], v129 offset:4096
  ds_read_b64_tr_b16 v[110:111], v129 offset:4608
  v_mfma_f32_32x32x16_bf16 v[36:51], v[160:163], v[76:79], v[36:51]
  ds_read_b128 v[64:67], v133
  ds_read_b64_tr_b16 v[96:97], v128 offset:6144
  ds_read_b64_tr_b16 v[98:99], v128 offset:6656
  v_mfma_f32_32x32x16_bf16 v[20:35], v[148:151], v[80:83], v[20:35]
  ds_read_b64_tr_b16 v[112:113], v129 offset:6144
  ds_read_b64_tr_b16 v[114:115], v129 offset:6656
  v_mfma_f32_32x32x16_bf16 v[36:51], v[164:167], v[80:83], v[36:51]
  s_sub_u32 s31, s31, 1
  s_cmp_lg_u32 s31, 0
  s_cbranch_scc1 L_k3_attn_kernel_ql_3
  s_waitcnt lgkmcnt(0)
  s_nop 4
  v_mul_f32 v20, 0x3e8293ee, v20
  v_mul_f32 v21, 0x3e8293ee, v21
  v_mul_f32 v22, 0x3e8293ee, v22
  v_mul_f32 v23, 0x3e8293ee, v23
  v_mul_f32 v24, 0x3e8293ee, v24
  v_mul_f32 v25, 0x3e8293ee, v25
  v_mul_f32 v26, 0x3e8293ee, v26
  v_mul_f32 v27, 0x3e8293ee, v27
  v_mul_f32 v28, 0x3e8293ee, v28
  v_mul_f32 v29, 0x3e8293ee, v29
  v_mul_f32 v30, 0x3e8293ee, v30
  v_mul_f32 v31, 0x3e8293ee, v31
  v_mul_f32 v32, 0x3e8293ee, v32
  v_mul_f32 v33, 0x3e8293ee, v33
  v_mul_f32 v34, 0x3e8293ee, v34
  v_mul_f32 v35, 0x3e8293ee, v35
  v_cvt_pk_bf16_f32 v8, v20, v21
  v_cvt_pk_bf16_f32 v9, v22, v23
  v_cvt_pk_bf16_f32 v10, v24, v25
  v_cvt_pk_bf16_f32 v11, v26, v27
  v_cvt_pk_bf16_f32 v12, v28, v29
  v_cvt_pk_bf16_f32 v13, v30, v31
  v_cvt_pk_bf16_f32 v14, v32, v33
  v_cvt_pk_bf16_f32 v15, v34, v35
  v_mul_f32 v36, 0x3e8293ee, v36
  v_mul_f32 v37, 0x3e8293ee, v37
  v_mul_f32 v38, 0x3e8293ee, v38
  v_mul_f32 v39, 0x3e8293ee, v39
  v_mul_f32 v40, 0x3e8293ee, v40
  v_mul_f32 v41, 0x3e8293ee, v41
  v_mul_f32 v42, 0x3e8293ee, v42
  v_mul_f32 v43, 0x3e8293ee, v43
  v_mul_f32 v44, 0x3e8293ee, v44
  v_mul_f32 v45, 0x3e8293ee, v45
  v_mul_f32 v46, 0x3e8293ee, v46
  v_mul_f32 v47, 0x3e8293ee, v47
  v_mul_f32 v48, 0x3e8293ee, v48
  v_mul_f32 v49, 0x3e8293ee, v49
  v_mul_f32 v50, 0x3e8293ee, v50
  v_mul_f32 v51, 0x3e8293ee, v51
  v_cvt_pk_bf16_f32 v136, v36, v37
  v_cvt_pk_bf16_f32 v137, v38, v39
  v_cvt_pk_bf16_f32 v138, v40, v41
  v_cvt_pk_bf16_f32 v139, v42, v43
  v_cvt_pk_bf16_f32 v140, v44, v45
  v_cvt_pk_bf16_f32 v141, v46, v47
  v_cvt_pk_bf16_f32 v142, v48, v49
  v_cvt_pk_bf16_f32 v143, v50, v51
  s_setprio 0
  s_barrier
  v_lshlrev_b32 v130, 11, v3
  v_lshl_add_u32 v130, v1, 4, v130
  v_add_u32 v130, 0x10000, v130
  ds_write_b128 v130, v[136:139]
  ds_write_b128 v130, v[140:143] offset:1024
  s_waitcnt lgkmcnt(0)
  s_barrier
  s_branch L_k3_attn_kernel_qjoin_2
L_k3_attn_kernel_qload_1:
  v_lshrrev_b32 v4, 3, v1
  v_lshl_add_u32 v4, v3, 3, v4
  v_bfe_u32 v5, v4, 1, 3
  v_and_b32 v6, 7, v1
  v_xor_b32 v5, v6, v5
  v_lshlrev_b32 v4, 11, v4
  v_lshl_add_u32 v120, v5, 4, v4
  v_add_u32 v121, 0x10000, v120
  v_add_u32 v122, 0x20000, v120
  v_add_u32 v123, 0x30000, v120
  v_lshrrev_b32 v4, 3, v1
  v_lshl_add_u32 v4, v3, 3, v4
  v_and_b32 v5, 7, v1
  v_and_b32 v6, 2, v4
  v_lshlrev_b32 v6, 1, v6
  v_xor_b32 v5, v5, v6
  v_lshlrev_b32 v4, 11, v4
  v_lshl_add_u32 v124, v5, 4, v4
  v_add_u32 v125, 0x10000, v124
  v_lshlrev_b32 v126, 10, v3
  v_lshl_add_u32 v126, v1, 4, v126
  v_add_u32 v127, 0x1000, v126
  s_add_u32 s40, s4, 0x400000
  s_addc_u32 s41, s5, 0
  s_add_u32 s40, s40, s14
  s_addc_u32 s41, s41, 0
  s_mov_b32 s42, 0x40000
  s_mov_b32 s43, 0x20000
  s_add_u32 s44, s6, s15
  s_addc_u32 s45, s7, 0
  s_mov_b32 s46, 0x200000
  s_mov_b32 s47, 0x20000
  s_sub_u32 s46, 2097152, s15
  s_lshl_b32 s52, s13, 10
  s_add_u32 s50, s52, 65536
  s_add_u32 s51, s50, 98304
  s_mov_b32 s48, 0
  s_mov_b32 s49, 0
  s_add_u32 m0, s50, 0
  s_nop 0
  buffer_load_dwordx4 v120, s[40:43], s48 offen lds
  s_add_u32 m0, s50, 4096
  s_nop 0
  buffer_load_dwordx4 v121, s[40:43], s48 offen lds
  s_add_u32 m0, s50, 8192
  s_nop 0
  buffer_load_dwordx4 v122, s[40:43], s48 offen lds
  s_add_u32 m0, s50, 12288
  s_nop 0
  buffer_load_dwordx4 v123, s[40:43], s48 offen lds
  s_add_u32 m0, s50, 16384
  s_nop 0
  buffer_load_dwordx4 v124, s[44:47], s49 offen lds
  s_add_u32 m0, s50, 20480
  s_nop 0
  buffer_load_dwordx4 v125, s[44:47], s49 offen lds
  s_add_u32 s48, s48, 128
  s_add_u32 s49, s49, 131072
  s_add_u32 s50, s50, 24576
  s_cmp_ge_u32 s50, s51
  s_cselect_b32 s3, 98304, 0
  s_sub_u32 s50, s50, s3
  s_add_u32 m0, s50, 0
  s_nop 0
  buffer_load_dwordx4 v120, s[40:43], s48 offen lds
  s_add_u32 m0, s50, 4096
  s_nop 0
  buffer_load_dwordx4 v121, s[40:43], s48 offen lds
  s_add_u32 m0, s50, 8192
  s_nop 0
  buffer_load_dwordx4 v122, s[40:43], s48 offen lds
  s_add_u32 m0, s50, 12288
  s_nop 0
  buffer_load_dwordx4 v123, s[40:43], s48 offen lds
  s_add_u32 m0, s50, 16384
  s_nop 0
  buffer_load_dwordx4 v124, s[44:47], s49 offen lds
  s_add_u32 m0, s50, 20480
  s_nop 0
  buffer_load_dwordx4 v125, s[44:47], s49 offen lds
  s_add_u32 s48, s48, 128
  s_add_u32 s49, s49, 131072
  s_add_u32 s50, s50, 24576
  s_cmp_ge_u32 s50, s51
  s_cselect_b32 s3, 98304, 0
  s_sub_u32 s50, s50, s3
  s_add_u32 m0, s50, 0
  s_nop 0
  buffer_load_dwordx4 v120, s[40:43], s48 offen lds
  s_add_u32 m0, s50, 4096
  s_nop 0
  buffer_load_dwordx4 v121, s[40:43], s48 offen lds
  s_add_u32 m0, s50, 8192
  s_nop 0
  buffer_load_dwordx4 v122, s[40:43], s48 offen lds
  s_add_u32 m0, s50, 12288
  s_nop 0
  buffer_load_dwordx4 v123, s[40:43], s48 offen lds
  s_add_u32 m0, s50, 16384
  s_nop 0
  buffer_load_dwordx4 v124, s[44:47], s49 offen lds
  s_add_u32 m0, s50, 20480
  s_nop 0
  buffer_load_dwordx4 v125, s[44:47], s49 offen lds
  s_add_u32 s48, s48, 128
  s_add_u32 s49, s49, 131072
  s_add_u32 s50, s50, 24576
  s_cmp_ge_u32 s50, s51
  s_cselect_b32 s3, 98304, 0
  s_sub_u32 s50, s50, s3
  s_add_u32 m0, s50, 0
  s_nop 0
  buffer_load_dwordx4 v120, s[40:43], s48 offen lds
  s_add_u32 m0, s50, 4096
  s_nop 0
  buffer_load_dwordx4 v121, s[40:43], s48 offen lds
  s_add_u32 m0, s50, 8192
  s_nop 0
  buffer_load_dwordx4 v122, s[40:43], s48 offen lds
  s_add_u32 m0, s50, 12288
  s_nop 0
  buffer_load_dwordx4 v123, s[40:43], s48 offen lds
  s_add_u32 m0, s50, 16384
  s_nop 0
  buffer_load_dwordx4 v124, s[44:47], s49 offen lds
  s_add_u32 m0, s50, 20480
  s_nop 0
  buffer_load_dwordx4 v125, s[44:47], s49 offen lds
  s_add_u32 s48, s48, 128
  s_add_u32 s49, s49, 131072
  s_add_u32 s50, s50, 24576
  s_cmp_ge_u32 s50, s51
  s_cselect_b32 s3, 98304, 0
  s_sub_u32 s50, s50, s3
  s_waitcnt vmcnt(18)
  s_barrier
  s_mov_b32 s31, 12
L_k3_attn_kernel_qll_4:
  s_waitcnt vmcnt(12)
  s_barrier
  s_add_u32 m0, s50, 0
  s_nop 0
  buffer_load_dwordx4 v120, s[40:43], s48 offen lds
  s_add_u32 m0, s50, 4096
  s_nop 0
  buffer_load_dwordx4 v121, s[40:43], s48 offen lds
  s_add_u32 m0, s50, 8192
  s_nop 0
  buffer_load_dwordx4 v122, s[40:43], s48 offen lds
  s_add_u32 m0, s50, 12288
  s_nop 0
  buffer_load_dwordx4 v123, s[40:43], s48 offen lds
  s_add_u32 m0, s50, 16384
  s_nop 0
  buffer_load_dwordx4 v124, s[44:47], s49 offen lds
  s_add_u32 m0, s50, 20480
  s_nop 0
  buffer_load_dwordx4 v125, s[44:47], s49 offen lds
  s_add_u32 s48, s48, 128
  s_add_u32 s49, s49, 131072
  s_add_u32 s50, s50, 24576
  s_cmp_ge_u32 s50, s51
  s_cselect_b32 s3, 98304, 0
  s_sub_u32 s50, s50, s3
  s_sub_u32 s31, s31, 1
  s_cmp_lg_u32 s31, 0
  s_cbranch_scc1 L_k3_attn_kernel_qll_4
  s_add_u32 m0, s52, 0
  s_mov_b32 s3, 0
  buffer_load_dwordx4 v126, s[20:23], s3 offen lds
  s_add_u32 m0, s52, 4096
  s_mov_b32 s3, 0
  buffer_load_dwordx4 v127, s[20:23], s3 offen lds
  s_add_u32 m0, s52, 8192
  s_mov_b32 s3, 8192
  buffer_load_dwordx4 v126, s[20:23], s3 offen lds
  s_add_u32 m0, s52, 12288
  s_mov_b32 s3, 8192
  buffer_load_dwordx4 v127, s[20:23], s3 offen lds
  s_add_u32 m0, s52, 16384
  s_mov_b32 s3, 0
  buffer_load_dwordx4 v126, s[24:27], s3 offen lds
  s_add_u32 m0, s52, 20480
  s_mov_b32 s3, 0
  buffer_load_dwordx4 v127, s[24:27], s3 offen lds
  s_add_u32 m0, s52, 24576
  s_mov_b32 s3, 8192
  buffer_load_dwordx4 v126, s[24:27], s3 offen lds
  s_add_u32 m0, s52, 28672
  s_mov_b32 s3, 8192
  buffer_load_dwordx4 v127, s[24:27], s3 offen lds
  s_add_u32 m0, s52, 32768
  s_mov_b32 s3, 16384
  buffer_load_dwordx4 v126, s[20:23], s3 offen lds
  s_add_u32 m0, s52, 36864
  s_mov_b32 s3, 16384
  buffer_load_dwordx4 v127, s[20:23], s3 offen lds
  s_add_u32 m0, s52, 40960
  s_mov_b32 s3, 24576
  buffer_load_dwordx4 v126, s[20:23], s3 offen lds
  s_add_u32 m0, s52, 45056
  s_mov_b32 s3, 24576
  buffer_load_dwordx4 v127, s[20:23], s3 offen lds
  s_add_u32 m0, s52, 49152
  s_mov_b32 s3, 16384
  buffer_load_dwordx4 v126, s[24:27], s3 offen lds
  s_add_u32 m0, s52, 53248
  s_mov_b32 s3, 16384
  buffer_load_dwordx4 v127, s[24:27], s3 offen lds
  s_add_u32 m0, s52, 57344
  s_mov_b32 s3, 24576
  buffer_load_dwordx4 v126, s[24:27], s3 offen lds
  s_add_u32 m0, s52, 61440
  s_mov_b32 s3, 24576
  buffer_load_dwordx4 v127, s[24:27], s3 offen lds
  s_waitcnt vmcnt(28)
  s_barrier
  s_waitcnt vmcnt(22)
  s_barrier
  s_waitcnt vmcnt(16)
  s_barrier
  s_waitcnt vmcnt(16)
  s_barrier
  s_barrier
  s_barrier
  v_lshlrev_b32 v120, 11, v3
  v_lshl_add_u32 v120, v1, 4, v120
  v_add_u32 v120, 0x10000, v120
  ds_read_b128 v[8:11], v120
  ds_read_b128 v[12:15], v120 offset:1024
  s_waitcnt lgkmcnt(0)
L_k3_attn_kernel_qjoin_2:
  s_mov_b32 s28, 32768
  s_mov_b32 s32, 0
  s_mov_b32 s33, 32768
  s_load_dwordx2 s[40:41], s[0:1], 80
  s_load_dwordx2 s[42:43], s[0:1], 88
  s_load_dwordx2 s[44:45], s[0:1], 32
  s_load_dwordx2 s[46:47], s[0:1], 48
  s_load_dwordx2 s[48:49], s[0:1], 64
  s_waitcnt vmcnt(0) lgkmcnt(0)
  s_lshr_b32 s50, s2, 6
  s_and_b32 s51, s2, 63
  s_mov_b32 s52, s42
  s_mov_b32 s53, s43
  s_mov_b32 s54, 0xc00000
  s_mov_b32 s55, 0x20000
  s_mov_b32 s56, s40
  s_mov_b32 s57, s41
  s_mov_b32 s58, 0x800
  s_mov_b32 s59, 0x20000
  v_lshrrev_b32 v4, 3, v0
  v_mul_u32_u24 v120, 0x3000, v4
  v_and_b32 v5, 7, v0
  v_lshl_add_u32 v120, v5, 4, v120
  v_lshlrev_b32 v121, 1, v4
  s_mul_i32 s60, s50, 3145728
  s_lshl_b32 s3, s51, 7
  s_add_u32 s60, s60, s3
  s_add_u32 s60, s60, 4096
  s_lshl_b32 s61, s50, 9
  buffer_load_ushort v140, v121, s[56:59], s61 offen offset:0
  buffer_load_ushort v141, v121, s[56:59], s61 offen offset:128
  buffer_load_ushort v142, v121, s[56:59], s61 offen offset:256
  buffer_load_ushort v143, v121, s[56:59], s61 offen offset:384
  v_and_b32 v4, 7, v1
  v_lshl_add_u32 v4, v2, 3, v4
  v_lshlrev_b32 v144, 7, v4
  s_cmp_lt_u32 s2, 32
  s_cselect_b32 s72, s44, s46
  s_cselect_b32 s73, s45, s47
  s_cselect_b32 s76, 0, 32
  s_cmp_lt_u32 s2, 144
  s_cselect_b32 s72, s72, s48
  s_cselect_b32 s73, s73, s49
  s_cselect_b32 s76, s76, 144
  s_sub_u32 s76, s2, s76
  s_lshl_b32 s76, s76, 16
  s_add_u32 s72, s72, s76
  s_addc_u32 s73, s73, 0
  s_mov_b32 s74, 65536
  s_mov_b32 s75, 0x20000
  s_mov_b32 s76, 0
  v_lshlrev_b32 v116, 16, v8
  v_and_b32 v117, 0xffff0000, v8
  v_mul_f32 v146, v116, v116
  v_fmac_f32 v146, v117, v117
  v_lshlrev_b32 v116, 16, v9
  v_and_b32 v117, 0xffff0000, v9
  v_fmac_f32 v146, v116, v116
  v_fmac_f32 v146, v117, v117
  v_lshlrev_b32 v116, 16, v10
  v_and_b32 v117, 0xffff0000, v10
  v_fmac_f32 v146, v116, v116
  v_fmac_f32 v146, v117, v117
  v_lshlrev_b32 v116, 16, v11
  v_and_b32 v117, 0xffff0000, v11
  v_fmac_f32 v146, v116, v116
  v_fmac_f32 v146, v117, v117
  v_lshlrev_b32 v116, 16, v12
  v_and_b32 v117, 0xffff0000, v12
  v_fmac_f32 v146, v116, v116
  v_fmac_f32 v146, v117, v117
  v_lshlrev_b32 v116, 16, v13
  v_and_b32 v117, 0xffff0000, v13
  v_fmac_f32 v146, v116, v116
  v_fmac_f32 v146, v117, v117
  v_lshlrev_b32 v116, 16, v14
  v_and_b32 v117, 0xffff0000, v14
  v_fmac_f32 v146, v116, v116
  v_fmac_f32 v146, v117, v117
  v_lshlrev_b32 v116, 16, v15
  v_and_b32 v117, 0xffff0000, v15
  v_fmac_f32 v146, v116, v116
  v_fmac_f32 v146, v117, v117
  v_mov_b32 v147, v146
  s_nop 1
  v_permlane32_swap_b32 v146, v147
  v_add_f32 v146, v146, v147
  v_max_f32 v118, v118, v119
  s_nop 1
  v_max_f32_dpp v118, v118, v118 row_ror:1 row_mask:0xf bank_mask:0xf
  s_nop 1
  v_max_f32_dpp v118, v118, v118 row_ror:2 row_mask:0xf bank_mask:0xf
  s_nop 1
  v_max_f32_dpp v118, v118, v118 row_ror:4 row_mask:0xf bank_mask:0xf
  s_nop 1
  v_max_f32_dpp v118, v118, v118 row_ror:8 row_mask:0xf bank_mask:0xf
  v_mov_b32 v119, v118
  s_nop 1
  v_permlane16_swap_b32 v118, v119
  v_max_f32 v118, v118, v119
  v_mov_b32 v119, v118
  s_nop 1
  v_permlane32_swap_b32 v118, v119
  v_max_f32 v118, v118, v119
  v_mul_f32 v146, v146, v118
  v_sqrt_f32 v146, v146
  s_nop 0
  v_mul_f32 v146, 0xbf804189, v146
  v_mov_b32 v100, v146
  v_mov_b32 v101, v146
  v_mov_b32 v102, v146
  v_mov_b32 v103, v146
  v_mov_b32 v104, v146
  v_mov_b32 v105, v146
  v_mov_b32 v106, v146
  v_mov_b32 v107, v146
  v_mov_b32 v108, v146
  v_mov_b32 v109, v146
  v_mov_b32 v110, v146
  v_mov_b32 v111, v146
  v_mov_b32 v112, v146
  v_mov_b32 v113, v146
  v_mov_b32 v114, v146
  v_mov_b32 v115, v146
  v_and_b32 v4, 15, v1
  v_bfe_u32 v5, v1, 4, 1
  v_bfe_u32 v6, v1, 2, 1
  v_xor_b32 v5, v5, v6
  v_and_b32 v4, 3, v1
  v_or_b32 v4, v4, v5
  v_cmp_eq_u32 vcc, 0, v4
  v_mov_b32 v5, 0x3f803f80
  s_nop 0
  v_cndmask_b32 v148, 0, v5, vcc
  v_mov_b32 v149, v148
  v_mov_b32 v150, v148
  v_mov_b32 v151, v148
  v_mov_b32 v84, 0
  v_mov_b32 v85, 0
  v_mov_b32 v86, 0
  v_mov_b32 v87, 0
  v_mov_b32 v88, 0
  v_mov_b32 v89, 0
  v_mov_b32 v90, 0
  v_mov_b32 v91, 0
  v_mov_b32 v92, 0
  v_mov_b32 v93, 0
  v_mov_b32 v94, 0
  v_mov_b32 v95, 0
  v_mov_b32 v96, 0
  v_mov_b32 v97, 0
  v_mov_b32 v98, 0
  v_mov_b32 v99, 0
  v_mov_b32 v152, 0
  v_mov_b32 v153, 0
  v_mov_b32 v154, 0
  v_mov_b32 v155, 0
  v_mov_b32 v160, 0
  v_mov_b32 v161, 0
  v_mov_b32 v162, 0
  v_mov_b32 v163, 0
  s_mov_b32 s34, 65536
  v_add_u32 v164, s32, v16
  v_add_u32 v165, s33, v16
  s_mov_b64 s[62:63], exec
  s_mov_b64 exec, 255
  buffer_load_dword v145, v144, s[72:75], s76 offen
  s_mov_b64 exec, s[62:63]
  s_add_u32 s76, s76, 8192
  s_barrier
  ds_read_b128 v[52:55], v164 offset:0
  ds_read_b128 v[56:59], v164 offset:1024
  ds_read_b128 v[60:63], v164 offset:2048
  ds_read_b128 v[64:67], v164 offset:3072
  ds_read_b128 v[68:71], v164 offset:16384
  ds_read_b128 v[72:75], v164 offset:17408
  v_mov_b32 v76, 0
  v_mov_b32 v77, 0
  v_mov_b32 v78, 0
  v_mov_b32 v79, 0
  v_mov_b32 v80, 0
  v_mov_b32 v81, 0
  v_mov_b32 v82, 0
  v_mov_b32 v83, 0
  s_waitcnt lgkmcnt(4)
  v_mfma_f32_32x32x16_bf16 v[20:35], v[52:55], v[8:11], v[100:115]
  v_mfma_f32_32x32x16_bf16 v[20:35], v[56:59], v[12:15], v[20:35]
  s_nop 7
  v_add_u32 v166, 65536, v16
  s_waitcnt lgkmcnt(0)
  v_mfma_f32_32x32x16_bf16 v[36:51], v[60:63], v[8:11], v[100:115]
  ds_read_b128 v[52:55], v164 offset:4096
  ds_read_b128 v[56:59], v164 offset:5120
  v_exp_f32 v20, v20
  v_exp_f32 v21, v21
  v_exp_f32 v22, v22
  v_exp_f32 v23, v23
  v_mfma_f32_32x32x16_bf16 v[84:99], v[80:83], v[160:163], v[84:99]
  v_cvt_pk_bf16_f32 v156, v20, v21
  v_cvt_pk_bf16_f32 v157, v22, v23
  v_exp_f32 v24, v24
  v_exp_f32 v25, v25
  v_exp_f32 v26, v26
  v_mfma_f32_16x16x32_bf16 v[152:155], v[148:151], v[160:163], v[152:155]
  ds_read_b128 v[76:79], v164 offset:18432
  ds_read_b128 v[80:83], v164 offset:19456
  v_exp_f32 v27, v27
  v_cvt_pk_bf16_f32 v158, v24, v25
  v_cvt_pk_bf16_f32 v159, v26, v27
  v_mfma_f32_32x32x16_bf16 v[36:51], v[64:67], v[12:15], v[36:51]
  v_exp_f32 v28, v28
  v_exp_f32 v29, v29
  v_exp_f32 v30, v30
  v_mfma_f32_32x32x16_bf16 v[84:99], v[68:71], v[156:159], v[84:99]
  v_exp_f32 v31, v31
  v_cvt_pk_bf16_f32 v160, v28, v29
  v_cvt_pk_bf16_f32 v161, v30, v31
  v_exp_f32 v32, v32
  v_exp_f32 v33, v33
  v_mfma_f32_16x16x32_bf16 v[152:155], v[148:151], v[156:159], v[152:155]
  v_exp_f32 v34, v34
  v_exp_f32 v35, v35
  v_cvt_pk_bf16_f32 v162, v32, v33
  v_cvt_pk_bf16_f32 v163, v34, v35
  s_waitcnt lgkmcnt(0)
  v_mfma_f32_32x32x16_bf16 v[20:35], v[52:55], v[8:11], v[100:115]
  ds_read_b128 v[60:63], v164 offset:6144
  ds_read_b128 v[64:67], v164 offset:7168
  v_exp_f32 v36, v36
  v_exp_f32 v37, v37
  v_exp_f32 v38, v38
  v_exp_f32 v39, v39
  v_mfma_f32_32x32x16_bf16 v[84:99], v[72:75], v[160:163], v[84:99]
  v_cvt_pk_bf16_f32 v156, v36, v37
  v_cvt_pk_bf16_f32 v157, v38, v39
  v_exp_f32 v40, v40
  v_exp_f32 v41, v41
  v_exp_f32 v42, v42
  v_mfma_f32_16x16x32_bf16 v[152:155], v[148:151], v[160:163], v[152:155]
  ds_read_b128 v[68:71], v164 offset:20480
  ds_read_b128 v[72:75], v164 offset:21504
  v_exp_f32 v43, v43
  v_cvt_pk_bf16_f32 v158, v40, v41
  v_cvt_pk_bf16_f32 v159, v42, v43
  v_mfma_f32_32x32x16_bf16 v[20:35], v[56:59], v[12:15], v[20:35]
  v_exp_f32 v44, v44
  v_exp_f32 v45, v45
  v_exp_f32 v46, v46
  v_mfma_f32_32x32x16_bf16 v[84:99], v[76:79], v[156:159], v[84:99]
  v_exp_f32 v47, v47
  v_cvt_pk_bf16_f32 v160, v44, v45
  v_cvt_pk_bf16_f32 v161, v46, v47
  v_exp_f32 v48, v48
  v_exp_f32 v49, v49
  v_mfma_f32_16x16x32_bf16 v[152:155], v[148:151], v[156:159], v[152:155]
  v_exp_f32 v50, v50
  v_exp_f32 v51, v51
  v_cvt_pk_bf16_f32 v162, v48, v49
  v_cvt_pk_bf16_f32 v163, v50, v51
  s_waitcnt lgkmcnt(0)
  v_mfma_f32_32x32x16_bf16 v[36:51], v[60:63], v[8:11], v[100:115]
  ds_read_b128 v[52:55], v164 offset:8192
  ds_read_b128 v[56:59], v164 offset:9216
  v_exp_f32 v20, v20
  v_exp_f32 v21, v21
  v_exp_f32 v22, v22
  v_exp_f32 v23, v23
  v_mfma_f32_32x32x16_bf16 v[84:99], v[80:83], v[160:163], v[84:99]
  v_cvt_pk_bf16_f32 v156, v20, v21
  v_cvt_pk_bf16_f32 v157, v22, v23
  v_exp_f32 v24, v24
  v_exp_f32 v25, v25
  v_exp_f32 v26, v26
  v_mfma_f32_16x16x32_bf16 v[152:155], v[148:151], v[160:163], v[152:155]
  ds_read_b128 v[76:79], v164 offset:22528
  ds_read_b128 v[80:83], v164 offset:23552
  v_exp_f32 v27, v27
  v_cvt_pk_bf16_f32 v158, v24, v25
  v_cvt_pk_bf16_f32 v159, v26, v27
  v_mfma_f32_32x32x16_bf16 v[36:51], v[64:67], v[12:15], v[36:51]
  v_exp_f32 v28, v28
  v_exp_f32 v29, v29
  v_exp_f32 v30, v30
  v_mfma_f32_32x32x16_bf16 v[84:99], v[68:71], v[156:159], v[84:99]
  v_exp_f32 v31, v31
  v_cvt_pk_bf16_f32 v160, v28, v29
  v_cvt_pk_bf16_f32 v161, v30, v31
  v_exp_f32 v32, v32
  v_exp_f32 v33, v33
  v_mfma_f32_16x16x32_bf16 v[152:155], v[148:151], v[156:159], v[152:155]
  v_exp_f32 v34, v34
  v_exp_f32 v35, v35
  v_cvt_pk_bf16_f32 v162, v32, v33
  v_cvt_pk_bf16_f32 v163, v34, v35
  s_waitcnt lgkmcnt(0)
  v_mfma_f32_32x32x16_bf16 v[20:35], v[52:55], v[8:11], v[100:115]
  ds_read_b128 v[60:63], v164 offset:10240
  ds_read_b128 v[64:67], v164 offset:11264
  v_exp_f32 v36, v36
  v_exp_f32 v37, v37
  v_exp_f32 v38, v38
  v_exp_f32 v39, v39
  v_mfma_f32_32x32x16_bf16 v[84:99], v[72:75], v[160:163], v[84:99]
  v_cvt_pk_bf16_f32 v156, v36, v37
  v_cvt_pk_bf16_f32 v157, v38, v39
  v_exp_f32 v40, v40
  v_exp_f32 v41, v41
  v_exp_f32 v42, v42
  v_mfma_f32_16x16x32_bf16 v[152:155], v[148:151], v[160:163], v[152:155]
  ds_read_b128 v[68:71], v164 offset:24576
  ds_read_b128 v[72:75], v164 offset:25600
  v_exp_f32 v43, v43
  v_cvt_pk_bf16_f32 v158, v40, v41
  v_cvt_pk_bf16_f32 v159, v42, v43
  v_mfma_f32_32x32x16_bf16 v[20:35], v[56:59], v[12:15], v[20:35]
  v_exp_f32 v44, v44
  v_exp_f32 v45, v45
  v_exp_f32 v46, v46
  v_mfma_f32_32x32x16_bf16 v[84:99], v[76:79], v[156:159], v[84:99]
  v_exp_f32 v47, v47
  v_cvt_pk_bf16_f32 v160, v44, v45
  v_cvt_pk_bf16_f32 v161, v46, v47
  v_exp_f32 v48, v48
  v_exp_f32 v49, v49
  v_mfma_f32_16x16x32_bf16 v[152:155], v[148:151], v[156:159], v[152:155]
  v_exp_f32 v50, v50
  v_exp_f32 v51, v51
  v_cvt_pk_bf16_f32 v162, v48, v49
  v_cvt_pk_bf16_f32 v163, v50, v51
  s_waitcnt lgkmcnt(0)
  v_mfma_f32_32x32x16_bf16 v[36:51], v[60:63], v[8:11], v[100:115]
  ds_read_b128 v[52:55], v164 offset:12288
  ds_read_b128 v[56:59], v164 offset:13312
  v_exp_f32 v20, v20
  v_exp_f32 v21, v21
  v_exp_f32 v22, v22
  v_exp_f32 v23, v23
  v_mfma_f32_32x32x16_bf16 v[84:99], v[80:83], v[160:163], v[84:99]
  v_cvt_pk_bf16_f32 v156, v20, v21
  v_cvt_pk_bf16_f32 v157, v22, v23
  v_exp_f32 v24, v24
  v_exp_f32 v25, v25
  v_exp_f32 v26, v26
  v_mfma_f32_16x16x32_bf16 v[152:155], v[148:151], v[160:163], v[152:155]
  ds_read_b128 v[76:79], v164 offset:26624
  ds_read_b128 v[80:83], v164 offset:27648
  v_exp_f32 v27, v27
  v_cvt_pk_bf16_f32 v158, v24, v25
  v_cvt_pk_bf16_f32 v159, v26, v27
  v_mfma_f32_32x32x16_bf16 v[36:51], v[64:67], v[12:15], v[36:51]
  v_exp_f32 v28, v28
  v_exp_f32 v29, v29
  v_exp_f32 v30, v30
  v_mfma_f32_32x32x16_bf16 v[84:99], v[68:71], v[156:159], v[84:99]
  v_exp_f32 v31, v31
  v_cvt_pk_bf16_f32 v160, v28, v29
  v_cvt_pk_bf16_f32 v161, v30, v31
  v_exp_f32 v32, v32
  v_exp_f32 v33, v33
  v_mfma_f32_16x16x32_bf16 v[152:155], v[148:151], v[156:159], v[152:155]
  v_exp_f32 v34, v34
  v_exp_f32 v35, v35
  v_cvt_pk_bf16_f32 v162, v32, v33
  v_cvt_pk_bf16_f32 v163, v34, v35
  s_waitcnt lgkmcnt(0)
  v_mfma_f32_32x32x16_bf16 v[20:35], v[52:55], v[8:11], v[100:115]
  ds_read_b128 v[60:63], v164 offset:14336
  ds_read_b128 v[64:67], v164 offset:15360
  v_exp_f32 v36, v36
  v_exp_f32 v37, v37
  v_exp_f32 v38, v38
  v_exp_f32 v39, v39
  v_mfma_f32_32x32x16_bf16 v[84:99], v[72:75], v[160:163], v[84:99]
  v_cvt_pk_bf16_f32 v156, v36, v37
  v_cvt_pk_bf16_f32 v157, v38, v39
  v_exp_f32 v40, v40
  v_exp_f32 v41, v41
  v_exp_f32 v42, v42
  v_mfma_f32_16x16x32_bf16 v[152:155], v[148:151], v[160:163], v[152:155]
  ds_read_b128 v[68:71], v164 offset:28672
  ds_read_b128 v[72:75], v164 offset:29696
  v_exp_f32 v43, v43
  v_cvt_pk_bf16_f32 v158, v40, v41
  v_cvt_pk_bf16_f32 v159, v42, v43
  v_mfma_f32_32x32x16_bf16 v[20:35], v[56:59], v[12:15], v[20:35]
  v_exp_f32 v44, v44
  v_exp_f32 v45, v45
  v_exp_f32 v46, v46
  v_mfma_f32_32x32x16_bf16 v[84:99], v[76:79], v[156:159], v[84:99]
  v_exp_f32 v47, v47
  v_cvt_pk_bf16_f32 v160, v44, v45
  v_cvt_pk_bf16_f32 v161, v46, v47
  v_exp_f32 v48, v48
  v_exp_f32 v49, v49
  v_mfma_f32_16x16x32_bf16 v[152:155], v[148:151], v[156:159], v[152:155]
  v_exp_f32 v50, v50
  v_exp_f32 v51, v51
  v_cvt_pk_bf16_f32 v162, v48, v49
  v_cvt_pk_bf16_f32 v163, v50, v51
  s_waitcnt lgkmcnt(0)
  s_waitcnt vmcnt(5)
  s_barrier
  s_add_u32 s29, s16, 65536
  s_mov_b32 s30, 32768
  v_mfma_f32_32x32x16_bf16 v[36:51], v[60:63], v[8:11], v[100:115]
  ds_read_b128 v[52:55], v165 offset:0
  ds_read_b128 v[56:59], v165 offset:1024
  v_exp_f32 v20, v20
  v_exp_f32 v21, v21
  v_exp_f32 v22, v22
  v_exp_f32 v23, v23
  v_mfma_f32_32x32x16_bf16 v[84:99], v[80:83], v[160:163], v[84:99]
  v_cvt_pk_bf16_f32 v156, v20, v21
  v_cvt_pk_bf16_f32 v157, v22, v23
  v_exp_f32 v24, v24
  v_exp_f32 v25, v25
  v_exp_f32 v26, v26
  v_mfma_f32_16x16x32_bf16 v[152:155], v[148:151], v[160:163], v[152:155]
  ds_read_b128 v[76:79], v164 offset:30720
  ds_read_b128 v[80:83], v164 offset:31744
  v_exp_f32 v27, v27
  v_cvt_pk_bf16_f32 v158, v24, v25
  v_cvt_pk_bf16_f32 v159, v26, v27
  s_add_u32 m0, s29, 0
  s_nop 0
  buffer_load_dwordx4 v17, s[20:23], s30 offen lds
  v_mfma_f32_32x32x16_bf16 v[36:51], v[64:67], v[12:15], v[36:51]
  v_exp_f32 v28, v28
  v_exp_f32 v29, v29
  v_exp_f32 v30, v30
  v_mfma_f32_32x32x16_bf16 v[84:99], v[68:71], v[156:159], v[84:99]
  v_exp_f32 v31, v31
  v_cvt_pk_bf16_f32 v160, v28, v29
  v_cvt_pk_bf16_f32 v161, v30, v31
  v_exp_f32 v32, v32
  v_exp_f32 v33, v33
  v_mfma_f32_16x16x32_bf16 v[152:155], v[148:151], v[156:159], v[152:155]
  v_exp_f32 v34, v34
  v_exp_f32 v35, v35
  v_cvt_pk_bf16_f32 v162, v32, v33
  v_cvt_pk_bf16_f32 v163, v34, v35
  s_waitcnt lgkmcnt(0)
  v_mfma_f32_32x32x16_bf16 v[20:35], v[52:55], v[8:11], v[100:115]
  ds_read_b128 v[60:63], v165 offset:2048
  ds_read_b128 v[64:67], v165 offset:3072
  v_exp_f32 v36, v36
  v_exp_f32 v37, v37
  v_exp_f32 v38, v38
  v_exp_f32 v39, v39
  v_mfma_f32_32x32x16_bf16 v[84:99], v[72:75], v[160:163], v[84:99]
  v_cvt_pk_bf16_f32 v156, v36, v37
  v_cvt_pk_bf16_f32 v157, v38, v39
  v_exp_f32 v40, v40
  v_exp_f32 v41, v41
  v_exp_f32 v42, v42
  v_mfma_f32_16x16x32_bf16 v[152:155], v[148:151], v[160:163], v[152:155]
  ds_read_b128 v[68:71], v165 offset:16384
  ds_read_b128 v[72:75], v165 offset:17408
  v_exp_f32 v43, v43
  v_cvt_pk_bf16_f32 v158, v40, v41
  v_cvt_pk_bf16_f32 v159, v42, v43
  s_add_u32 m0, s29, 8192
  s_add_u32 s3, s30, 8192
  buffer_load_dwordx4 v17, s[20:23], s3 offen lds
  v_mfma_f32_32x32x16_bf16 v[20:35], v[56:59], v[12:15], v[20:35]
  v_exp_f32 v44, v44
  v_exp_f32 v45, v45
  v_exp_f32 v46, v46
  v_mfma_f32_32x32x16_bf16 v[84:99], v[76:79], v[156:159], v[84:99]
  v_exp_f32 v47, v47
  v_cvt_pk_bf16_f32 v160, v44, v45
  v_cvt_pk_bf16_f32 v161, v46, v47
  v_exp_f32 v48, v48
  v_exp_f32 v49, v49
  v_mfma_f32_16x16x32_bf16 v[152:155], v[148:151], v[156:159], v[152:155]
  v_exp_f32 v50, v50
  v_exp_f32 v51, v51
  v_cvt_pk_bf16_f32 v162, v48, v49
  v_cvt_pk_bf16_f32 v163, v50, v51
  s_waitcnt lgkmcnt(0)
  v_mfma_f32_32x32x16_bf16 v[36:51], v[60:63], v[8:11], v[100:115]
  ds_read_b128 v[52:55], v165 offset:4096
  ds_read_b128 v[56:59], v165 offset:5120
  v_exp_f32 v20, v20
  v_exp_f32 v21, v21
  v_exp_f32 v22, v22
  v_exp_f32 v23, v23
  v_mfma_f32_32x32x16_bf16 v[84:99], v[80:83], v[160:163], v[84:99]
  v_cvt_pk_bf16_f32 v156, v20, v21
  v_cvt_pk_bf16_f32 v157, v22, v23
  v_exp_f32 v24, v24
  v_exp_f32 v25, v25
  v_exp_f32 v26, v26
  v_mfma_f32_16x16x32_bf16 v[152:155], v[148:151], v[160:163], v[152:155]
  ds_read_b128 v[76:79], v165 offset:18432
  ds_read_b128 v[80:83], v165 offset:19456
  v_exp_f32 v27, v27
  v_cvt_pk_bf16_f32 v158, v24, v25
  v_cvt_pk_bf16_f32 v159, v26, v27
  s_add_u32 m0, s29, 16384
  s_nop 0
  buffer_load_dwordx4 v17, s[24:27], s30 offen lds
  v_mfma_f32_32x32x16_bf16 v[36:51], v[64:67], v[12:15], v[36:51]
  v_exp_f32 v28, v28
  v_exp_f32 v29, v29
  v_exp_f32 v30, v30
  v_mfma_f32_32x32x16_bf16 v[84:99], v[68:71], v[156:159], v[84:99]
  v_exp_f32 v31, v31
  v_cvt_pk_bf16_f32 v160, v28, v29
  v_cvt_pk_bf16_f32 v161, v30, v31
  v_exp_f32 v32, v32
  v_exp_f32 v33, v33
  v_mfma_f32_16x16x32_bf16 v[152:155], v[148:151], v[156:159], v[152:155]
  v_exp_f32 v34, v34
  v_exp_f32 v35, v35
  v_cvt_pk_bf16_f32 v162, v32, v33
  v_cvt_pk_bf16_f32 v163, v34, v35
  s_waitcnt lgkmcnt(0)
  v_mfma_f32_32x32x16_bf16 v[20:35], v[52:55], v[8:11], v[100:115]
  ds_read_b128 v[60:63], v165 offset:6144
  ds_read_b128 v[64:67], v165 offset:7168
  v_exp_f32 v36, v36
  v_exp_f32 v37, v37
  v_exp_f32 v38, v38
  v_exp_f32 v39, v39
  v_mfma_f32_32x32x16_bf16 v[84:99], v[72:75], v[160:163], v[84:99]
  v_cvt_pk_bf16_f32 v156, v36, v37
  v_cvt_pk_bf16_f32 v157, v38, v39
  v_exp_f32 v40, v40
  v_exp_f32 v41, v41
  v_exp_f32 v42, v42
  v_mfma_f32_16x16x32_bf16 v[152:155], v[148:151], v[160:163], v[152:155]
  ds_read_b128 v[68:71], v165 offset:20480
  ds_read_b128 v[72:75], v165 offset:21504
  v_exp_f32 v43, v43
  v_cvt_pk_bf16_f32 v158, v40, v41
  v_cvt_pk_bf16_f32 v159, v42, v43
  s_add_u32 m0, s29, 24576
  s_add_u32 s3, s30, 8192
  buffer_load_dwordx4 v17, s[24:27], s3 offen lds
  v_mfma_f32_32x32x16_bf16 v[20:35], v[56:59], v[12:15], v[20:35]
  v_exp_f32 v44, v44
  v_exp_f32 v45, v45
  v_exp_f32 v46, v46
  v_mfma_f32_32x32x16_bf16 v[84:99], v[76:79], v[156:159], v[84:99]
  v_exp_f32 v47, v47
  v_cvt_pk_bf16_f32 v160, v44, v45
  v_cvt_pk_bf16_f32 v161, v46, v47
  v_exp_f32 v48, v48
  v_exp_f32 v49, v49
  v_mfma_f32_16x16x32_bf16 v[152:155], v[148:151], v[156:159], v[152:155]
  v_exp_f32 v50, v50
  v_exp_f32 v51, v51
  v_cvt_pk_bf16_f32 v162, v48, v49
  v_cvt_pk_bf16_f32 v163, v50, v51
  s_waitcnt lgkmcnt(0)
  v_mfma_f32_32x32x16_bf16 v[36:51], v[60:63], v[8:11], v[100:115]
  ds_read_b128 v[52:55], v165 offset:8192
  ds_read_b128 v[56:59], v165 offset:9216
  v_exp_f32 v20, v20
  v_exp_f32 v21, v21
  v_exp_f32 v22, v22
  v_exp_f32 v23, v23
  v_mfma_f32_32x32x16_bf16 v[84:99], v[80:83], v[160:163], v[84:99]
  v_cvt_pk_bf16_f32 v156, v20, v21
  v_cvt_pk_bf16_f32 v157, v22, v23
  v_exp_f32 v24, v24
  v_exp_f32 v25, v25
  v_exp_f32 v26, v26
  v_mfma_f32_16x16x32_bf16 v[152:155], v[148:151], v[160:163], v[152:155]
  ds_read_b128 v[76:79], v165 offset:22528
  ds_read_b128 v[80:83], v165 offset:23552
  v_exp_f32 v27, v27
  v_cvt_pk_bf16_f32 v158, v24, v25
  v_cvt_pk_bf16_f32 v159, v26, v27
  s_add_u32 s3, s60, 0x0
  buffer_load_dwordx4 v[124:127], v120, s[52:55], s3 offen
  v_mfma_f32_32x32x16_bf16 v[36:51], v[64:67], v[12:15], v[36:51]
  v_exp_f32 v28, v28
  v_exp_f32 v29, v29
  v_exp_f32 v30, v30
  v_mfma_f32_32x32x16_bf16 v[84:99], v[68:71], v[156:159], v[84:99]
  v_exp_f32 v31, v31
  v_cvt_pk_bf16_f32 v160, v28, v29
  v_cvt_pk_bf16_f32 v161, v30, v31
  v_exp_f32 v32, v32
  v_exp_f32 v33, v33
  v_mfma_f32_16x16x32_bf16 v[152:155], v[148:151], v[156:159], v[152:155]
  v_exp_f32 v34, v34
  v_exp_f32 v35, v35
  v_cvt_pk_bf16_f32 v162, v32, v33
  v_cvt_pk_bf16_f32 v163, v34, v35
  s_waitcnt lgkmcnt(0)
  v_mfma_f32_32x32x16_bf16 v[20:35], v[52:55], v[8:11], v[100:115]
  ds_read_b128 v[60:63], v165 offset:10240
  ds_read_b128 v[64:67], v165 offset:11264
  v_exp_f32 v36, v36
  v_exp_f32 v37, v37
  v_exp_f32 v38, v38
  v_exp_f32 v39, v39
  v_mfma_f32_32x32x16_bf16 v[84:99], v[72:75], v[160:163], v[84:99]
  v_cvt_pk_bf16_f32 v156, v36, v37
  v_cvt_pk_bf16_f32 v157, v38, v39
  v_exp_f32 v40, v40
  v_exp_f32 v41, v41
  v_exp_f32 v42, v42
  v_mfma_f32_16x16x32_bf16 v[152:155], v[148:151], v[160:163], v[152:155]
  ds_read_b128 v[68:71], v165 offset:24576
  ds_read_b128 v[72:75], v165 offset:25600
  v_exp_f32 v43, v43
  v_cvt_pk_bf16_f32 v158, v40, v41
  v_cvt_pk_bf16_f32 v159, v42, v43
  s_mov_b64 s[62:63], exec
  s_mov_b64 exec, 255
  buffer_load_dword v145, v144, s[72:75], s76 offen
  s_mov_b64 exec, s[62:63]
  s_add_u32 s76, s76, 8192
  v_mfma_f32_32x32x16_bf16 v[20:35], v[56:59], v[12:15], v[20:35]
  v_exp_f32 v44, v44
  v_exp_f32 v45, v45
  v_exp_f32 v46, v46
  v_mfma_f32_32x32x16_bf16 v[84:99], v[76:79], v[156:159], v[84:99]
  v_exp_f32 v47, v47
  v_cvt_pk_bf16_f32 v160, v44, v45
  v_cvt_pk_bf16_f32 v161, v46, v47
  v_exp_f32 v48, v48
  v_exp_f32 v49, v49
  v_mfma_f32_16x16x32_bf16 v[152:155], v[148:151], v[156:159], v[152:155]
  v_exp_f32 v50, v50
  v_exp_f32 v51, v51
  v_cvt_pk_bf16_f32 v162, v48, v49
  v_cvt_pk_bf16_f32 v163, v50, v51
  s_waitcnt lgkmcnt(0)
  v_mfma_f32_32x32x16_bf16 v[36:51], v[60:63], v[8:11], v[100:115]
  ds_read_b128 v[52:55], v165 offset:12288
  ds_read_b128 v[56:59], v165 offset:13312
  v_exp_f32 v20, v20
  v_exp_f32 v21, v21
  v_exp_f32 v22, v22
  v_exp_f32 v23, v23
  v_mfma_f32_32x32x16_bf16 v[84:99], v[80:83], v[160:163], v[84:99]
  v_cvt_pk_bf16_f32 v156, v20, v21
  v_cvt_pk_bf16_f32 v157, v22, v23
  v_exp_f32 v24, v24
  v_exp_f32 v25, v25
  v_exp_f32 v26, v26
  v_mfma_f32_16x16x32_bf16 v[152:155], v[148:151], v[160:163], v[152:155]
  ds_read_b128 v[76:79], v165 offset:26624
  ds_read_b128 v[80:83], v165 offset:27648
  v_exp_f32 v27, v27
  v_cvt_pk_bf16_f32 v158, v24, v25
  v_cvt_pk_bf16_f32 v159, v26, v27
  v_mfma_f32_32x32x16_bf16 v[36:51], v[64:67], v[12:15], v[36:51]
  v_exp_f32 v28, v28
  v_exp_f32 v29, v29
  v_exp_f32 v30, v30
  v_mfma_f32_32x32x16_bf16 v[84:99], v[68:71], v[156:159], v[84:99]
  v_exp_f32 v31, v31
  v_cvt_pk_bf16_f32 v160, v28, v29
  v_cvt_pk_bf16_f32 v161, v30, v31
  v_exp_f32 v32, v32
  v_exp_f32 v33, v33
  v_mfma_f32_16x16x32_bf16 v[152:155], v[148:151], v[156:159], v[152:155]
  v_exp_f32 v34, v34
  v_exp_f32 v35, v35
  v_cvt_pk_bf16_f32 v162, v32, v33
  v_cvt_pk_bf16_f32 v163, v34, v35
  s_waitcnt lgkmcnt(0)
  v_mfma_f32_32x32x16_bf16 v[20:35], v[52:55], v[8:11], v[100:115]
  ds_read_b128 v[60:63], v165 offset:14336
  ds_read_b128 v[64:67], v165 offset:15360
  v_exp_f32 v36, v36
  v_exp_f32 v37, v37
  v_exp_f32 v38, v38
  v_exp_f32 v39, v39
  v_mfma_f32_32x32x16_bf16 v[84:99], v[72:75], v[160:163], v[84:99]
  v_cvt_pk_bf16_f32 v156, v36, v37
  v_cvt_pk_bf16_f32 v157, v38, v39
  v_exp_f32 v40, v40
  v_exp_f32 v41, v41
  v_exp_f32 v42, v42
  v_mfma_f32_16x16x32_bf16 v[152:155], v[148:151], v[160:163], v[152:155]
  ds_read_b128 v[68:71], v165 offset:28672
  ds_read_b128 v[72:75], v165 offset:29696
  v_exp_f32 v43, v43
  v_cvt_pk_bf16_f32 v158, v40, v41
  v_cvt_pk_bf16_f32 v159, v42, v43
  v_mfma_f32_32x32x16_bf16 v[20:35], v[56:59], v[12:15], v[20:35]
  v_exp_f32 v44, v44
  v_exp_f32 v45, v45
  v_exp_f32 v46, v46
  v_mfma_f32_32x32x16_bf16 v[84:99], v[76:79], v[156:159], v[84:99]
  v_exp_f32 v47, v47
  v_cvt_pk_bf16_f32 v160, v44, v45
  v_cvt_pk_bf16_f32 v161, v46, v47
  v_exp_f32 v48, v48
  v_exp_f32 v49, v49
  v_mfma_f32_16x16x32_bf16 v[152:155], v[148:151], v[156:159], v[152:155]
  v_exp_f32 v50, v50
  v_exp_f32 v51, v51
  v_cvt_pk_bf16_f32 v162, v48, v49
  v_cvt_pk_bf16_f32 v163, v50, v51
  s_waitcnt lgkmcnt(0)
  s_waitcnt vmcnt(2)
  s_barrier
  s_add_u32 s29, s16, 0
  s_mov_b32 s30, 49152
  v_mfma_f32_32x32x16_bf16 v[36:51], v[60:63], v[8:11], v[100:115]
  ds_read_b128 v[52:55], v166 offset:0
  ds_read_b128 v[56:59], v166 offset:1024
  v_exp_f32 v20, v20
  v_exp_f32 v21, v21
  v_exp_f32 v22, v22
  v_exp_f32 v23, v23
  v_mfma_f32_32x32x16_bf16 v[84:99], v[80:83], v[160:163], v[84:99]
  v_cvt_pk_bf16_f32 v156, v20, v21
  v_cvt_pk_bf16_f32 v157, v22, v23
  v_exp_f32 v24, v24
  v_exp_f32 v25, v25
  v_exp_f32 v26, v26
  v_mfma_f32_16x16x32_bf16 v[152:155], v[148:151], v[160:163], v[152:155]
  ds_read_b128 v[76:79], v165 offset:30720
  ds_read_b128 v[80:83], v165 offset:31744
  v_exp_f32 v27, v27
  v_cvt_pk_bf16_f32 v158, v24, v25
  v_cvt_pk_bf16_f32 v159, v26, v27
  s_add_u32 m0, s29, 0
  s_nop 0
  buffer_load_dwordx4 v17, s[20:23], s30 offen lds
  v_mfma_f32_32x32x16_bf16 v[36:51], v[64:67], v[12:15], v[36:51]
  v_exp_f32 v28, v28
  v_exp_f32 v29, v29
  v_exp_f32 v30, v30
  v_mfma_f32_32x32x16_bf16 v[84:99], v[68:71], v[156:159], v[84:99]
  v_exp_f32 v31, v31
  v_cvt_pk_bf16_f32 v160, v28, v29
  v_cvt_pk_bf16_f32 v161, v30, v31
  v_exp_f32 v32, v32
  v_exp_f32 v33, v33
  v_mfma_f32_16x16x32_bf16 v[152:155], v[148:151], v[156:159], v[152:155]
  v_exp_f32 v34, v34
  v_exp_f32 v35, v35
  v_cvt_pk_bf16_f32 v162, v32, v33
  v_cvt_pk_bf16_f32 v163, v34, v35
  s_waitcnt lgkmcnt(0)
  v_mfma_f32_32x32x16_bf16 v[20:35], v[52:55], v[8:11], v[100:115]
  ds_read_b128 v[60:63], v166 offset:2048
  ds_read_b128 v[64:67], v166 offset:3072
  v_exp_f32 v36, v36
  v_exp_f32 v37, v37
  v_exp_f32 v38, v38
  v_exp_f32 v39, v39
  v_mfma_f32_32x32x16_bf16 v[84:99], v[72:75], v[160:163], v[84:99]
  v_cvt_pk_bf16_f32 v156, v36, v37
  v_cvt_pk_bf16_f32 v157, v38, v39
  v_exp_f32 v40, v40
  v_exp_f32 v41, v41
  v_exp_f32 v42, v42
  v_mfma_f32_16x16x32_bf16 v[152:155], v[148:151], v[160:163], v[152:155]
  ds_read_b128 v[68:71], v166 offset:16384
  ds_read_b128 v[72:75], v166 offset:17408
  v_exp_f32 v43, v43
  v_cvt_pk_bf16_f32 v158, v40, v41
  v_cvt_pk_bf16_f32 v159, v42, v43
  s_add_u32 m0, s29, 8192
  s_add_u32 s3, s30, 8192
  buffer_load_dwordx4 v17, s[20:23], s3 offen lds
  v_mfma_f32_32x32x16_bf16 v[20:35], v[56:59], v[12:15], v[20:35]
  v_exp_f32 v44, v44
  v_exp_f32 v45, v45
  v_exp_f32 v46, v46
  v_mfma_f32_32x32x16_bf16 v[84:99], v[76:79], v[156:159], v[84:99]
  v_exp_f32 v47, v47
  v_cvt_pk_bf16_f32 v160, v44, v45
  v_cvt_pk_bf16_f32 v161, v46, v47
  v_exp_f32 v48, v48
  v_exp_f32 v49, v49
  v_mfma_f32_16x16x32_bf16 v[152:155], v[148:151], v[156:159], v[152:155]
  v_exp_f32 v50, v50
  v_exp_f32 v51, v51
  v_cvt_pk_bf16_f32 v162, v48, v49
  v_cvt_pk_bf16_f32 v163, v50, v51
  s_waitcnt lgkmcnt(0)
  v_mfma_f32_32x32x16_bf16 v[36:51], v[60:63], v[8:11], v[100:115]
  ds_read_b128 v[52:55], v166 offset:4096
  ds_read_b128 v[56:59], v166 offset:5120
  v_exp_f32 v20, v20
  v_exp_f32 v21, v21
  v_exp_f32 v22, v22
  v_exp_f32 v23, v23
  v_mfma_f32_32x32x16_bf16 v[84:99], v[80:83], v[160:163], v[84:99]
  v_cvt_pk_bf16_f32 v156, v20, v21
  v_cvt_pk_bf16_f32 v157, v22, v23
  v_exp_f32 v24, v24
  v_exp_f32 v25, v25
  v_exp_f32 v26, v26
  v_mfma_f32_16x16x32_bf16 v[152:155], v[148:151], v[160:163], v[152:155]
  ds_read_b128 v[76:79], v166 offset:18432
  ds_read_b128 v[80:83], v166 offset:19456
  v_exp_f32 v27, v27
  v_cvt_pk_bf16_f32 v158, v24, v25
  v_cvt_pk_bf16_f32 v159, v26, v27
  s_add_u32 m0, s29, 16384
  s_nop 0
  buffer_load_dwordx4 v17, s[24:27], s30 offen lds
  v_mfma_f32_32x32x16_bf16 v[36:51], v[64:67], v[12:15], v[36:51]
  v_exp_f32 v28, v28
  v_exp_f32 v29, v29
  v_exp_f32 v30, v30
  v_mfma_f32_32x32x16_bf16 v[84:99], v[68:71], v[156:159], v[84:99]
  v_exp_f32 v31, v31
  v_cvt_pk_bf16_f32 v160, v28, v29
  v_cvt_pk_bf16_f32 v161, v30, v31
  v_exp_f32 v32, v32
  v_exp_f32 v33, v33
  v_mfma_f32_16x16x32_bf16 v[152:155], v[148:151], v[156:159], v[152:155]
  v_exp_f32 v34, v34
  v_exp_f32 v35, v35
  v_cvt_pk_bf16_f32 v162, v32, v33
  v_cvt_pk_bf16_f32 v163, v34, v35
  s_waitcnt lgkmcnt(0)
  v_mfma_f32_32x32x16_bf16 v[20:35], v[52:55], v[8:11], v[100:115]
  ds_read_b128 v[60:63], v166 offset:6144
  ds_read_b128 v[64:67], v166 offset:7168
  v_exp_f32 v36, v36
  v_exp_f32 v37, v37
  v_exp_f32 v38, v38
  v_exp_f32 v39, v39
  v_mfma_f32_32x32x16_bf16 v[84:99], v[72:75], v[160:163], v[84:99]
  v_cvt_pk_bf16_f32 v156, v36, v37
  v_cvt_pk_bf16_f32 v157, v38, v39
  v_exp_f32 v40, v40
  v_exp_f32 v41, v41
  v_exp_f32 v42, v42
  v_mfma_f32_16x16x32_bf16 v[152:155], v[148:151], v[160:163], v[152:155]
  ds_read_b128 v[68:71], v166 offset:20480
  ds_read_b128 v[72:75], v166 offset:21504
  v_exp_f32 v43, v43
  v_cvt_pk_bf16_f32 v158, v40, v41
  v_cvt_pk_bf16_f32 v159, v42, v43
  s_add_u32 m0, s29, 24576
  s_add_u32 s3, s30, 8192
  buffer_load_dwordx4 v17, s[24:27], s3 offen lds
  v_mfma_f32_32x32x16_bf16 v[20:35], v[56:59], v[12:15], v[20:35]
  v_exp_f32 v44, v44
  v_exp_f32 v45, v45
  v_exp_f32 v46, v46
  v_mfma_f32_32x32x16_bf16 v[84:99], v[76:79], v[156:159], v[84:99]
  v_exp_f32 v47, v47
  v_cvt_pk_bf16_f32 v160, v44, v45
  v_cvt_pk_bf16_f32 v161, v46, v47
  v_exp_f32 v48, v48
  v_exp_f32 v49, v49
  v_mfma_f32_16x16x32_bf16 v[152:155], v[148:151], v[156:159], v[152:155]
  v_exp_f32 v50, v50
  v_exp_f32 v51, v51
  v_cvt_pk_bf16_f32 v162, v48, v49
  v_cvt_pk_bf16_f32 v163, v50, v51
  s_waitcnt lgkmcnt(0)
  v_mfma_f32_32x32x16_bf16 v[36:51], v[60:63], v[8:11], v[100:115]
  ds_read_b128 v[52:55], v166 offset:8192
  ds_read_b128 v[56:59], v166 offset:9216
  v_exp_f32 v20, v20
  v_exp_f32 v21, v21
  v_exp_f32 v22, v22
  v_exp_f32 v23, v23
  v_mfma_f32_32x32x16_bf16 v[84:99], v[80:83], v[160:163], v[84:99]
  v_cvt_pk_bf16_f32 v156, v20, v21
  v_cvt_pk_bf16_f32 v157, v22, v23
  v_exp_f32 v24, v24
  v_exp_f32 v25, v25
  v_exp_f32 v26, v26
  v_mfma_f32_16x16x32_bf16 v[152:155], v[148:151], v[160:163], v[152:155]
  ds_read_b128 v[76:79], v166 offset:22528
  ds_read_b128 v[80:83], v166 offset:23552
  v_exp_f32 v27, v27
  v_cvt_pk_bf16_f32 v158, v24, v25
  v_cvt_pk_bf16_f32 v159, v26, v27
  s_add_u32 s3, s60, 0xc0000
  buffer_load_dwordx4 v[128:131], v120, s[52:55], s3 offen
  v_mfma_f32_32x32x16_bf16 v[36:51], v[64:67], v[12:15], v[36:51]
  v_exp_f32 v28, v28
  v_exp_f32 v29, v29
  v_exp_f32 v30, v30
  v_mfma_f32_32x32x16_bf16 v[84:99], v[68:71], v[156:159], v[84:99]
  v_exp_f32 v31, v31
  v_cvt_pk_bf16_f32 v160, v28, v29
  v_cvt_pk_bf16_f32 v161, v30, v31
  v_exp_f32 v32, v32
  v_exp_f32 v33, v33
  v_mfma_f32_16x16x32_bf16 v[152:155], v[148:151], v[156:159], v[152:155]
  v_exp_f32 v34, v34
  v_exp_f32 v35, v35
  v_cvt_pk_bf16_f32 v162, v32, v33
  v_cvt_pk_bf16_f32 v163, v34, v35
  s_waitcnt lgkmcnt(0)
  v_mfma_f32_32x32x16_bf16 v[20:35], v[52:55], v[8:11], v[100:115]
  ds_read_b128 v[60:63], v166 offset:10240
  ds_read_b128 v[64:67], v166 offset:11264
  v_exp_f32 v36, v36
  v_exp_f32 v37, v37
  v_exp_f32 v38, v38
  v_exp_f32 v39, v39
  v_mfma_f32_32x32x16_bf16 v[84:99], v[72:75], v[160:163], v[84:99]
  v_cvt_pk_bf16_f32 v156, v36, v37
  v_cvt_pk_bf16_f32 v157, v38, v39
  v_exp_f32 v40, v40
  v_exp_f32 v41, v41
  v_exp_f32 v42, v42
  v_mfma_f32_16x16x32_bf16 v[152:155], v[148:151], v[160:163], v[152:155]
  ds_read_b128 v[68:71], v166 offset:24576
  ds_read_b128 v[72:75], v166 offset:25600
  v_exp_f32 v43, v43
  v_cvt_pk_bf16_f32 v158, v40, v41
  v_cvt_pk_bf16_f32 v159, v42, v43
  s_mov_b64 s[62:63], exec
  s_mov_b64 exec, 255
  buffer_load_dword v145, v144, s[72:75], s76 offen
  s_mov_b64 exec, s[62:63]
  s_add_u32 s76, s76, 8192
  v_mfma_f32_32x32x16_bf16 v[20:35], v[56:59], v[12:15], v[20:35]
  v_exp_f32 v44, v44
  v_exp_f32 v45, v45
  v_exp_f32 v46, v46
  v_mfma_f32_32x32x16_bf16 v[84:99], v[76:79], v[156:159], v[84:99]
  v_exp_f32 v47, v47
  v_cvt_pk_bf16_f32 v160, v44, v45
  v_cvt_pk_bf16_f32 v161, v46, v47
  v_exp_f32 v48, v48
  v_exp_f32 v49, v49
  v_mfma_f32_16x16x32_bf16 v[152:155], v[148:151], v[156:159], v[152:155]
  v_exp_f32 v50, v50
  v_exp_f32 v51, v51
  v_cvt_pk_bf16_f32 v162, v48, v49
  v_cvt_pk_bf16_f32 v163, v50, v51
  s_waitcnt lgkmcnt(0)
  v_mfma_f32_32x32x16_bf16 v[36:51], v[60:63], v[8:11], v[100:115]
  ds_read_b128 v[52:55], v166 offset:12288
  ds_read_b128 v[56:59], v166 offset:13312
  v_exp_f32 v20, v20
  v_exp_f32 v21, v21
  v_exp_f32 v22, v22
  v_exp_f32 v23, v23
  v_mfma_f32_32x32x16_bf16 v[84:99], v[80:83], v[160:163], v[84:99]
  v_cvt_pk_bf16_f32 v156, v20, v21
  v_cvt_pk_bf16_f32 v157, v22, v23
  v_exp_f32 v24, v24
  v_exp_f32 v25, v25
  v_exp_f32 v26, v26
  v_mfma_f32_16x16x32_bf16 v[152:155], v[148:151], v[160:163], v[152:155]
  ds_read_b128 v[76:79], v166 offset:26624
  ds_read_b128 v[80:83], v166 offset:27648
  v_exp_f32 v27, v27
  v_cvt_pk_bf16_f32 v158, v24, v25
  v_cvt_pk_bf16_f32 v159, v26, v27
  v_mfma_f32_32x32x16_bf16 v[36:51], v[64:67], v[12:15], v[36:51]
  v_exp_f32 v28, v28
  v_exp_f32 v29, v29
  v_exp_f32 v30, v30
  v_mfma_f32_32x32x16_bf16 v[84:99], v[68:71], v[156:159], v[84:99]
  v_exp_f32 v31, v31
  v_cvt_pk_bf16_f32 v160, v28, v29
  v_cvt_pk_bf16_f32 v161, v30, v31
  v_exp_f32 v32, v32
  v_exp_f32 v33, v33
  v_mfma_f32_16x16x32_bf16 v[152:155], v[148:151], v[156:159], v[152:155]
  v_exp_f32 v34, v34
  v_exp_f32 v35, v35
  v_cvt_pk_bf16_f32 v162, v32, v33
  v_cvt_pk_bf16_f32 v163, v34, v35
  s_waitcnt lgkmcnt(0)
  v_mfma_f32_32x32x16_bf16 v[20:35], v[52:55], v[8:11], v[100:115]
  ds_read_b128 v[60:63], v166 offset:14336
  ds_read_b128 v[64:67], v166 offset:15360
  v_exp_f32 v36, v36
  v_exp_f32 v37, v37
  v_exp_f32 v38, v38
  v_exp_f32 v39, v39
  v_mfma_f32_32x32x16_bf16 v[84:99], v[72:75], v[160:163], v[84:99]
  v_cvt_pk_bf16_f32 v156, v36, v37
  v_cvt_pk_bf16_f32 v157, v38, v39
  v_exp_f32 v40, v40
  v_exp_f32 v41, v41
  v_exp_f32 v42, v42
  v_mfma_f32_16x16x32_bf16 v[152:155], v[148:151], v[160:163], v[152:155]
  ds_read_b128 v[68:71], v166 offset:28672
  ds_read_b128 v[72:75], v166 offset:29696
  v_exp_f32 v43, v43
  v_cvt_pk_bf16_f32 v158, v40, v41
  v_cvt_pk_bf16_f32 v159, v42, v43
  v_mfma_f32_32x32x16_bf16 v[20:35], v[56:59], v[12:15], v[20:35]
  v_exp_f32 v44, v44
  v_exp_f32 v45, v45
  v_exp_f32 v46, v46
  v_mfma_f32_32x32x16_bf16 v[84:99], v[76:79], v[156:159], v[84:99]
  v_exp_f32 v47, v47
  v_cvt_pk_bf16_f32 v160, v44, v45
  v_cvt_pk_bf16_f32 v161, v46, v47
  v_exp_f32 v48, v48
  v_exp_f32 v49, v49
  v_mfma_f32_16x16x32_bf16 v[152:155], v[148:151], v[156:159], v[152:155]
  v_exp_f32 v50, v50
  v_exp_f32 v51, v51
  v_cvt_pk_bf16_f32 v162, v48, v49
  v_cvt_pk_bf16_f32 v163, v50, v51
  s_waitcnt lgkmcnt(0)
  s_waitcnt vmcnt(2)
  s_barrier
  s_add_u32 s29, s16, 32768
  s_mov_b32 s30, 65536
  v_mfma_f32_32x32x16_bf16 v[36:51], v[60:63], v[8:11], v[100:115]
  ds_read_b128 v[52:55], v164 offset:0
  ds_read_b128 v[56:59], v164 offset:1024
  v_exp_f32 v20, v20
  v_exp_f32 v21, v21
  v_exp_f32 v22, v22
  v_exp_f32 v23, v23
  v_mfma_f32_32x32x16_bf16 v[84:99], v[80:83], v[160:163], v[84:99]
  v_cvt_pk_bf16_f32 v156, v20, v21
  v_cvt_pk_bf16_f32 v157, v22, v23
  v_exp_f32 v24, v24
  v_exp_f32 v25, v25
  v_exp_f32 v26, v26
  v_mfma_f32_16x16x32_bf16 v[152:155], v[148:151], v[160:163], v[152:155]
  ds_read_b128 v[76:79], v166 offset:30720
  ds_read_b128 v[80:83], v166 offset:31744
  v_exp_f32 v27, v27
  v_cvt_pk_bf16_f32 v158, v24, v25
  v_cvt_pk_bf16_f32 v159, v26, v27
  s_add_u32 m0, s29, 0
  s_nop 0
  buffer_load_dwordx4 v17, s[20:23], s30 offen lds
  v_mfma_f32_32x32x16_bf16 v[36:51], v[64:67], v[12:15], v[36:51]
  v_exp_f32 v28, v28
  v_exp_f32 v29, v29
  v_exp_f32 v30, v30
  v_mfma_f32_32x32x16_bf16 v[84:99], v[68:71], v[156:159], v[84:99]
  v_exp_f32 v31, v31
  v_cvt_pk_bf16_f32 v160, v28, v29
  v_cvt_pk_bf16_f32 v161, v30, v31
  v_exp_f32 v32, v32
  v_exp_f32 v33, v33
  v_mfma_f32_16x16x32_bf16 v[152:155], v[148:151], v[156:159], v[152:155]
  v_exp_f32 v34, v34
  v_exp_f32 v35, v35
  v_cvt_pk_bf16_f32 v162, v32, v33
  v_cvt_pk_bf16_f32 v163, v34, v35
  s_waitcnt lgkmcnt(0)
  v_mfma_f32_32x32x16_bf16 v[20:35], v[52:55], v[8:11], v[100:115]
  ds_read_b128 v[60:63], v164 offset:2048
  ds_read_b128 v[64:67], v164 offset:3072
  v_exp_f32 v36, v36
  v_exp_f32 v37, v37
  v_exp_f32 v38, v38
  v_exp_f32 v39, v39
  v_mfma_f32_32x32x16_bf16 v[84:99], v[72:75], v[160:163], v[84:99]
  v_cvt_pk_bf16_f32 v156, v36, v37
  v_cvt_pk_bf16_f32 v157, v38, v39
  v_exp_f32 v40, v40
  v_exp_f32 v41, v41
  v_exp_f32 v42, v42
  v_mfma_f32_16x16x32_bf16 v[152:155], v[148:151], v[160:163], v[152:155]
  ds_read_b128 v[68:71], v164 offset:16384
  ds_read_b128 v[72:75], v164 offset:17408
  v_exp_f32 v43, v43
  v_cvt_pk_bf16_f32 v158, v40, v41
  v_cvt_pk_bf16_f32 v159, v42, v43
  s_add_u32 m0, s29, 8192
  s_add_u32 s3, s30, 8192
  buffer_load_dwordx4 v17, s[20:23], s3 offen lds
  v_mfma_f32_32x32x16_bf16 v[20:35], v[56:59], v[12:15], v[20:35]
  v_exp_f32 v44, v44
  v_exp_f32 v45, v45
  v_exp_f32 v46, v46
  v_mfma_f32_32x32x16_bf16 v[84:99], v[76:79], v[156:159], v[84:99]
  v_exp_f32 v47, v47
  v_cvt_pk_bf16_f32 v160, v44, v45
  v_cvt_pk_bf16_f32 v161, v46, v47
  v_exp_f32 v48, v48
  v_exp_f32 v49, v49
  v_mfma_f32_16x16x32_bf16 v[152:155], v[148:151], v[156:159], v[152:155]
  v_exp_f32 v50, v50
  v_exp_f32 v51, v51
  v_cvt_pk_bf16_f32 v162, v48, v49
  v_cvt_pk_bf16_f32 v163, v50, v51
  s_waitcnt lgkmcnt(0)
  v_mfma_f32_32x32x16_bf16 v[36:51], v[60:63], v[8:11], v[100:115]
  ds_read_b128 v[52:55], v164 offset:4096
  ds_read_b128 v[56:59], v164 offset:5120
  v_exp_f32 v20, v20
  v_exp_f32 v21, v21
  v_exp_f32 v22, v22
  v_exp_f32 v23, v23
  v_mfma_f32_32x32x16_bf16 v[84:99], v[80:83], v[160:163], v[84:99]
  v_cvt_pk_bf16_f32 v156, v20, v21
  v_cvt_pk_bf16_f32 v157, v22, v23
  v_exp_f32 v24, v24
  v_exp_f32 v25, v25
  v_exp_f32 v26, v26
  v_mfma_f32_16x16x32_bf16 v[152:155], v[148:151], v[160:163], v[152:155]
  ds_read_b128 v[76:79], v164 offset:18432
  ds_read_b128 v[80:83], v164 offset:19456
  v_exp_f32 v27, v27
  v_cvt_pk_bf16_f32 v158, v24, v25
  v_cvt_pk_bf16_f32 v159, v26, v27
  s_add_u32 m0, s29, 16384
  s_nop 0
  buffer_load_dwordx4 v17, s[24:27], s30 offen lds
  v_mfma_f32_32x32x16_bf16 v[36:51], v[64:67], v[12:15], v[36:51]
  v_exp_f32 v28, v28
  v_exp_f32 v29, v29
  v_exp_f32 v30, v30
  v_mfma_f32_32x32x16_bf16 v[84:99], v[68:71], v[156:159], v[84:99]
  v_exp_f32 v31, v31
  v_cvt_pk_bf16_f32 v160, v28, v29
  v_cvt_pk_bf16_f32 v161, v30, v31
  v_exp_f32 v32, v32
  v_exp_f32 v33, v33
  v_mfma_f32_16x16x32_bf16 v[152:155], v[148:151], v[156:159], v[152:155]
  v_exp_f32 v34, v34
  v_exp_f32 v35, v35
  v_cvt_pk_bf16_f32 v162, v32, v33
  v_cvt_pk_bf16_f32 v163, v34, v35
  s_waitcnt lgkmcnt(0)
  v_mfma_f32_32x32x16_bf16 v[20:35], v[52:55], v[8:11], v[100:115]
  ds_read_b128 v[60:63], v164 offset:6144
  ds_read_b128 v[64:67], v164 offset:7168
  v_exp_f32 v36, v36
  v_exp_f32 v37, v37
  v_exp_f32 v38, v38
  v_exp_f32 v39, v39
  v_mfma_f32_32x32x16_bf16 v[84:99], v[72:75], v[160:163], v[84:99]
  v_cvt_pk_bf16_f32 v156, v36, v37
  v_cvt_pk_bf16_f32 v157, v38, v39
  v_exp_f32 v40, v40
  v_exp_f32 v41, v41
  v_exp_f32 v42, v42
  v_mfma_f32_16x16x32_bf16 v[152:155], v[148:151], v[160:163], v[152:155]
  ds_read_b128 v[68:71], v164 offset:20480
  ds_read_b128 v[72:75], v164 offset:21504
  v_exp_f32 v43, v43
  v_cvt_pk_bf16_f32 v158, v40, v41
  v_cvt_pk_bf16_f32 v159, v42, v43
  s_add_u32 m0, s29, 24576
  s_add_u32 s3, s30, 8192
  buffer_load_dwordx4 v17, s[24:27], s3 offen lds
  v_mfma_f32_32x32x16_bf16 v[20:35], v[56:59], v[12:15], v[20:35]
  v_exp_f32 v44, v44
  v_exp_f32 v45, v45
  v_exp_f32 v46, v46
  v_mfma_f32_32x32x16_bf16 v[84:99], v[76:79], v[156:159], v[84:99]
  v_exp_f32 v47, v47
  v_cvt_pk_bf16_f32 v160, v44, v45
  v_cvt_pk_bf16_f32 v161, v46, v47
  v_exp_f32 v48, v48
  v_exp_f32 v49, v49
  v_mfma_f32_16x16x32_bf16 v[152:155], v[148:151], v[156:159], v[152:155]
  v_exp_f32 v50, v50
  v_exp_f32 v51, v51
  v_cvt_pk_bf16_f32 v162, v48, v49
  v_cvt_pk_bf16_f32 v163, v50, v51
  s_waitcnt lgkmcnt(0)
  v_mfma_f32_32x32x16_bf16 v[36:51], v[60:63], v[8:11], v[100:115]
  ds_read_b128 v[52:55], v164 offset:8192
  ds_read_b128 v[56:59], v164 offset:9216
  v_exp_f32 v20, v20
  v_exp_f32 v21, v21
  v_exp_f32 v22, v22
  v_exp_f32 v23, v23
  v_mfma_f32_32x32x16_bf16 v[84:99], v[80:83], v[160:163], v[84:99]
  v_cvt_pk_bf16_f32 v156, v20, v21
  v_cvt_pk_bf16_f32 v157, v22, v23
  v_exp_f32 v24, v24
  v_exp_f32 v25, v25
  v_exp_f32 v26, v26
  v_mfma_f32_16x16x32_bf16 v[152:155], v[148:151], v[160:163], v[152:155]
  ds_read_b128 v[76:79], v164 offset:22528
  ds_read_b128 v[80:83], v164 offset:23552
  v_exp_f32 v27, v27
  v_cvt_pk_bf16_f32 v158, v24, v25
  v_cvt_pk_bf16_f32 v159, v26, v27
  s_add_u32 s3, s60, 0x180000
  buffer_load_dwordx4 v[132:135], v120, s[52:55], s3 offen
  v_mfma_f32_32x32x16_bf16 v[36:51], v[64:67], v[12:15], v[36:51]
  v_exp_f32 v28, v28
  v_exp_f32 v29, v29
  v_exp_f32 v30, v30
  v_mfma_f32_32x32x16_bf16 v[84:99], v[68:71], v[156:159], v[84:99]
  v_exp_f32 v31, v31
  v_cvt_pk_bf16_f32 v160, v28, v29
  v_cvt_pk_bf16_f32 v161, v30, v31
  v_exp_f32 v32, v32
  v_exp_f32 v33, v33
  v_mfma_f32_16x16x32_bf16 v[152:155], v[148:151], v[156:159], v[152:155]
  v_exp_f32 v34, v34
  v_exp_f32 v35, v35
  v_cvt_pk_bf16_f32 v162, v32, v33
  v_cvt_pk_bf16_f32 v163, v34, v35
  s_waitcnt lgkmcnt(0)
  v_mfma_f32_32x32x16_bf16 v[20:35], v[52:55], v[8:11], v[100:115]
  ds_read_b128 v[60:63], v164 offset:10240
  ds_read_b128 v[64:67], v164 offset:11264
  v_exp_f32 v36, v36
  v_exp_f32 v37, v37
  v_exp_f32 v38, v38
  v_exp_f32 v39, v39
  v_mfma_f32_32x32x16_bf16 v[84:99], v[72:75], v[160:163], v[84:99]
  v_cvt_pk_bf16_f32 v156, v36, v37
  v_cvt_pk_bf16_f32 v157, v38, v39
  v_exp_f32 v40, v40
  v_exp_f32 v41, v41
  v_exp_f32 v42, v42
  v_mfma_f32_16x16x32_bf16 v[152:155], v[148:151], v[160:163], v[152:155]
  ds_read_b128 v[68:71], v164 offset:24576
  ds_read_b128 v[72:75], v164 offset:25600
  v_exp_f32 v43, v43
  v_cvt_pk_bf16_f32 v158, v40, v41
  v_cvt_pk_bf16_f32 v159, v42, v43
  s_mov_b64 s[62:63], exec
  s_mov_b64 exec, 255
  buffer_load_dword v145, v144, s[72:75], s76 offen
  s_mov_b64 exec, s[62:63]
  s_add_u32 s76, s76, 8192
  v_mfma_f32_32x32x16_bf16 v[20:35], v[56:59], v[12:15], v[20:35]
  v_exp_f32 v44, v44
  v_exp_f32 v45, v45
  v_exp_f32 v46, v46
  v_mfma_f32_32x32x16_bf16 v[84:99], v[76:79], v[156:159], v[84:99]
  v_exp_f32 v47, v47
  v_cvt_pk_bf16_f32 v160, v44, v45
  v_cvt_pk_bf16_f32 v161, v46, v47
  v_exp_f32 v48, v48
  v_exp_f32 v49, v49
  v_mfma_f32_16x16x32_bf16 v[152:155], v[148:151], v[156:159], v[152:155]
  v_exp_f32 v50, v50
  v_exp_f32 v51, v51
  v_cvt_pk_bf16_f32 v162, v48, v49
  v_cvt_pk_bf16_f32 v163, v50, v51
  s_waitcnt lgkmcnt(0)
  v_mfma_f32_32x32x16_bf16 v[36:51], v[60:63], v[8:11], v[100:115]
  ds_read_b128 v[52:55], v164 offset:12288
  ds_read_b128 v[56:59], v164 offset:13312
  v_exp_f32 v20, v20
  v_exp_f32 v21, v21
  v_exp_f32 v22, v22
  v_exp_f32 v23, v23
  v_mfma_f32_32x32x16_bf16 v[84:99], v[80:83], v[160:163], v[84:99]
  v_cvt_pk_bf16_f32 v156, v20, v21
  v_cvt_pk_bf16_f32 v157, v22, v23
  v_exp_f32 v24, v24
  v_exp_f32 v25, v25
  v_exp_f32 v26, v26
  v_mfma_f32_16x16x32_bf16 v[152:155], v[148:151], v[160:163], v[152:155]
  ds_read_b128 v[76:79], v164 offset:26624
  ds_read_b128 v[80:83], v164 offset:27648
  v_exp_f32 v27, v27
  v_cvt_pk_bf16_f32 v158, v24, v25
  v_cvt_pk_bf16_f32 v159, v26, v27
  v_mfma_f32_32x32x16_bf16 v[36:51], v[64:67], v[12:15], v[36:51]
  v_exp_f32 v28, v28
  v_exp_f32 v29, v29
  v_exp_f32 v30, v30
  v_mfma_f32_32x32x16_bf16 v[84:99], v[68:71], v[156:159], v[84:99]
  v_exp_f32 v31, v31
  v_cvt_pk_bf16_f32 v160, v28, v29
  v_cvt_pk_bf16_f32 v161, v30, v31
  v_exp_f32 v32, v32
  v_exp_f32 v33, v33
  v_mfma_f32_16x16x32_bf16 v[152:155], v[148:151], v[156:159], v[152:155]
  v_exp_f32 v34, v34
  v_exp_f32 v35, v35
  v_cvt_pk_bf16_f32 v162, v32, v33
  v_cvt_pk_bf16_f32 v163, v34, v35
  s_waitcnt lgkmcnt(0)
  v_mfma_f32_32x32x16_bf16 v[20:35], v[52:55], v[8:11], v[100:115]
  ds_read_b128 v[60:63], v164 offset:14336
  ds_read_b128 v[64:67], v164 offset:15360
  v_exp_f32 v36, v36
  v_exp_f32 v37, v37
  v_exp_f32 v38, v38
  v_exp_f32 v39, v39
  v_mfma_f32_32x32x16_bf16 v[84:99], v[72:75], v[160:163], v[84:99]
  v_cvt_pk_bf16_f32 v156, v36, v37
  v_cvt_pk_bf16_f32 v157, v38, v39
  v_exp_f32 v40, v40
  v_exp_f32 v41, v41
  v_exp_f32 v42, v42
  v_mfma_f32_16x16x32_bf16 v[152:155], v[148:151], v[160:163], v[152:155]
  ds_read_b128 v[68:71], v164 offset:28672
  ds_read_b128 v[72:75], v164 offset:29696
  v_exp_f32 v43, v43
  v_cvt_pk_bf16_f32 v158, v40, v41
  v_cvt_pk_bf16_f32 v159, v42, v43
  v_mfma_f32_32x32x16_bf16 v[20:35], v[56:59], v[12:15], v[20:35]
  v_exp_f32 v44, v44
  v_exp_f32 v45, v45
  v_exp_f32 v46, v46
  v_mfma_f32_32x32x16_bf16 v[84:99], v[76:79], v[156:159], v[84:99]
  v_exp_f32 v47, v47
  v_cvt_pk_bf16_f32 v160, v44, v45
  v_cvt_pk_bf16_f32 v161, v46, v47
  v_exp_f32 v48, v48
  v_exp_f32 v49, v49
  v_mfma_f32_16x16x32_bf16 v[152:155], v[148:151], v[156:159], v[152:155]
  v_exp_f32 v50, v50
  v_exp_f32 v51, v51
  v_cvt_pk_bf16_f32 v162, v48, v49
  v_cvt_pk_bf16_f32 v163, v50, v51
  s_waitcnt lgkmcnt(0)
  s_waitcnt vmcnt(2)
  s_barrier
  s_add_u32 s29, s16, 65536
  s_mov_b32 s30, 81920
  v_mfma_f32_32x32x16_bf16 v[36:51], v[60:63], v[8:11], v[100:115]
  ds_read_b128 v[52:55], v165 offset:0
  ds_read_b128 v[56:59], v165 offset:1024
  v_exp_f32 v20, v20
  v_exp_f32 v21, v21
  v_exp_f32 v22, v22
  v_exp_f32 v23, v23
  v_mfma_f32_32x32x16_bf16 v[84:99], v[80:83], v[160:163], v[84:99]
  v_cvt_pk_bf16_f32 v156, v20, v21
  v_cvt_pk_bf16_f32 v157, v22, v23
  v_exp_f32 v24, v24
  v_exp_f32 v25, v25
  v_exp_f32 v26, v26
  v_mfma_f32_16x16x32_bf16 v[152:155], v[148:151], v[160:163], v[152:155]
  ds_read_b128 v[76:79], v164 offset:30720
  ds_read_b128 v[80:83], v164 offset:31744
  v_exp_f32 v27, v27
  v_cvt_pk_bf16_f32 v158, v24, v25
  v_cvt_pk_bf16_f32 v159, v26, v27
  s_add_u32 m0, s29, 0
  s_nop 0
  buffer_load_dwordx4 v17, s[20:23], s30 offen lds
  v_mfma_f32_32x32x16_bf16 v[36:51], v[64:67], v[12:15], v[36:51]
  v_exp_f32 v28, v28
  v_exp_f32 v29, v29
  v_exp_f32 v30, v30
  v_mfma_f32_32x32x16_bf16 v[84:99], v[68:71], v[156:159], v[84:99]
  v_exp_f32 v31, v31
  v_cvt_pk_bf16_f32 v160, v28, v29
  v_cvt_pk_bf16_f32 v161, v30, v31
  v_exp_f32 v32, v32
  v_exp_f32 v33, v33
  v_mfma_f32_16x16x32_bf16 v[152:155], v[148:151], v[156:159], v[152:155]
  v_exp_f32 v34, v34
  v_exp_f32 v35, v35
  v_cvt_pk_bf16_f32 v162, v32, v33
  v_cvt_pk_bf16_f32 v163, v34, v35
  s_waitcnt lgkmcnt(0)
  v_mfma_f32_32x32x16_bf16 v[20:35], v[52:55], v[8:11], v[100:115]
  ds_read_b128 v[60:63], v165 offset:2048
  ds_read_b128 v[64:67], v165 offset:3072
  v_exp_f32 v36, v36
  v_exp_f32 v37, v37
  v_exp_f32 v38, v38
  v_exp_f32 v39, v39
  v_mfma_f32_32x32x16_bf16 v[84:99], v[72:75], v[160:163], v[84:99]
  v_cvt_pk_bf16_f32 v156, v36, v37
  v_cvt_pk_bf16_f32 v157, v38, v39
  v_exp_f32 v40, v40
  v_exp_f32 v41, v41
  v_exp_f32 v42, v42
  v_mfma_f32_16x16x32_bf16 v[152:155], v[148:151], v[160:163], v[152:155]
  ds_read_b128 v[68:71], v165 offset:16384
  ds_read_b128 v[72:75], v165 offset:17408
  v_exp_f32 v43, v43
  v_cvt_pk_bf16_f32 v158, v40, v41
  v_cvt_pk_bf16_f32 v159, v42, v43
  s_add_u32 m0, s29, 8192
  s_add_u32 s3, s30, 8192
  buffer_load_dwordx4 v17, s[20:23], s3 offen lds
  v_mfma_f32_32x32x16_bf16 v[20:35], v[56:59], v[12:15], v[20:35]
  v_exp_f32 v44, v44
  v_exp_f32 v45, v45
  v_exp_f32 v46, v46
  v_mfma_f32_32x32x16_bf16 v[84:99], v[76:79], v[156:159], v[84:99]
  v_exp_f32 v47, v47
  v_cvt_pk_bf16_f32 v160, v44, v45
  v_cvt_pk_bf16_f32 v161, v46, v47
  v_exp_f32 v48, v48
  v_exp_f32 v49, v49
  v_mfma_f32_16x16x32_bf16 v[152:155], v[148:151], v[156:159], v[152:155]
  v_exp_f32 v50, v50
  v_exp_f32 v51, v51
  v_cvt_pk_bf16_f32 v162, v48, v49
  v_cvt_pk_bf16_f32 v163, v50, v51
  s_waitcnt lgkmcnt(0)
  v_mfma_f32_32x32x16_bf16 v[36:51], v[60:63], v[8:11], v[100:115]
  ds_read_b128 v[52:55], v165 offset:4096
  ds_read_b128 v[56:59], v165 offset:5120
  v_exp_f32 v20, v20
  v_exp_f32 v21, v21
  v_exp_f32 v22, v22
  v_exp_f32 v23, v23
  v_mfma_f32_32x32x16_bf16 v[84:99], v[80:83], v[160:163], v[84:99]
  v_cvt_pk_bf16_f32 v156, v20, v21
  v_cvt_pk_bf16_f32 v157, v22, v23
  v_exp_f32 v24, v24
  v_exp_f32 v25, v25
  v_exp_f32 v26, v26
  v_mfma_f32_16x16x32_bf16 v[152:155], v[148:151], v[160:163], v[152:155]
  ds_read_b128 v[76:79], v165 offset:18432
  ds_read_b128 v[80:83], v165 offset:19456
  v_exp_f32 v27, v27
  v_cvt_pk_bf16_f32 v158, v24, v25
  v_cvt_pk_bf16_f32 v159, v26, v27
  s_add_u32 m0, s29, 16384
  s_nop 0
  buffer_load_dwordx4 v17, s[24:27], s30 offen lds
  v_mfma_f32_32x32x16_bf16 v[36:51], v[64:67], v[12:15], v[36:51]
  v_exp_f32 v28, v28
  v_exp_f32 v29, v29
  v_exp_f32 v30, v30
  v_mfma_f32_32x32x16_bf16 v[84:99], v[68:71], v[156:159], v[84:99]
  v_exp_f32 v31, v31
  v_cvt_pk_bf16_f32 v160, v28, v29
  v_cvt_pk_bf16_f32 v161, v30, v31
  v_exp_f32 v32, v32
  v_exp_f32 v33, v33
  v_mfma_f32_16x16x32_bf16 v[152:155], v[148:151], v[156:159], v[152:155]
  v_exp_f32 v34, v34
  v_exp_f32 v35, v35
  v_cvt_pk_bf16_f32 v162, v32, v33
  v_cvt_pk_bf16_f32 v163, v34, v35
  s_waitcnt lgkmcnt(0)
  v_mfma_f32_32x32x16_bf16 v[20:35], v[52:55], v[8:11], v[100:115]
  ds_read_b128 v[60:63], v165 offset:6144
  ds_read_b128 v[64:67], v165 offset:7168
  v_exp_f32 v36, v36
  v_exp_f32 v37, v37
  v_exp_f32 v38, v38
  v_exp_f32 v39, v39
  v_mfma_f32_32x32x16_bf16 v[84:99], v[72:75], v[160:163], v[84:99]
  v_cvt_pk_bf16_f32 v156, v36, v37
  v_cvt_pk_bf16_f32 v157, v38, v39
  v_exp_f32 v40, v40
  v_exp_f32 v41, v41
  v_exp_f32 v42, v42
  v_mfma_f32_16x16x32_bf16 v[152:155], v[148:151], v[160:163], v[152:155]
  ds_read_b128 v[68:71], v165 offset:20480
  ds_read_b128 v[72:75], v165 offset:21504
  v_exp_f32 v43, v43
  v_cvt_pk_bf16_f32 v158, v40, v41
  v_cvt_pk_bf16_f32 v159, v42, v43
  s_add_u32 m0, s29, 24576
  s_add_u32 s3, s30, 8192
  buffer_load_dwordx4 v17, s[24:27], s3 offen lds
  v_mfma_f32_32x32x16_bf16 v[20:35], v[56:59], v[12:15], v[20:35]
  v_exp_f32 v44, v44
  v_exp_f32 v45, v45
  v_exp_f32 v46, v46
  v_mfma_f32_32x32x16_bf16 v[84:99], v[76:79], v[156:159], v[84:99]
  v_exp_f32 v47, v47
  v_cvt_pk_bf16_f32 v160, v44, v45
  v_cvt_pk_bf16_f32 v161, v46, v47
  v_exp_f32 v48, v48
  v_exp_f32 v49, v49
  v_mfma_f32_16x16x32_bf16 v[152:155], v[148:151], v[156:159], v[152:155]
  v_exp_f32 v50, v50
  v_exp_f32 v51, v51
  v_cvt_pk_bf16_f32 v162, v48, v49
  v_cvt_pk_bf16_f32 v163, v50, v51
  s_waitcnt lgkmcnt(0)
  v_mfma_f32_32x32x16_bf16 v[36:51], v[60:63], v[8:11], v[100:115]
  ds_read_b128 v[52:55], v165 offset:8192
  ds_read_b128 v[56:59], v165 offset:9216
  v_exp_f32 v20, v20
  v_exp_f32 v21, v21
  v_exp_f32 v22, v22
  v_exp_f32 v23, v23
  v_mfma_f32_32x32x16_bf16 v[84:99], v[80:83], v[160:163], v[84:99]
  v_cvt_pk_bf16_f32 v156, v20, v21
  v_cvt_pk_bf16_f32 v157, v22, v23
  v_exp_f32 v24, v24
  v_exp_f32 v25, v25
  v_exp_f32 v26, v26
  v_mfma_f32_16x16x32_bf16 v[152:155], v[148:151], v[160:163], v[152:155]
  ds_read_b128 v[76:79], v165 offset:22528
  ds_read_b128 v[80:83], v165 offset:23552
  v_exp_f32 v27, v27
  v_cvt_pk_bf16_f32 v158, v24, v25
  v_cvt_pk_bf16_f32 v159, v26, v27
  s_add_u32 s3, s60, 0x240000
  buffer_load_dwordx4 v[136:139], v120, s[52:55], s3 offen
  v_mfma_f32_32x32x16_bf16 v[36:51], v[64:67], v[12:15], v[36:51]
  v_exp_f32 v28, v28
  v_exp_f32 v29, v29
  v_exp_f32 v30, v30
  v_mfma_f32_32x32x16_bf16 v[84:99], v[68:71], v[156:159], v[84:99]
  v_exp_f32 v31, v31
  v_cvt_pk_bf16_f32 v160, v28, v29
  v_cvt_pk_bf16_f32 v161, v30, v31
  v_exp_f32 v32, v32
  v_exp_f32 v33, v33
  v_mfma_f32_16x16x32_bf16 v[152:155], v[148:151], v[156:159], v[152:155]
  v_exp_f32 v34, v34
  v_exp_f32 v35, v35
  v_cvt_pk_bf16_f32 v162, v32, v33
  v_cvt_pk_bf16_f32 v163, v34, v35
  s_waitcnt lgkmcnt(0)
  v_mfma_f32_32x32x16_bf16 v[20:35], v[52:55], v[8:11], v[100:115]
  ds_read_b128 v[60:63], v165 offset:10240
  ds_read_b128 v[64:67], v165 offset:11264
  v_exp_f32 v36, v36
  v_exp_f32 v37, v37
  v_exp_f32 v38, v38
  v_exp_f32 v39, v39
  v_mfma_f32_32x32x16_bf16 v[84:99], v[72:75], v[160:163], v[84:99]
  v_cvt_pk_bf16_f32 v156, v36, v37
  v_cvt_pk_bf16_f32 v157, v38, v39
  v_exp_f32 v40, v40
  v_exp_f32 v41, v41
  v_exp_f32 v42, v42
  v_mfma_f32_16x16x32_bf16 v[152:155], v[148:151], v[160:163], v[152:155]
  ds_read_b128 v[68:71], v165 offset:24576
  ds_read_b128 v[72:75], v165 offset:25600
  v_exp_f32 v43, v43
  v_cvt_pk_bf16_f32 v158, v40, v41
  v_cvt_pk_bf16_f32 v159, v42, v43
  s_mov_b64 s[62:63], exec
  s_mov_b64 exec, 255
  buffer_load_dword v145, v144, s[72:75], s76 offen
  s_mov_b64 exec, s[62:63]
  s_add_u32 s76, s76, 8192
  v_mfma_f32_32x32x16_bf16 v[20:35], v[56:59], v[12:15], v[20:35]
  v_exp_f32 v44, v44
  v_exp_f32 v45, v45
  v_exp_f32 v46, v46
  v_mfma_f32_32x32x16_bf16 v[84:99], v[76:79], v[156:159], v[84:99]
  v_exp_f32 v47, v47
  v_cvt_pk_bf16_f32 v160, v44, v45
  v_cvt_pk_bf16_f32 v161, v46, v47
  v_exp_f32 v48, v48
  v_exp_f32 v49, v49
  v_mfma_f32_16x16x32_bf16 v[152:155], v[148:151], v[156:159], v[152:155]
  v_exp_f32 v50, v50
  v_exp_f32 v51, v51
  v_cvt_pk_bf16_f32 v162, v48, v49
  v_cvt_pk_bf16_f32 v163, v50, v51
  s_waitcnt lgkmcnt(0)
  v_mfma_f32_32x32x16_bf16 v[36:51], v[60:63], v[8:11], v[100:115]
  ds_read_b128 v[52:55], v165 offset:12288
  ds_read_b128 v[56:59], v165 offset:13312
  v_exp_f32 v20, v20
  v_exp_f32 v21, v21
  v_exp_f32 v22, v22
  v_exp_f32 v23, v23
  v_mfma_f32_32x32x16_bf16 v[84:99], v[80:83], v[160:163], v[84:99]
  v_cvt_pk_bf16_f32 v156, v20, v21
  v_cvt_pk_bf16_f32 v157, v22, v23
  v_exp_f32 v24, v24
  v_exp_f32 v25, v25
  v_exp_f32 v26, v26
  v_mfma_f32_16x16x32_bf16 v[152:155], v[148:151], v[160:163], v[152:155]
  ds_read_b128 v[76:79], v165 offset:26624
  ds_read_b128 v[80:83], v165 offset:27648
  v_exp_f32 v27, v27
  v_cvt_pk_bf16_f32 v158, v24, v25
  v_cvt_pk_bf16_f32 v159, v26, v27
  v_mfma_f32_32x32x16_bf16 v[36:51], v[64:67], v[12:15], v[36:51]
  v_exp_f32 v28, v28
  v_exp_f32 v29, v29
  v_exp_f32 v30, v30
  v_mfma_f32_32x32x16_bf16 v[84:99], v[68:71], v[156:159], v[84:99]
  v_exp_f32 v31, v31
  v_cvt_pk_bf16_f32 v160, v28, v29
  v_cvt_pk_bf16_f32 v161, v30, v31
  v_exp_f32 v32, v32
  v_exp_f32 v33, v33
  v_mfma_f32_16x16x32_bf16 v[152:155], v[148:151], v[156:159], v[152:155]
  v_exp_f32 v34, v34
  v_exp_f32 v35, v35
  v_cvt_pk_bf16_f32 v162, v32, v33
  v_cvt_pk_bf16_f32 v163, v34, v35
  s_waitcnt lgkmcnt(0)
  v_mfma_f32_32x32x16_bf16 v[20:35], v[52:55], v[8:11], v[100:115]
  ds_read_b128 v[60:63], v165 offset:14336
  ds_read_b128 v[64:67], v165 offset:15360
  v_exp_f32 v36, v36
  v_exp_f32 v37, v37
  v_exp_f32 v38, v38
  v_exp_f32 v39, v39
  v_mfma_f32_32x32x16_bf16 v[84:99], v[72:75], v[160:163], v[84:99]
  v_cvt_pk_bf16_f32 v156, v36, v37
  v_cvt_pk_bf16_f32 v157, v38, v39
  v_exp_f32 v40, v40
  v_exp_f32 v41, v41
  v_exp_f32 v42, v42
  v_mfma_f32_16x16x32_bf16 v[152:155], v[148:151], v[160:163], v[152:155]
  ds_read_b128 v[68:71], v165 offset:28672
  ds_read_b128 v[72:75], v165 offset:29696
  v_exp_f32 v43, v43
  v_cvt_pk_bf16_f32 v158, v40, v41
  v_cvt_pk_bf16_f32 v159, v42, v43
  v_mfma_f32_32x32x16_bf16 v[20:35], v[56:59], v[12:15], v[20:35]
  v_exp_f32 v44, v44
  v_exp_f32 v45, v45
  v_exp_f32 v46, v46
  v_mfma_f32_32x32x16_bf16 v[84:99], v[76:79], v[156:159], v[84:99]
  v_exp_f32 v47, v47
  v_cvt_pk_bf16_f32 v160, v44, v45
  v_cvt_pk_bf16_f32 v161, v46, v47
  v_exp_f32 v48, v48
  v_exp_f32 v49, v49
  v_mfma_f32_16x16x32_bf16 v[152:155], v[148:151], v[156:159], v[152:155]
  v_exp_f32 v50, v50
  v_exp_f32 v51, v51
  v_cvt_pk_bf16_f32 v162, v48, v49
  v_cvt_pk_bf16_f32 v163, v50, v51
  s_waitcnt lgkmcnt(0)
  s_waitcnt vmcnt(2)
  s_barrier
  s_add_u32 s29, s16, 0
  s_mov_b32 s30, 98304
  v_mfma_f32_32x32x16_bf16 v[36:51], v[60:63], v[8:11], v[100:115]
  ds_read_b128 v[52:55], v166 offset:0
  ds_read_b128 v[56:59], v166 offset:1024
  v_exp_f32 v20, v20
  v_exp_f32 v21, v21
  v_exp_f32 v22, v22
  v_exp_f32 v23, v23
  v_mfma_f32_32x32x16_bf16 v[84:99], v[80:83], v[160:163], v[84:99]
  v_cvt_pk_bf16_f32 v156, v20, v21
  v_cvt_pk_bf16_f32 v157, v22, v23
  v_exp_f32 v24, v24
  v_exp_f32 v25, v25
  v_exp_f32 v26, v26
  v_mfma_f32_16x16x32_bf16 v[152:155], v[148:151], v[160:163], v[152:155]
  ds_read_b128 v[76:79], v165 offset:30720
  ds_read_b128 v[80:83], v165 offset:31744
  v_exp_f32 v27, v27
  v_cvt_pk_bf16_f32 v158, v24, v25
  v_cvt_pk_bf16_f32 v159, v26, v27
  s_add_u32 m0, s29, 0
  s_nop 0
  buffer_load_dwordx4 v17, s[20:23], s30 offen lds
  v_mfma_f32_32x32x16_bf16 v[36:51], v[64:67], v[12:15], v[36:51]
  v_exp_f32 v28, v28
  v_exp_f32 v29, v29
  v_exp_f32 v30, v30
  v_mfma_f32_32x32x16_bf16 v[84:99], v[68:71], v[156:159], v[84:99]
  v_exp_f32 v31, v31
  v_cvt_pk_bf16_f32 v160, v28, v29
  v_cvt_pk_bf16_f32 v161, v30, v31
  v_exp_f32 v32, v32
  v_exp_f32 v33, v33
  v_mfma_f32_16x16x32_bf16 v[152:155], v[148:151], v[156:159], v[152:155]
  v_exp_f32 v34, v34
  v_exp_f32 v35, v35
  v_cvt_pk_bf16_f32 v162, v32, v33
  v_cvt_pk_bf16_f32 v163, v34, v35
  s_waitcnt lgkmcnt(0)
  v_mfma_f32_32x32x16_bf16 v[20:35], v[52:55], v[8:11], v[100:115]
  ds_read_b128 v[60:63], v166 offset:2048
  ds_read_b128 v[64:67], v166 offset:3072
  v_exp_f32 v36, v36
  v_exp_f32 v37, v37
  v_exp_f32 v38, v38
  v_exp_f32 v39, v39
  v_mfma_f32_32x32x16_bf16 v[84:99], v[72:75], v[160:163], v[84:99]
  v_cvt_pk_bf16_f32 v156, v36, v37
  v_cvt_pk_bf16_f32 v157, v38, v39
  v_exp_f32 v40, v40
  v_exp_f32 v41, v41
  v_exp_f32 v42, v42
  v_mfma_f32_16x16x32_bf16 v[152:155], v[148:151], v[160:163], v[152:155]
  ds_read_b128 v[68:71], v166 offset:16384
  ds_read_b128 v[72:75], v166 offset:17408
  v_exp_f32 v43, v43
  v_cvt_pk_bf16_f32 v158, v40, v41
  v_cvt_pk_bf16_f32 v159, v42, v43
  s_add_u32 m0, s29, 8192
  s_add_u32 s3, s30, 8192
  buffer_load_dwordx4 v17, s[20:23], s3 offen lds
  v_mfma_f32_32x32x16_bf16 v[20:35], v[56:59], v[12:15], v[20:35]
  v_exp_f32 v44, v44
  v_exp_f32 v45, v45
  v_exp_f32 v46, v46
  v_mfma_f32_32x32x16_bf16 v[84:99], v[76:79], v[156:159], v[84:99]
  v_exp_f32 v47, v47
  v_cvt_pk_bf16_f32 v160, v44, v45
  v_cvt_pk_bf16_f32 v161, v46, v47
  v_exp_f32 v48, v48
  v_exp_f32 v49, v49
  v_mfma_f32_16x16x32_bf16 v[152:155], v[148:151], v[156:159], v[152:155]
  v_exp_f32 v50, v50
  v_exp_f32 v51, v51
  v_cvt_pk_bf16_f32 v162, v48, v49
  v_cvt_pk_bf16_f32 v163, v50, v51
  s_waitcnt lgkmcnt(0)
  v_mfma_f32_32x32x16_bf16 v[36:51], v[60:63], v[8:11], v[100:115]
  ds_read_b128 v[52:55], v166 offset:4096
  ds_read_b128 v[56:59], v166 offset:5120
  v_exp_f32 v20, v20
  v_exp_f32 v21, v21
  v_exp_f32 v22, v22
  v_exp_f32 v23, v23
  v_mfma_f32_32x32x16_bf16 v[84:99], v[80:83], v[160:163], v[84:99]
  v_cvt_pk_bf16_f32 v156, v20, v21
  v_cvt_pk_bf16_f32 v157, v22, v23
  v_exp_f32 v24, v24
  v_exp_f32 v25, v25
  v_exp_f32 v26, v26
  v_mfma_f32_16x16x32_bf16 v[152:155], v[148:151], v[160:163], v[152:155]
  ds_read_b128 v[76:79], v166 offset:18432
  ds_read_b128 v[80:83], v166 offset:19456
  v_exp_f32 v27, v27
  v_cvt_pk_bf16_f32 v158, v24, v25
  v_cvt_pk_bf16_f32 v159, v26, v27
  s_add_u32 m0, s29, 16384
  s_nop 0
  buffer_load_dwordx4 v17, s[24:27], s30 offen lds
  v_mfma_f32_32x32x16_bf16 v[36:51], v[64:67], v[12:15], v[36:51]
  v_exp_f32 v28, v28
  v_exp_f32 v29, v29
  v_exp_f32 v30, v30
  v_mfma_f32_32x32x16_bf16 v[84:99], v[68:71], v[156:159], v[84:99]
  v_exp_f32 v31, v31
  v_cvt_pk_bf16_f32 v160, v28, v29
  v_cvt_pk_bf16_f32 v161, v30, v31
  v_exp_f32 v32, v32
  v_exp_f32 v33, v33
  v_mfma_f32_16x16x32_bf16 v[152:155], v[148:151], v[156:159], v[152:155]
  v_exp_f32 v34, v34
  v_exp_f32 v35, v35
  v_cvt_pk_bf16_f32 v162, v32, v33
  v_cvt_pk_bf16_f32 v163, v34, v35
  s_waitcnt lgkmcnt(0)
  v_mfma_f32_32x32x16_bf16 v[20:35], v[52:55], v[8:11], v[100:115]
  ds_read_b128 v[60:63], v166 offset:6144
  ds_read_b128 v[64:67], v166 offset:7168
  v_exp_f32 v36, v36
  v_exp_f32 v37, v37
  v_exp_f32 v38, v38
  v_exp_f32 v39, v39
  v_mfma_f32_32x32x16_bf16 v[84:99], v[72:75], v[160:163], v[84:99]
  v_cvt_pk_bf16_f32 v156, v36, v37
  v_cvt_pk_bf16_f32 v157, v38, v39
  v_exp_f32 v40, v40
  v_exp_f32 v41, v41
  v_exp_f32 v42, v42
  v_mfma_f32_16x16x32_bf16 v[152:155], v[148:151], v[160:163], v[152:155]
  ds_read_b128 v[68:71], v166 offset:20480
  ds_read_b128 v[72:75], v166 offset:21504
  v_exp_f32 v43, v43
  v_cvt_pk_bf16_f32 v158, v40, v41
  v_cvt_pk_bf16_f32 v159, v42, v43
  s_add_u32 m0, s29, 24576
  s_add_u32 s3, s30, 8192
  buffer_load_dwordx4 v17, s[24:27], s3 offen lds
  v_mfma_f32_32x32x16_bf16 v[20:35], v[56:59], v[12:15], v[20:35]
  v_exp_f32 v44, v44
  v_exp_f32 v45, v45
  v_exp_f32 v46, v46
  v_mfma_f32_32x32x16_bf16 v[84:99], v[76:79], v[156:159], v[84:99]
  v_exp_f32 v47, v47
  v_cvt_pk_bf16_f32 v160, v44, v45
  v_cvt_pk_bf16_f32 v161, v46, v47
  v_exp_f32 v48, v48
  v_exp_f32 v49, v49
  v_mfma_f32_16x16x32_bf16 v[152:155], v[148:151], v[156:159], v[152:155]
  v_exp_f32 v50, v50
  v_exp_f32 v51, v51
  v_cvt_pk_bf16_f32 v162, v48, v49
  v_cvt_pk_bf16_f32 v163, v50, v51
  s_waitcnt lgkmcnt(0)
  v_mfma_f32_32x32x16_bf16 v[36:51], v[60:63], v[8:11], v[100:115]
  ds_read_b128 v[52:55], v166 offset:8192
  ds_read_b128 v[56:59], v166 offset:9216
  v_exp_f32 v20, v20
  v_exp_f32 v21, v21
  v_exp_f32 v22, v22
  v_exp_f32 v23, v23
  v_mfma_f32_32x32x16_bf16 v[84:99], v[80:83], v[160:163], v[84:99]
  v_cvt_pk_bf16_f32 v156, v20, v21
  v_cvt_pk_bf16_f32 v157, v22, v23
  v_exp_f32 v24, v24
  v_exp_f32 v25, v25
  v_exp_f32 v26, v26
  v_mfma_f32_16x16x32_bf16 v[152:155], v[148:151], v[160:163], v[152:155]
  ds_read_b128 v[76:79], v166 offset:22528
  ds_read_b128 v[80:83], v166 offset:23552
  v_exp_f32 v27, v27
  v_cvt_pk_bf16_f32 v158, v24, v25
  v_cvt_pk_bf16_f32 v159, v26, v27
  v_mfma_f32_32x32x16_bf16 v[36:51], v[64:67], v[12:15], v[36:51]
  v_exp_f32 v28, v28
  v_exp_f32 v29, v29
  v_exp_f32 v30, v30
  v_mfma_f32_32x32x16_bf16 v[84:99], v[68:71], v[156:159], v[84:99]
  v_exp_f32 v31, v31
  v_cvt_pk_bf16_f32 v160, v28, v29
  v_cvt_pk_bf16_f32 v161, v30, v31
  v_exp_f32 v32, v32
  v_exp_f32 v33, v33
  v_mfma_f32_16x16x32_bf16 v[152:155], v[148:151], v[156:159], v[152:155]
  v_exp_f32 v34, v34
  v_exp_f32 v35, v35
  v_cvt_pk_bf16_f32 v162, v32, v33
  v_cvt_pk_bf16_f32 v163, v34, v35
  s_waitcnt lgkmcnt(0)
  v_mfma_f32_32x32x16_bf16 v[20:35], v[52:55], v[8:11], v[100:115]
  ds_read_b128 v[60:63], v166 offset:10240
  ds_read_b128 v[64:67], v166 offset:11264
  v_exp_f32 v36, v36
  v_exp_f32 v37, v37
  v_exp_f32 v38, v38
  v_exp_f32 v39, v39
  v_mfma_f32_32x32x16_bf16 v[84:99], v[72:75], v[160:163], v[84:99]
  v_cvt_pk_bf16_f32 v156, v36, v37
  v_cvt_pk_bf16_f32 v157, v38, v39
  v_exp_f32 v40, v40
  v_exp_f32 v41, v41
  v_exp_f32 v42, v42
  v_mfma_f32_16x16x32_bf16 v[152:155], v[148:151], v[160:163], v[152:155]
  ds_read_b128 v[68:71], v166 offset:24576
  ds_read_b128 v[72:75], v166 offset:25600
  v_exp_f32 v43, v43
  v_cvt_pk_bf16_f32 v158, v40, v41
  v_cvt_pk_bf16_f32 v159, v42, v43
  s_mov_b64 s[62:63], exec
  s_mov_b64 exec, 255
  buffer_load_dword v145, v144, s[72:75], s76 offen
  s_mov_b64 exec, s[62:63]
  s_add_u32 s76, s76, 8192
  v_mfma_f32_32x32x16_bf16 v[20:35], v[56:59], v[12:15], v[20:35]
  v_exp_f32 v44, v44
  v_exp_f32 v45, v45
  v_exp_f32 v46, v46
  v_mfma_f32_32x32x16_bf16 v[84:99], v[76:79], v[156:159], v[84:99]
  v_exp_f32 v47, v47
  v_cvt_pk_bf16_f32 v160, v44, v45
  v_cvt_pk_bf16_f32 v161, v46, v47
  v_exp_f32 v48, v48
  v_exp_f32 v49, v49
  v_mfma_f32_16x16x32_bf16 v[152:155], v[148:151], v[156:159], v[152:155]
  v_exp_f32 v50, v50
  v_exp_f32 v51, v51
  v_cvt_pk_bf16_f32 v162, v48, v49
  v_cvt_pk_bf16_f32 v163, v50, v51
  s_waitcnt lgkmcnt(0)
  v_mfma_f32_32x32x16_bf16 v[36:51], v[60:63], v[8:11], v[100:115]
  ds_read_b128 v[52:55], v166 offset:12288
  ds_read_b128 v[56:59], v166 offset:13312
  v_exp_f32 v20, v20
  v_exp_f32 v21, v21
  v_exp_f32 v22, v22
  v_exp_f32 v23, v23
  v_mfma_f32_32x32x16_bf16 v[84:99], v[80:83], v[160:163], v[84:99]
  v_cvt_pk_bf16_f32 v156, v20, v21
  v_cvt_pk_bf16_f32 v157, v22, v23
  v_exp_f32 v24, v24
  v_exp_f32 v25, v25
  v_exp_f32 v26, v26
  v_mfma_f32_16x16x32_bf16 v[152:155], v[148:151], v[160:163], v[152:155]
  ds_read_b128 v[76:79], v166 offset:26624
  ds_read_b128 v[80:83], v166 offset:27648
  v_exp_f32 v27, v27
  v_cvt_pk_bf16_f32 v158, v24, v25
  v_cvt_pk_bf16_f32 v159, v26, v27
  v_mfma_f32_32x32x16_bf16 v[36:51], v[64:67], v[12:15], v[36:51]
  v_exp_f32 v28, v28
  v_exp_f32 v29, v29
  v_exp_f32 v30, v30
  v_mfma_f32_32x32x16_bf16 v[84:99], v[68:71], v[156:159], v[84:99]
  v_exp_f32 v31, v31
  v_cvt_pk_bf16_f32 v160, v28, v29
  v_cvt_pk_bf16_f32 v161, v30, v31
  v_exp_f32 v32, v32
  v_exp_f32 v33, v33
  v_mfma_f32_16x16x32_bf16 v[152:155], v[148:151], v[156:159], v[152:155]
  v_exp_f32 v34, v34
  v_exp_f32 v35, v35
  v_cvt_pk_bf16_f32 v162, v32, v33
  v_cvt_pk_bf16_f32 v163, v34, v35
  s_waitcnt lgkmcnt(0)
  v_mfma_f32_32x32x16_bf16 v[20:35], v[52:55], v[8:11], v[100:115]
  ds_read_b128 v[60:63], v166 offset:14336
  ds_read_b128 v[64:67], v166 offset:15360
  v_exp_f32 v36, v36
  v_exp_f32 v37, v37
  v_exp_f32 v38, v38
  v_exp_f32 v39, v39
  v_mfma_f32_32x32x16_bf16 v[84:99], v[72:75], v[160:163], v[84:99]
  v_cvt_pk_bf16_f32 v156, v36, v37
  v_cvt_pk_bf16_f32 v157, v38, v39
  v_exp_f32 v40, v40
  v_exp_f32 v41, v41
  v_exp_f32 v42, v42
  v_mfma_f32_16x16x32_bf16 v[152:155], v[148:151], v[160:163], v[152:155]
  ds_read_b128 v[68:71], v166 offset:28672
  ds_read_b128 v[72:75], v166 offset:29696
  v_exp_f32 v43, v43
  v_cvt_pk_bf16_f32 v158, v40, v41
  v_cvt_pk_bf16_f32 v159, v42, v43
  v_mfma_f32_32x32x16_bf16 v[20:35], v[56:59], v[12:15], v[20:35]
  v_exp_f32 v44, v44
  v_exp_f32 v45, v45
  v_exp_f32 v46, v46
  v_mfma_f32_32x32x16_bf16 v[84:99], v[76:79], v[156:159], v[84:99]
  v_exp_f32 v47, v47
  v_cvt_pk_bf16_f32 v160, v44, v45
  v_cvt_pk_bf16_f32 v161, v46, v47
  v_exp_f32 v48, v48
  v_exp_f32 v49, v49
  v_mfma_f32_16x16x32_bf16 v[152:155], v[148:151], v[156:159], v[152:155]
  v_exp_f32 v50, v50
  v_exp_f32 v51, v51
  v_cvt_pk_bf16_f32 v162, v48, v49
  v_cvt_pk_bf16_f32 v163, v50, v51
  s_waitcnt lgkmcnt(0)
  s_waitcnt vmcnt(1)
  s_barrier
  s_add_u32 s29, s16, 32768
  s_mov_b32 s30, 114688
  v_mfma_f32_32x32x16_bf16 v[36:51], v[60:63], v[8:11], v[100:115]
  ds_read_b128 v[52:55], v164 offset:0
  ds_read_b128 v[56:59], v164 offset:1024
  v_exp_f32 v20, v20
  v_exp_f32 v21, v21
  v_exp_f32 v22, v22
  v_exp_f32 v23, v23
  v_mfma_f32_32x32x16_bf16 v[84:99], v[80:83], v[160:163], v[84:99]
  v_cvt_pk_bf16_f32 v156, v20, v21
  v_cvt_pk_bf16_f32 v157, v22, v23
  v_exp_f32 v24, v24
  v_exp_f32 v25, v25
  v_exp_f32 v26, v26
  v_mfma_f32_16x16x32_bf16 v[152:155], v[148:151], v[160:163], v[152:155]
  ds_read_b128 v[76:79], v166 offset:30720
  ds_read_b128 v[80:83], v166 offset:31744
  v_exp_f32 v27, v27
  v_cvt_pk_bf16_f32 v158, v24, v25
  v_cvt_pk_bf16_f32 v159, v26, v27
  s_add_u32 m0, s29, 0
  s_nop 0
  buffer_load_dwordx4 v17, s[20:23], s30 offen lds
  v_mfma_f32_32x32x16_bf16 v[36:51], v[64:67], v[12:15], v[36:51]
  v_exp_f32 v28, v28
  v_exp_f32 v29, v29
  v_exp_f32 v30, v30
  v_mfma_f32_32x32x16_bf16 v[84:99], v[68:71], v[156:159], v[84:99]
  v_exp_f32 v31, v31
  v_cvt_pk_bf16_f32 v160, v28, v29
  v_cvt_pk_bf16_f32 v161, v30, v31
  v_exp_f32 v32, v32
  v_exp_f32 v33, v33
  v_mfma_f32_16x16x32_bf16 v[152:155], v[148:151], v[156:159], v[152:155]
  v_exp_f32 v34, v34
  v_exp_f32 v35, v35
  v_cvt_pk_bf16_f32 v162, v32, v33
  v_cvt_pk_bf16_f32 v163, v34, v35
  s_waitcnt lgkmcnt(0)
  v_mfma_f32_32x32x16_bf16 v[20:35], v[52:55], v[8:11], v[100:115]
  ds_read_b128 v[60:63], v164 offset:2048
  ds_read_b128 v[64:67], v164 offset:3072
  v_exp_f32 v36, v36
  v_exp_f32 v37, v37
  v_exp_f32 v38, v38
  v_exp_f32 v39, v39
  v_mfma_f32_32x32x16_bf16 v[84:99], v[72:75], v[160:163], v[84:99]
  v_cvt_pk_bf16_f32 v156, v36, v37
  v_cvt_pk_bf16_f32 v157, v38, v39
  v_exp_f32 v40, v40
  v_exp_f32 v41, v41
  v_exp_f32 v42, v42
  v_mfma_f32_16x16x32_bf16 v[152:155], v[148:151], v[160:163], v[152:155]
  ds_read_b128 v[68:71], v164 offset:16384
  ds_read_b128 v[72:75], v164 offset:17408
  v_exp_f32 v43, v43
  v_cvt_pk_bf16_f32 v158, v40, v41
  v_cvt_pk_bf16_f32 v159, v42, v43
  s_add_u32 m0, s29, 8192
  s_add_u32 s3, s30, 8192
  buffer_load_dwordx4 v17, s[20:23], s3 offen lds
  v_mfma_f32_32x32x16_bf16 v[20:35], v[56:59], v[12:15], v[20:35]
  v_exp_f32 v44, v44
  v_exp_f32 v45, v45
  v_exp_f32 v46, v46
  v_mfma_f32_32x32x16_bf16 v[84:99], v[76:79], v[156:159], v[84:99]
  v_exp_f32 v47, v47
  v_cvt_pk_bf16_f32 v160, v44, v45
  v_cvt_pk_bf16_f32 v161, v46, v47
  v_exp_f32 v48, v48
  v_exp_f32 v49, v49
  v_mfma_f32_16x16x32_bf16 v[152:155], v[148:151], v[156:159], v[152:155]
  v_exp_f32 v50, v50
  v_exp_f32 v51, v51
  v_cvt_pk_bf16_f32 v162, v48, v49
  v_cvt_pk_bf16_f32 v163, v50, v51
  s_branch L_k3_attn_kernel_gemv_5
L_k3_attn_kernel_gemvret_6:
  s_waitcnt lgkmcnt(0)
  v_mfma_f32_32x32x16_bf16 v[36:51], v[60:63], v[8:11], v[100:115]
  ds_read_b128 v[52:55], v164 offset:4096
  ds_read_b128 v[56:59], v164 offset:5120
  v_exp_f32 v20, v20
  v_exp_f32 v21, v21
  v_exp_f32 v22, v22
  v_exp_f32 v23, v23
  v_mfma_f32_32x32x16_bf16 v[84:99], v[80:83], v[160:163], v[84:99]
  v_cvt_pk_bf16_f32 v156, v20, v21
  v_cvt_pk_bf16_f32 v157, v22, v23
  v_exp_f32 v24, v24
  v_exp_f32 v25, v25
  v_exp_f32 v26, v26
  v_mfma_f32_16x16x32_bf16 v[152:155], v[148:151], v[160:163], v[152:155]
  ds_read_b128 v[76:79], v164 offset:18432
  ds_read_b128 v[80:83], v164 offset:19456
  v_exp_f32 v27, v27
  v_cvt_pk_bf16_f32 v158, v24, v25
  v_cvt_pk_bf16_f32 v159, v26, v27
  s_add_u32 m0, s29, 16384
  s_nop 0
  buffer_load_dwordx4 v17, s[24:27], s30 offen lds
  v_mfma_f32_32x32x16_bf16 v[36:51], v[64:67], v[12:15], v[36:51]
  v_exp_f32 v28, v28
  v_exp_f32 v29, v29
  v_exp_f32 v30, v30
  v_mfma_f32_32x32x16_bf16 v[84:99], v[68:71], v[156:159], v[84:99]
  v_exp_f32 v31, v31
  v_cvt_pk_bf16_f32 v160, v28, v29
  v_cvt_pk_bf16_f32 v161, v30, v31
  v_exp_f32 v32, v32
  v_exp_f32 v33, v33
  v_mfma_f32_16x16x32_bf16 v[152:155], v[148:151], v[156:159], v[152:155]
  v_exp_f32 v34, v34
  v_exp_f32 v35, v35
  v_cvt_pk_bf16_f32 v162, v32, v33
  v_cvt_pk_bf16_f32 v163, v34, v35
  s_waitcnt lgkmcnt(0)
  v_mfma_f32_32x32x16_bf16 v[20:35], v[52:55], v[8:11], v[100:115]
  ds_read_b128 v[60:63], v164 offset:6144
  ds_read_b128 v[64:67], v164 offset:7168
  v_exp_f32 v36, v36
  v_exp_f32 v37, v37
  v_exp_f32 v38, v38
  v_exp_f32 v39, v39
  v_mfma_f32_32x32x16_bf16 v[84:99], v[72:75], v[160:163], v[84:99]
  v_cvt_pk_bf16_f32 v156, v36, v37
  v_cvt_pk_bf16_f32 v157, v38, v39
  v_exp_f32 v40, v40
  v_exp_f32 v41, v41
  v_exp_f32 v42, v42
  v_mfma_f32_16x16x32_bf16 v[152:155], v[148:151], v[160:163], v[152:155]
  ds_read_b128 v[68:71], v164 offset:20480
  ds_read_b128 v[72:75], v164 offset:21504
  v_exp_f32 v43, v43
  v_cvt_pk_bf16_f32 v158, v40, v41
  v_cvt_pk_bf16_f32 v159, v42, v43
  s_add_u32 m0, s29, 24576
  s_add_u32 s3, s30, 8192
  buffer_load_dwordx4 v17, s[24:27], s3 offen lds
  v_mfma_f32_32x32x16_bf16 v[20:35], v[56:59], v[12:15], v[20:35]
  v_exp_f32 v44, v44
  v_exp_f32 v45, v45
  v_exp_f32 v46, v46
  v_mfma_f32_32x32x16_bf16 v[84:99], v[76:79], v[156:159], v[84:99]
  v_exp_f32 v47, v47
  v_cvt_pk_bf16_f32 v160, v44, v45
  v_cvt_pk_bf16_f32 v161, v46, v47
  v_exp_f32 v48, v48
  v_exp_f32 v49, v49
  v_mfma_f32_16x16x32_bf16 v[152:155], v[148:151], v[156:159], v[152:155]
  v_exp_f32 v50, v50
  v_exp_f32 v51, v51
  v_cvt_pk_bf16_f32 v162, v48, v49
  v_cvt_pk_bf16_f32 v163, v50, v51
  s_waitcnt lgkmcnt(0)
  v_mfma_f32_32x32x16_bf16 v[36:51], v[60:63], v[8:11], v[100:115]
  ds_read_b128 v[52:55], v164 offset:8192
  ds_read_b128 v[56:59], v164 offset:9216
  v_exp_f32 v20, v20
  v_exp_f32 v21, v21
  v_exp_f32 v22, v22
  v_exp_f32 v23, v23
  v_mfma_f32_32x32x16_bf16 v[84:99], v[80:83], v[160:163], v[84:99]
  v_cvt_pk_bf16_f32 v156, v20, v21
  v_cvt_pk_bf16_f32 v157, v22, v23
  v_exp_f32 v24, v24
  v_exp_f32 v25, v25
  v_exp_f32 v26, v26
  v_mfma_f32_16x16x32_bf16 v[152:155], v[148:151], v[160:163], v[152:155]
  ds_read_b128 v[76:79], v164 offset:22528
  ds_read_b128 v[80:83], v164 offset:23552
  v_exp_f32 v27, v27
  v_cvt_pk_bf16_f32 v158, v24, v25
  v_cvt_pk_bf16_f32 v159, v26, v27
  v_mfma_f32_32x32x16_bf16 v[36:51], v[64:67], v[12:15], v[36:51]
  v_exp_f32 v28, v28
  v_exp_f32 v29, v29
  v_exp_f32 v30, v30
  v_mfma_f32_32x32x16_bf16 v[84:99], v[68:71], v[156:159], v[84:99]
  v_exp_f32 v31, v31
  v_cvt_pk_bf16_f32 v160, v28, v29
  v_cvt_pk_bf16_f32 v161, v30, v31
  v_exp_f32 v32, v32
  v_exp_f32 v33, v33
  v_mfma_f32_16x16x32_bf16 v[152:155], v[148:151], v[156:159], v[152:155]
  v_exp_f32 v34, v34
  v_exp_f32 v35, v35
  v_cvt_pk_bf16_f32 v162, v32, v33
  v_cvt_pk_bf16_f32 v163, v34, v35
  s_waitcnt lgkmcnt(0)
  v_mfma_f32_32x32x16_bf16 v[20:35], v[52:55], v[8:11], v[100:115]
  ds_read_b128 v[60:63], v164 offset:10240
  ds_read_b128 v[64:67], v164 offset:11264
  v_exp_f32 v36, v36
  v_exp_f32 v37, v37
  v_exp_f32 v38, v38
  v_exp_f32 v39, v39
  v_mfma_f32_32x32x16_bf16 v[84:99], v[72:75], v[160:163], v[84:99]
  v_cvt_pk_bf16_f32 v156, v36, v37
  v_cvt_pk_bf16_f32 v157, v38, v39
  v_exp_f32 v40, v40
  v_exp_f32 v41, v41
  v_exp_f32 v42, v42
  v_mfma_f32_16x16x32_bf16 v[152:155], v[148:151], v[160:163], v[152:155]
  ds_read_b128 v[68:71], v164 offset:24576
  ds_read_b128 v[72:75], v164 offset:25600
  v_exp_f32 v43, v43
  v_cvt_pk_bf16_f32 v158, v40, v41
  v_cvt_pk_bf16_f32 v159, v42, v43
  s_mov_b64 s[62:63], exec
  s_mov_b64 exec, 255
  buffer_load_dword v145, v144, s[72:75], s76 offen
  s_mov_b64 exec, s[62:63]
  s_add_u32 s76, s76, 8192
  v_mfma_f32_32x32x16_bf16 v[20:35], v[56:59], v[12:15], v[20:35]
  v_exp_f32 v44, v44
  v_exp_f32 v45, v45
  v_exp_f32 v46, v46
  v_mfma_f32_32x32x16_bf16 v[84:99], v[76:79], v[156:159], v[84:99]
  v_exp_f32 v47, v47
  v_cvt_pk_bf16_f32 v160, v44, v45
  v_cvt_pk_bf16_f32 v161, v46, v47
  v_exp_f32 v48, v48
  v_exp_f32 v49, v49
  v_mfma_f32_16x16x32_bf16 v[152:155], v[148:151], v[156:159], v[152:155]
  v_exp_f32 v50, v50
  v_exp_f32 v51, v51
  v_cvt_pk_bf16_f32 v162, v48, v49
  v_cvt_pk_bf16_f32 v163, v50, v51
  s_waitcnt lgkmcnt(0)
  v_mfma_f32_32x32x16_bf16 v[36:51], v[60:63], v[8:11], v[100:115]
  ds_read_b128 v[52:55], v164 offset:12288
  ds_read_b128 v[56:59], v164 offset:13312
  v_exp_f32 v20, v20
  v_exp_f32 v21, v21
  v_exp_f32 v22, v22
  v_exp_f32 v23, v23
  v_mfma_f32_32x32x16_bf16 v[84:99], v[80:83], v[160:163], v[84:99]
  v_cvt_pk_bf16_f32 v156, v20, v21
  v_cvt_pk_bf16_f32 v157, v22, v23
  v_exp_f32 v24, v24
  v_exp_f32 v25, v25
  v_exp_f32 v26, v26
  v_mfma_f32_16x16x32_bf16 v[152:155], v[148:151], v[160:163], v[152:155]
  ds_read_b128 v[76:79], v164 offset:26624
  ds_read_b128 v[80:83], v164 offset:27648
  v_exp_f32 v27, v27
  v_cvt_pk_bf16_f32 v158, v24, v25
  v_cvt_pk_bf16_f32 v159, v26, v27
  v_mfma_f32_32x32x16_bf16 v[36:51], v[64:67], v[12:15], v[36:51]
  v_exp_f32 v28, v28
  v_exp_f32 v29, v29
  v_exp_f32 v30, v30
  v_mfma_f32_32x32x16_bf16 v[84:99], v[68:71], v[156:159], v[84:99]
  v_exp_f32 v31, v31
  v_cvt_pk_bf16_f32 v160, v28, v29
  v_cvt_pk_bf16_f32 v161, v30, v31
  v_exp_f32 v32, v32
  v_exp_f32 v33, v33
  v_mfma_f32_16x16x32_bf16 v[152:155], v[148:151], v[156:159], v[152:155]
  v_exp_f32 v34, v34
  v_exp_f32 v35, v35
  v_cvt_pk_bf16_f32 v162, v32, v33
  v_cvt_pk_bf16_f32 v163, v34, v35
  s_waitcnt lgkmcnt(0)
  v_mfma_f32_32x32x16_bf16 v[20:35], v[52:55], v[8:11], v[100:115]
  ds_read_b128 v[60:63], v164 offset:14336
  ds_read_b128 v[64:67], v164 offset:15360
  v_exp_f32 v36, v36
  v_exp_f32 v37, v37
  v_exp_f32 v38, v38
  v_exp_f32 v39, v39
  v_mfma_f32_32x32x16_bf16 v[84:99], v[72:75], v[160:163], v[84:99]
  v_cvt_pk_bf16_f32 v156, v36, v37
  v_cvt_pk_bf16_f32 v157, v38, v39
  v_exp_f32 v40, v40
  v_exp_f32 v41, v41
  v_exp_f32 v42, v42
  v_mfma_f32_16x16x32_bf16 v[152:155], v[148:151], v[160:163], v[152:155]
  ds_read_b128 v[68:71], v164 offset:28672
  ds_read_b128 v[72:75], v164 offset:29696
  v_exp_f32 v43, v43
  v_cvt_pk_bf16_f32 v158, v40, v41
  v_cvt_pk_bf16_f32 v159, v42, v43
  v_mfma_f32_32x32x16_bf16 v[20:35], v[56:59], v[12:15], v[20:35]
  v_exp_f32 v44, v44
  v_exp_f32 v45, v45
  v_exp_f32 v46, v46
  v_mfma_f32_32x32x16_bf16 v[84:99], v[76:79], v[156:159], v[84:99]
  v_exp_f32 v47, v47
  v_cvt_pk_bf16_f32 v160, v44, v45
  v_cvt_pk_bf16_f32 v161, v46, v47
  v_exp_f32 v48, v48
  v_exp_f32 v49, v49
  v_mfma_f32_16x16x32_bf16 v[152:155], v[148:151], v[156:159], v[152:155]
  v_exp_f32 v50, v50
  v_exp_f32 v51, v51
  v_cvt_pk_bf16_f32 v162, v48, v49
  v_cvt_pk_bf16_f32 v163, v50, v51
  s_waitcnt lgkmcnt(0)
  s_waitcnt vmcnt(1)
  s_barrier
  v_mfma_f32_32x32x16_bf16 v[36:51], v[60:63], v[8:11], v[100:115]
  ds_read_b128 v[52:55], v165 offset:0
  ds_read_b128 v[56:59], v165 offset:1024
  v_exp_f32 v20, v20
  v_exp_f32 v21, v21
  v_exp_f32 v22, v22
  v_exp_f32 v23, v23
  v_mfma_f32_32x32x16_bf16 v[84:99], v[80:83], v[160:163], v[84:99]
  v_cvt_pk_bf16_f32 v156, v20, v21
  v_cvt_pk_bf16_f32 v157, v22, v23
  v_exp_f32 v24, v24
  v_exp_f32 v25, v25
  v_exp_f32 v26, v26
  v_mfma_f32_16x16x32_bf16 v[152:155], v[148:151], v[160:163], v[152:155]
  ds_read_b128 v[76:79], v164 offset:30720
  ds_read_b128 v[80:83], v164 offset:31744
  v_exp_f32 v27, v27
  v_cvt_pk_bf16_f32 v158, v24, v25
  v_cvt_pk_bf16_f32 v159, v26, v27
  v_mfma_f32_32x32x16_bf16 v[36:51], v[64:67], v[12:15], v[36:51]
  v_exp_f32 v28, v28
  v_exp_f32 v29, v29
  v_exp_f32 v30, v30
  v_mfma_f32_32x32x16_bf16 v[84:99], v[68:71], v[156:159], v[84:99]
  v_exp_f32 v31, v31
  v_cvt_pk_bf16_f32 v160, v28, v29
  v_cvt_pk_bf16_f32 v161, v30, v31
  v_exp_f32 v32, v32
  v_exp_f32 v33, v33
  v_mfma_f32_16x16x32_bf16 v[152:155], v[148:151], v[156:159], v[152:155]
  v_exp_f32 v34, v34
  v_exp_f32 v35, v35
  v_cvt_pk_bf16_f32 v162, v32, v33
  v_cvt_pk_bf16_f32 v163, v34, v35
  s_waitcnt lgkmcnt(0)
  v_mfma_f32_32x32x16_bf16 v[20:35], v[52:55], v[8:11], v[100:115]
  ds_read_b128 v[60:63], v165 offset:2048
  ds_read_b128 v[64:67], v165 offset:3072
  v_exp_f32 v36, v36
  v_exp_f32 v37, v37
  v_exp_f32 v38, v38
  v_exp_f32 v39, v39
  v_mfma_f32_32x32x16_bf16 v[84:99], v[72:75], v[160:163], v[84:99]
  v_cvt_pk_bf16_f32 v156, v36, v37
  v_cvt_pk_bf16_f32 v157, v38, v39
  v_exp_f32 v40, v40
  v_exp_f32 v41, v41
  v_exp_f32 v42, v42
  v_mfma_f32_16x16x32_bf16 v[152:155], v[148:151], v[160:163], v[152:155]
  ds_read_b128 v[68:71], v165 offset:16384
  ds_read_b128 v[72:75], v165 offset:17408
  v_exp_f32 v43, v43
  v_cvt_pk_bf16_f32 v158, v40, v41
  v_cvt_pk_bf16_f32 v159, v42, v43
  v_mfma_f32_32x32x16_bf16 v[20:35], v[56:59], v[12:15], v[20:35]
  v_exp_f32 v44, v44
  v_exp_f32 v45, v45
  v_exp_f32 v46, v46
  v_mfma_f32_32x32x16_bf16 v[84:99], v[76:79], v[156:159], v[84:99]
  v_exp_f32 v47, v47
  v_cvt_pk_bf16_f32 v160, v44, v45
  v_cvt_pk_bf16_f32 v161, v46, v47
  v_exp_f32 v48, v48
  v_exp_f32 v49, v49
  v_mfma_f32_16x16x32_bf16 v[152:155], v[148:151], v[156:159], v[152:155]
  v_exp_f32 v50, v50
  v_exp_f32 v51, v51
  v_cvt_pk_bf16_f32 v162, v48, v49
  v_cvt_pk_bf16_f32 v163, v50, v51
  s_waitcnt lgkmcnt(0)
  v_mfma_f32_32x32x16_bf16 v[36:51], v[60:63], v[8:11], v[100:115]
  ds_read_b128 v[52:55], v165 offset:4096
  ds_read_b128 v[56:59], v165 offset:5120
  v_exp_f32 v20, v20
  v_exp_f32 v21, v21
  v_exp_f32 v22, v22
  v_exp_f32 v23, v23
  v_mfma_f32_32x32x16_bf16 v[84:99], v[80:83], v[160:163], v[84:99]
  v_cvt_pk_bf16_f32 v156, v20, v21
  v_cvt_pk_bf16_f32 v157, v22, v23
  v_exp_f32 v24, v24
  v_exp_f32 v25, v25
  v_exp_f32 v26, v26
  v_mfma_f32_16x16x32_bf16 v[152:155], v[148:151], v[160:163], v[152:155]
  ds_read_b128 v[76:79], v165 offset:18432
  ds_read_b128 v[80:83], v165 offset:19456
  v_exp_f32 v27, v27
  v_cvt_pk_bf16_f32 v158, v24, v25
  v_cvt_pk_bf16_f32 v159, v26, v27
  v_mfma_f32_32x32x16_bf16 v[36:51], v[64:67], v[12:15], v[36:51]
  v_exp_f32 v28, v28
  v_exp_f32 v29, v29
  v_exp_f32 v30, v30
  v_mfma_f32_32x32x16_bf16 v[84:99], v[68:71], v[156:159], v[84:99]
  v_exp_f32 v31, v31
  v_cvt_pk_bf16_f32 v160, v28, v29
  v_cvt_pk_bf16_f32 v161, v30, v31
  v_exp_f32 v32, v32
  v_exp_f32 v33, v33
  v_mfma_f32_16x16x32_bf16 v[152:155], v[148:151], v[156:159], v[152:155]
  v_exp_f32 v34, v34
  v_exp_f32 v35, v35
  v_cvt_pk_bf16_f32 v162, v32, v33
  v_cvt_pk_bf16_f32 v163, v34, v35
  s_waitcnt lgkmcnt(0)
  v_mfma_f32_32x32x16_bf16 v[20:35], v[52:55], v[8:11], v[100:115]
  ds_read_b128 v[60:63], v165 offset:6144
  ds_read_b128 v[64:67], v165 offset:7168
  v_exp_f32 v36, v36
  v_exp_f32 v37, v37
  v_exp_f32 v38, v38
  v_exp_f32 v39, v39
  v_mfma_f32_32x32x16_bf16 v[84:99], v[72:75], v[160:163], v[84:99]
  v_cvt_pk_bf16_f32 v156, v36, v37
  v_cvt_pk_bf16_f32 v157, v38, v39
  v_exp_f32 v40, v40
  v_exp_f32 v41, v41
  v_exp_f32 v42, v42
  v_mfma_f32_16x16x32_bf16 v[152:155], v[148:151], v[160:163], v[152:155]
  ds_read_b128 v[68:71], v165 offset:20480
  ds_read_b128 v[72:75], v165 offset:21504
  v_exp_f32 v43, v43
  v_cvt_pk_bf16_f32 v158, v40, v41
  v_cvt_pk_bf16_f32 v159, v42, v43
  v_mfma_f32_32x32x16_bf16 v[20:35], v[56:59], v[12:15], v[20:35]
  v_exp_f32 v44, v44
  v_exp_f32 v45, v45
  v_exp_f32 v46, v46
  v_mfma_f32_32x32x16_bf16 v[84:99], v[76:79], v[156:159], v[84:99]
  v_exp_f32 v47, v47
  v_cvt_pk_bf16_f32 v160, v44, v45
  v_cvt_pk_bf16_f32 v161, v46, v47
  v_exp_f32 v48, v48
  v_exp_f32 v49, v49
  v_mfma_f32_16x16x32_bf16 v[152:155], v[148:151], v[156:159], v[152:155]
  v_exp_f32 v50, v50
  v_exp_f32 v51, v51
  v_cvt_pk_bf16_f32 v162, v48, v49
  v_cvt_pk_bf16_f32 v163, v50, v51
  s_waitcnt lgkmcnt(0)
  v_mfma_f32_32x32x16_bf16 v[36:51], v[60:63], v[8:11], v[100:115]
  ds_read_b128 v[52:55], v165 offset:8192
  ds_read_b128 v[56:59], v165 offset:9216
  v_exp_f32 v20, v20
  v_exp_f32 v21, v21
  v_exp_f32 v22, v22
  v_exp_f32 v23, v23
  v_mfma_f32_32x32x16_bf16 v[84:99], v[80:83], v[160:163], v[84:99]
  v_cvt_pk_bf16_f32 v156, v20, v21
  v_cvt_pk_bf16_f32 v157, v22, v23
  v_exp_f32 v24, v24
  v_exp_f32 v25, v25
  v_exp_f32 v26, v26
  v_mfma_f32_16x16x32_bf16 v[152:155], v[148:151], v[160:163], v[152:155]
  ds_read_b128 v[76:79], v165 offset:22528
  ds_read_b128 v[80:83], v165 offset:23552
  v_exp_f32 v27, v27
  v_cvt_pk_bf16_f32 v158, v24, v25
  v_cvt_pk_bf16_f32 v159, v26, v27
  v_mfma_f32_32x32x16_bf16 v[36:51], v[64:67], v[12:15], v[36:51]
  v_exp_f32 v28, v28
  v_exp_f32 v29, v29
  v_exp_f32 v30, v30
  v_mfma_f32_32x32x16_bf16 v[84:99], v[68:71], v[156:159], v[84:99]
  v_exp_f32 v31, v31
  v_cvt_pk_bf16_f32 v160, v28, v29
  v_cvt_pk_bf16_f32 v161, v30, v31
  v_exp_f32 v32, v32
  v_exp_f32 v33, v33
  v_mfma_f32_16x16x32_bf16 v[152:155], v[148:151], v[156:159], v[152:155]
  v_exp_f32 v34, v34
  v_exp_f32 v35, v35
  v_cvt_pk_bf16_f32 v162, v32, v33
  v_cvt_pk_bf16_f32 v163, v34, v35
  s_waitcnt lgkmcnt(0)
  v_mfma_f32_32x32x16_bf16 v[20:35], v[52:55], v[8:11], v[100:115]
  ds_read_b128 v[60:63], v165 offset:10240
  ds_read_b128 v[64:67], v165 offset:11264
  v_exp_f32 v36, v36
  v_exp_f32 v37, v37
  v_exp_f32 v38, v38
  v_exp_f32 v39, v39
  v_mfma_f32_32x32x16_bf16 v[84:99], v[72:75], v[160:163], v[84:99]
  v_cvt_pk_bf16_f32 v156, v36, v37
  v_cvt_pk_bf16_f32 v157, v38, v39
  v_exp_f32 v40, v40
  v_exp_f32 v41, v41
  v_exp_f32 v42, v42
  v_mfma_f32_16x16x32_bf16 v[152:155], v[148:151], v[160:163], v[152:155]
  ds_read_b128 v[68:71], v165 offset:24576
  ds_read_b128 v[72:75], v165 offset:25600
  v_exp_f32 v43, v43
  v_cvt_pk_bf16_f32 v158, v40, v41
  v_cvt_pk_bf16_f32 v159, v42, v43
  s_mov_b64 s[62:63], exec
  s_mov_b64 exec, 255
  buffer_load_dword v145, v144, s[72:75], s76 offen
  s_mov_b64 exec, s[62:63]
  s_add_u32 s76, s76, 8192
  v_mfma_f32_32x32x16_bf16 v[20:35], v[56:59], v[12:15], v[20:35]
  v_exp_f32 v44, v44
  v_exp_f32 v45, v45
  v_exp_f32 v46, v46
  v_mfma_f32_32x32x16_bf16 v[84:99], v[76:79], v[156:159], v[84:99]
  v_exp_f32 v47, v47
  v_cvt_pk_bf16_f32 v160, v44, v45
  v_cvt_pk_bf16_f32 v161, v46, v47
  v_exp_f32 v48, v48
  v_exp_f32 v49, v49
  v_mfma_f32_16x16x32_bf16 v[152:155], v[148:151], v[156:159], v[152:155]
  v_exp_f32 v50, v50
  v_exp_f32 v51, v51
  v_cvt_pk_bf16_f32 v162, v48, v49
  v_cvt_pk_bf16_f32 v163, v50, v51
  s_waitcnt lgkmcnt(0)
  v_mfma_f32_32x32x16_bf16 v[36:51], v[60:63], v[8:11], v[100:115]
  ds_read_b128 v[52:55], v165 offset:12288
  ds_read_b128 v[56:59], v165 offset:13312
  v_exp_f32 v20, v20
  v_exp_f32 v21, v21
  v_exp_f32 v22, v22
  v_exp_f32 v23, v23
  v_mfma_f32_32x32x16_bf16 v[84:99], v[80:83], v[160:163], v[84:99]
  v_cvt_pk_bf16_f32 v156, v20, v21
  v_cvt_pk_bf16_f32 v157, v22, v23
  v_exp_f32 v24, v24
  v_exp_f32 v25, v25
  v_exp_f32 v26, v26
  v_mfma_f32_16x16x32_bf16 v[152:155], v[148:151], v[160:163], v[152:155]
  ds_read_b128 v[76:79], v165 offset:26624
  ds_read_b128 v[80:83], v165 offset:27648
  v_exp_f32 v27, v27
  v_cvt_pk_bf16_f32 v158, v24, v25
  v_cvt_pk_bf16_f32 v159, v26, v27
  v_mfma_f32_32x32x16_bf16 v[36:51], v[64:67], v[12:15], v[36:51]
  v_exp_f32 v28, v28
  v_exp_f32 v29, v29
  v_exp_f32 v30, v30
  v_mfma_f32_32x32x16_bf16 v[84:99], v[68:71], v[156:159], v[84:99]
  v_exp_f32 v31, v31
  v_cvt_pk_bf16_f32 v160, v28, v29
  v_cvt_pk_bf16_f32 v161, v30, v31
  v_exp_f32 v32, v32
  v_exp_f32 v33, v33
  v_mfma_f32_16x16x32_bf16 v[152:155], v[148:151], v[156:159], v[152:155]
  v_exp_f32 v34, v34
  v_exp_f32 v35, v35
  v_cvt_pk_bf16_f32 v162, v32, v33
  v_cvt_pk_bf16_f32 v163, v34, v35
  s_waitcnt lgkmcnt(0)
  v_mfma_f32_32x32x16_bf16 v[20:35], v[52:55], v[8:11], v[100:115]
  ds_read_b128 v[60:63], v165 offset:14336
  ds_read_b128 v[64:67], v165 offset:15360
  v_exp_f32 v36, v36
  v_exp_f32 v37, v37
  v_exp_f32 v38, v38
  v_exp_f32 v39, v39
  v_mfma_f32_32x32x16_bf16 v[84:99], v[72:75], v[160:163], v[84:99]
  v_cvt_pk_bf16_f32 v156, v36, v37
  v_cvt_pk_bf16_f32 v157, v38, v39
  v_exp_f32 v40, v40
  v_exp_f32 v41, v41
  v_exp_f32 v42, v42
  v_mfma_f32_16x16x32_bf16 v[152:155], v[148:151], v[160:163], v[152:155]
  ds_read_b128 v[68:71], v165 offset:28672
  ds_read_b128 v[72:75], v165 offset:29696
  v_exp_f32 v43, v43
  v_cvt_pk_bf16_f32 v158, v40, v41
  v_cvt_pk_bf16_f32 v159, v42, v43
  v_mfma_f32_32x32x16_bf16 v[20:35], v[56:59], v[12:15], v[20:35]
  v_exp_f32 v44, v44
  v_exp_f32 v45, v45
  v_exp_f32 v46, v46
  v_mfma_f32_32x32x16_bf16 v[84:99], v[76:79], v[156:159], v[84:99]
  v_exp_f32 v47, v47
  v_cvt_pk_bf16_f32 v160, v44, v45
  v_cvt_pk_bf16_f32 v161, v46, v47
  v_exp_f32 v48, v48
  v_exp_f32 v49, v49
  v_mfma_f32_16x16x32_bf16 v[152:155], v[148:151], v[156:159], v[152:155]
  v_exp_f32 v50, v50
  v_exp_f32 v51, v51
  v_cvt_pk_bf16_f32 v162, v48, v49
  v_cvt_pk_bf16_f32 v163, v50, v51
  s_waitcnt lgkmcnt(0)
  v_mfma_f32_32x32x16_bf16 v[36:51], v[60:63], v[8:11], v[100:115]
  ds_read_b128 v[52:55], v166 offset:0
  ds_read_b128 v[56:59], v166 offset:1024
  v_exp_f32 v20, v20
  v_exp_f32 v21, v21
  v_exp_f32 v22, v22
  v_exp_f32 v23, v23
  v_mfma_f32_32x32x16_bf16 v[84:99], v[80:83], v[160:163], v[84:99]
  v_cvt_pk_bf16_f32 v156, v20, v21
  v_cvt_pk_bf16_f32 v157, v22, v23
  v_exp_f32 v24, v24
  v_exp_f32 v25, v25
  v_exp_f32 v26, v26
  v_mfma_f32_16x16x32_bf16 v[152:155], v[148:151], v[160:163], v[152:155]
  ds_read_b128 v[76:79], v165 offset:30720
  ds_read_b128 v[80:83], v165 offset:31744
  v_exp_f32 v27, v27
  v_cvt_pk_bf16_f32 v158, v24, v25
  v_cvt_pk_bf16_f32 v159, v26, v27
  v_mfma_f32_32x32x16_bf16 v[36:51], v[64:67], v[12:15], v[36:51]
  v_exp_f32 v28, v28
  v_exp_f32 v29, v29
  v_exp_f32 v30, v30
  v_mfma_f32_32x32x16_bf16 v[84:99], v[68:71], v[156:159], v[84:99]
  v_exp_f32 v31, v31
  v_cvt_pk_bf16_f32 v160, v28, v29
  v_cvt_pk_bf16_f32 v161, v30, v31
  v_exp_f32 v32, v32
  v_exp_f32 v33, v33
  v_mfma_f32_16x16x32_bf16 v[152:155], v[148:151], v[156:159], v[152:155]
  v_exp_f32 v34, v34
  v_exp_f32 v35, v35
  v_cvt_pk_bf16_f32 v162, v32, v33
  v_cvt_pk_bf16_f32 v163, v34, v35
  s_waitcnt lgkmcnt(0)
  v_mfma_f32_32x32x16_bf16 v[20:35], v[52:55], v[8:11], v[100:115]
  ds_read_b128 v[60:63], v166 offset:2048
  ds_read_b128 v[64:67], v166 offset:3072
  v_exp_f32 v36, v36
  v_exp_f32 v37, v37
  v_exp_f32 v38, v38
  v_exp_f32 v39, v39
  v_mfma_f32_32x32x16_bf16 v[84:99], v[72:75], v[160:163], v[84:99]
  v_cvt_pk_bf16_f32 v156, v36, v37
  v_cvt_pk_bf16_f32 v157, v38, v39
  v_exp_f32 v40, v40
  v_exp_f32 v41, v41
  v_exp_f32 v42, v42
  v_mfma_f32_16x16x32_bf16 v[152:155], v[148:151], v[160:163], v[152:155]
  ds_read_b128 v[68:71], v166 offset:16384
  ds_read_b128 v[72:75], v166 offset:17408
  v_exp_f32 v43, v43
  v_cvt_pk_bf16_f32 v158, v40, v41
  v_cvt_pk_bf16_f32 v159, v42, v43
  v_mfma_f32_32x32x16_bf16 v[20:35], v[56:59], v[12:15], v[20:35]
  v_exp_f32 v44, v44
  v_exp_f32 v45, v45
  v_exp_f32 v46, v46
  v_mfma_f32_32x32x16_bf16 v[84:99], v[76:79], v[156:159], v[84:99]
  v_exp_f32 v47, v47
  v_cvt_pk_bf16_f32 v160, v44, v45
  v_cvt_pk_bf16_f32 v161, v46, v47
  v_exp_f32 v48, v48
  v_exp_f32 v49, v49
  v_mfma_f32_16x16x32_bf16 v[152:155], v[148:151], v[156:159], v[152:155]
  v_exp_f32 v50, v50
  v_exp_f32 v51, v51
  v_cvt_pk_bf16_f32 v162, v48, v49
  v_cvt_pk_bf16_f32 v163, v50, v51
  s_nop 1
  v_mfma_f32_32x32x16_bf16 v[84:99], v[80:83], v[160:163], v[84:99]
  v_mfma_f32_16x16x32_bf16 v[152:155], v[148:151], v[160:163], v[152:155]
  v_mov_b32 v4, 0x21800000
  s_nop 7
  v_cmp_nge_f32 vcc, v152, v4
  s_nop 0
  s_cmp_lg_u64 vcc, 0
  s_cbranch_scc1 L_k3_attn_kernel_slow_8
L_k3_attn_kernel_done_7:
  s_nop 3
  v_rcp_f32 v4, v152
  s_nop 0
  v_mul_f32 v84, v84, v4
  v_mul_f32 v85, v85, v4
  v_mul_f32 v86, v86, v4
  v_mul_f32 v87, v87, v4
  v_mul_f32 v88, v88, v4
  v_mul_f32 v89, v89, v4
  v_mul_f32 v90, v90, v4
  v_mul_f32 v91, v91, v4
  v_mul_f32 v92, v92, v4
  v_mul_f32 v93, v93, v4
  v_mul_f32 v94, v94, v4
  v_mul_f32 v95, v95, v4
  v_mul_f32 v96, v96, v4
  v_mul_f32 v97, v97, v4
  v_mul_f32 v98, v98, v4
  v_mul_f32 v99, v99, v4
  v_cvt_pk_bf16_f32 v156, v84, v85
  v_cvt_pk_bf16_f32 v157, v86, v87
  v_cvt_pk_bf16_f32 v158, v88, v89
  v_cvt_pk_bf16_f32 v159, v90, v91
  v_cvt_pk_bf16_f32 v160, v92, v93
  v_cvt_pk_bf16_f32 v161, v94, v95
  v_cvt_pk_bf16_f32 v162, v96, v97
  v_cvt_pk_bf16_f32 v163, v98, v99
  v_permlane32_swap_b32 v156, v158
  v_permlane32_swap_b32 v157, v159
  v_permlane32_swap_b32 v160, v162
  v_permlane32_swap_b32 v161, v163
  s_add_u32 s36, s4, 0x800000
  s_addc_u32 s37, s5, 0
  s_add_u32 s36, s36, s14
  s_addc_u32 s37, s37, 0
  s_mov_b32 s38, 0x40000
  s_mov_b32 s39, 0x20000
  v_and_b32 v4, 3, v2
  v_and_b32 v5, 31, v1
  v_lshl_add_u32 v4, v4, 5, v5
  v_lshlrev_b32 v167, 11, v4
  v_lshrrev_b32 v4, 2, v2
  v_lshl_add_u32 v167, v4, 6, v167
  v_lshrrev_b32 v4, 5, v1
  v_lshl_add_u32 v167, v4, 4, v167
  buffer_store_dwordx4 v[156:159], v167, s[36:39], s15 offen
  buffer_store_dwordx4 v[160:163], v167, s[36:39], s15 offen offset:32
  s_branch L_k3_attn_kernel_end
L_k3_attn_kernel_slow_8:
  s_waitcnt lgkmcnt(0)
  v_mov_b32 v84, 0xff800000
  s_mov_b32 s77, 0
L_k3_attn_kernel_mloop_9:
  buffer_load_dwordx4 v[52:55], v16, s[20:23], s77 offen
  buffer_load_dwordx4 v[56:59], v16, s[20:23], s77 offen offset:1024
  s_waitcnt vmcnt(0)
  v_mfma_f32_32x32x16_bf16 v[20:35], v[52:55], v[8:11], 0
  v_mfma_f32_32x32x16_bf16 v[20:35], v[56:59], v[12:15], v[20:35]
  s_nop 11
  v_max_f32 v84, v84, v20
  v_max_f32 v84, v84, v21
  v_max_f32 v84, v84, v22
  v_max_f32 v84, v84, v23
  v_max_f32 v84, v84, v24
  v_max_f32 v84, v84, v25
  v_max_f32 v84, v84, v26
  v_max_f32 v84, v84, v27
  v_max_f32 v84, v84, v28
  v_max_f32 v84, v84, v29
  v_max_f32 v84, v84, v30
  v_max_f32 v84, v84, v31
  v_max_f32 v84, v84, v32
  v_max_f32 v84, v84, v33
  v_max_f32 v84, v84, v34
  v_max_f32 v84, v84, v35
  s_add_u32 s77, s77, 2048
  s_cmp_lt_u32 s77, 131072
  s_cbranch_scc1 L_k3_attn_kernel_mloop_9
  v_mov_b32 v4, v84
  s_nop 1
  v_permlane32_swap_b32 v84, v4
  v_max_f32 v84, v84, v4
  v_sub_f32 v84, 0, v84
  v_mov_b32 v100, v84
  v_mov_b32 v101, v84
  v_mov_b32 v102, v84
  v_mov_b32 v103, v84
  v_mov_b32 v104, v84
  v_mov_b32 v105, v84
  v_mov_b32 v106, v84
  v_mov_b32 v107, v84
  v_mov_b32 v108, v84
  v_mov_b32 v109, v84
  v_mov_b32 v110, v84
  v_mov_b32 v111, v84
  v_mov_b32 v112, v84
  v_mov_b32 v113, v84
  v_mov_b32 v114, v84
  v_mov_b32 v115, v84
  v_mov_b32 v84, 0
  v_mov_b32 v85, 0
  v_mov_b32 v86, 0
  v_mov_b32 v87, 0
  v_mov_b32 v88, 0
  v_mov_b32 v89, 0
  v_mov_b32 v90, 0
  v_mov_b32 v91, 0
  v_mov_b32 v92, 0
  v_mov_b32 v93, 0
  v_mov_b32 v94, 0
  v_mov_b32 v95, 0
  v_mov_b32 v96, 0
  v_mov_b32 v97, 0
  v_mov_b32 v98, 0
  v_mov_b32 v99, 0
  v_mov_b32 v152, 0
  v_mov_b32 v153, 0
  v_mov_b32 v154, 0
  v_mov_b32 v155, 0
  s_mov_b32 s77, 0
L_k3_attn_kernel_sloop_10:
  buffer_load_dwordx4 v[52:55], v16, s[20:23], s77 offen
  buffer_load_dwordx4 v[56:59], v16, s[20:23], s77 offen offset:1024
  buffer_load_dwordx4 v[68:71], v16, s[24:27], s77 offen
  buffer_load_dwordx4 v[72:75], v16, s[24:27], s77 offen offset:1024
  s_waitcnt vmcnt(0)
  v_mfma_f32_32x32x16_bf16 v[20:35], v[52:55], v[8:11], v[100:115]
  v_mfma_f32_32x32x16_bf16 v[20:35], v[56:59], v[12:15], v[20:35]
  s_nop 11
  v_exp_f32 v20, v20
  v_exp_f32 v21, v21
  v_exp_f32 v22, v22
  v_exp_f32 v23, v23
  v_exp_f32 v24, v24
  v_exp_f32 v25, v25
  v_exp_f32 v26, v26
  v_exp_f32 v27, v27
  v_exp_f32 v28, v28
  v_exp_f32 v29, v29
  v_exp_f32 v30, v30
  v_exp_f32 v31, v31
  v_exp_f32 v32, v32
  v_exp_f32 v33, v33
  v_exp_f32 v34, v34
  v_exp_f32 v35, v35
  v_cvt_pk_bf16_f32 v156, v20, v21
  v_cvt_pk_bf16_f32 v157, v22, v23
  v_cvt_pk_bf16_f32 v158, v24, v25
  v_cvt_pk_bf16_f32 v159, v26, v27
  v_cvt_pk_bf16_f32 v160, v28, v29
  v_cvt_pk_bf16_f32 v161, v30, v31
  v_cvt_pk_bf16_f32 v162, v32, v33
  v_cvt_pk_bf16_f32 v163, v34, v35
  v_mfma_f32_32x32x16_bf16 v[84:99], v[68:71], v[156:159], v[84:99]
  s_nop 0
  v_mfma_f32_32x32x16_bf16 v[84:99], v[72:75], v[160:163], v[84:99]
  v_mfma_f32_16x16x32_bf16 v[152:155], v[148:151], v[156:159], v[152:155]
  v_mfma_f32_16x16x32_bf16 v[152:155], v[148:151], v[160:163], v[152:155]
  s_add_u32 s77, s77, 2048
  s_cmp_lt_u32 s77, 131072
  s_cbranch_scc1 L_k3_attn_kernel_sloop_10
  s_branch L_k3_attn_kernel_done_7
L_k3_attn_kernel_gemv_5:
  v_lshlrev_b32 v140, 16, v140
  v_lshlrev_b32 v141, 16, v141
  v_lshlrev_b32 v142, 16, v142
  v_lshlrev_b32 v143, 16, v143
  v_mul_f32 v176, 0xbfb8aa3b, v140
  v_mul_f32 v177, 0xbfb8aa3b, v141
  v_mul_f32 v178, 0xbfb8aa3b, v142
  v_mul_f32 v179, 0xbfb8aa3b, v143
  v_exp_f32 v176, v176
  v_exp_f32 v177, v177
  v_exp_f32 v178, v178
  v_exp_f32 v179, v179
  v_add_f32 v176, 1.0, v176
  v_add_f32 v177, 1.0, v177
  v_add_f32 v178, 1.0, v178
  v_add_f32 v179, 1.0, v179
  v_rcp_f32 v176, v176
  v_rcp_f32 v177, v177
  v_rcp_f32 v178, v178
  v_rcp_f32 v179, v179
  v_mul_f32 v140, v140, v176
  v_mul_f32 v141, v141, v177
  v_mul_f32 v142, v142, v178
  v_mul_f32 v143, v143, v179
  v_cvt_pk_bf16_f32 v140, v140, v140
  v_and_b32 v140, 0xffff0000, v140
  v_cvt_pk_bf16_f32 v141, v141, v141
  v_and_b32 v141, 0xffff0000, v141
  v_cvt_pk_bf16_f32 v142, v142, v142
  v_and_b32 v142, 0xffff0000, v142
  v_cvt_pk_bf16_f32 v143, v143, v143
  v_and_b32 v143, 0xffff0000, v143
  v_lshlrev_b32 v116, 16, v124
  v_and_b32 v117, 0xffff0000, v124
  v_mul_f32 v168, v140, v116
  v_mul_f32 v169, v140, v117
  v_lshlrev_b32 v116, 16, v125
  v_and_b32 v117, 0xffff0000, v125
  v_mul_f32 v170, v140, v116
  v_mul_f32 v171, v140, v117
  v_lshlrev_b32 v116, 16, v126
  v_and_b32 v117, 0xffff0000, v126
  v_mul_f32 v172, v140, v116
  v_mul_f32 v173, v140, v117
  v_lshlrev_b32 v116, 16, v127
  v_and_b32 v117, 0xffff0000, v127
  v_mul_f32 v174, v140, v116
  v_mul_f32 v175, v140, v117
  v_lshlrev_b32 v116, 16, v128
  v_and_b32 v117, 0xffff0000, v128
  v_fmac_f32 v168, v141, v116
  v_fmac_f32 v169, v141, v117
  v_lshlrev_b32 v116, 16, v129
  v_and_b32 v117, 0xffff0000, v129
  v_fmac_f32 v170, v141, v116
  v_fmac_f32 v171, v141, v117
  v_lshlrev_b32 v116, 16, v130
  v_and_b32 v117, 0xffff0000, v130
  v_fmac_f32 v172, v141, v116
  v_fmac_f32 v173, v141, v117
  v_lshlrev_b32 v116, 16, v131
  v_and_b32 v117, 0xffff0000, v131
  v_fmac_f32 v174, v141, v116
  v_fmac_f32 v175, v141, v117
  v_lshlrev_b32 v116, 16, v132
  v_and_b32 v117, 0xffff0000, v132
  v_fmac_f32 v168, v142, v116
  v_fmac_f32 v169, v142, v117
  v_lshlrev_b32 v116, 16, v133
  v_and_b32 v117, 0xffff0000, v133
  v_fmac_f32 v170, v142, v116
  v_fmac_f32 v171, v142, v117
  v_lshlrev_b32 v116, 16, v134
  v_and_b32 v117, 0xffff0000, v134
  v_fmac_f32 v172, v142, v116
  v_fmac_f32 v173, v142, v117
  v_lshlrev_b32 v116, 16, v135
  v_and_b32 v117, 0xffff0000, v135
  v_fmac_f32 v174, v142, v116
  v_fmac_f32 v175, v142, v117
  v_lshlrev_b32 v116, 16, v136
  v_and_b32 v117, 0xffff0000, v136
  v_fmac_f32 v168, v143, v116
  v_fmac_f32 v169, v143, v117
  v_lshlrev_b32 v116, 16, v137
  v_and_b32 v117, 0xffff0000, v137
  v_fmac_f32 v170, v143, v116
  v_fmac_f32 v171, v143, v117
  v_lshlrev_b32 v116, 16, v138
  v_and_b32 v117, 0xffff0000, v138
  v_fmac_f32 v172, v143, v116
  v_fmac_f32 v173, v143, v117
  v_lshlrev_b32 v116, 16, v139
  v_and_b32 v117, 0xffff0000, v139
  v_fmac_f32 v174, v143, v116
  v_fmac_f32 v175, v143, v117
  v_add_f32_dpp v168, v168, v168 row_ror:8 row_mask:0xf bank_mask:0xf
  v_add_f32_dpp v169, v169, v169 row_ror:8 row_mask:0xf bank_mask:0xf
  v_add_f32_dpp v170, v170, v170 row_ror:8 row_mask:0xf bank_mask:0xf
  v_add_f32_dpp v171, v171, v171 row_ror:8 row_mask:0xf bank_mask:0xf
  v_add_f32_dpp v172, v172, v172 row_ror:8 row_mask:0xf bank_mask:0xf
  v_add_f32_dpp v173, v173, v173 row_ror:8 row_mask:0xf bank_mask:0xf
  v_add_f32_dpp v174, v174, v174 row_ror:8 row_mask:0xf bank_mask:0xf
  v_add_f32_dpp v175, v175, v175 row_ror:8 row_mask:0xf bank_mask:0xf
  v_lshrrev_b32 v180, 4, v0
  v_lshlrev_b32 v180, 8, v180
  v_and_b32 v4, 7, v0
  v_lshl_add_u32 v180, v4, 5, v180
  v_add_u32 v180, 0x18000, v180
  v_and_b32 v4, 15, v0
  v_cmp_gt_u32 vcc, 8, v4
  s_nop 0
  s_and_saveexec_b64 s[62:63], vcc
  ds_write_b128 v180, v[168:171]
  ds_write_b128 v180, v[172:175] offset:16
  s_mov_b64 exec, s[62:63]
  s_waitcnt lgkmcnt(0)
  s_barrier
  s_cmp_eq_u32 s12, 0
  s_cbranch_scc0 L_k3_attn_kernel_gemvret_6
  v_lshlrev_b32 v180, 2, v1
  v_add_u32 v180, 0x18000, v180
  ds_read_b32 v124, v180 offset:0
  ds_read_b32 v125, v180 offset:256
  ds_read_b32 v126, v180 offset:512
  ds_read_b32 v127, v180 offset:768
  ds_read_b32 v128, v180 offset:1024
  ds_read_b32 v129, v180 offset:1280
  ds_read_b32 v130, v180 offset:1536
  ds_read_b32 v131, v180 offset:1792
  ds_read_b32 v132, v180 offset:2048
  ds_read_b32 v133, v180 offset:2304
  ds_read_b32 v134, v180 offset:2560
  ds_read_b32 v135, v180 offset:2816
  ds_read_b32 v136, v180 offset:3072
  ds_read_b32 v137, v180 offset:3328
  ds_read_b32 v138, v180 offset:3584
  ds_read_b32 v139, v180 offset:3840
  ds_read_b32 v168, v180 offset:4096
  ds_read_b32 v169, v180 offset:4352
  ds_read_b32 v170, v180 offset:4608
  ds_read_b32 v171, v180 offset:4864
  ds_read_b32 v172, v180 offset:5120
  ds_read_b32 v173, v180 offset:5376
  ds_read_b32 v174, v180 offset:5632
  ds_read_b32 v175, v180 offset:5888
  s_waitcnt lgkmcnt(0)
  v_add_f32 v124, v124, v168
  v_add_f32 v125, v125, v169
  v_add_f32 v126, v126, v170
  v_add_f32 v127, v127, v171
  v_add_f32 v128, v128, v172
  v_add_f32 v129, v129, v173
  v_add_f32 v130, v130, v174
  v_add_f32 v131, v131, v175
  ds_read_b32 v168, v180 offset:6144
  ds_read_b32 v169, v180 offset:6400
  ds_read_b32 v170, v180 offset:6656
  ds_read_b32 v171, v180 offset:6912
  ds_read_b32 v172, v180 offset:7168
  ds_read_b32 v173, v180 offset:7424
  ds_read_b32 v174, v180 offset:7680
  ds_read_b32 v175, v180 offset:7936
  s_waitcnt lgkmcnt(0)
  v_add_f32 v132, v132, v168
  v_add_f32 v133, v133, v169
  v_add_f32 v134, v134, v170
  v_add_f32 v135, v135, v171
  v_add_f32 v136, v136, v172
  v_add_f32 v137, v137, v173
  v_add_f32 v138, v138, v174
  v_add_f32 v139, v139, v175
  v_add_f32 v124, v124, v132
  v_add_f32 v125, v125, v133
  v_add_f32 v126, v126, v134
  v_add_f32 v127, v127, v135
  v_add_f32 v128, v128, v136
  v_add_f32 v129, v129, v137
  v_add_f32 v130, v130, v138
  v_add_f32 v131, v131, v139
  v_add_f32 v124, v124, v128
  v_add_f32 v125, v125, v129
  v_add_f32 v126, v126, v130
  v_add_f32 v127, v127, v131
  v_add_f32 v124, v124, v126
  v_add_f32 v125, v125, v127
  v_add_f32 v124, v124, v125
  s_add_u32 s68, s4, 0x110000
  s_addc_u32 s69, s5, 0
  s_mov_b32 s70, 0x10000
  s_mov_b32 s71, 0x20000
  s_lshl_b32 s64, s50, 14
  s_lshl_b32 s3, s51, 8
  s_add_u32 s64, s64, s3
  v_lshlrev_b32 v180, 2, v1
  buffer_store_dword v124, v180, s[68:71], s64 offen
  s_branch L_k3_attn_kernel_gemvret_6
L_k3_attn_kernel_end:
L_k3_attn_kernel_exit:
  s_endpgm
.globl k4_wo_kernel
.p2align 8
.type k4_wo_kernel,@function
k4_wo_kernel:
  s_cmp_ge_u32 s2, 256
  s_cbranch_scc1 L_k4_wo_kernel_exit
  s_load_dwordx2 s[4:5], s[0:1], 112
  s_load_dwordx2 s[6:7], s[0:1], 32
  s_load_dwordx2 s[8:9], s[0:1], 0
  s_and_b32 s10, s2, 7
  s_lshr_b32 s11, s2, 3
  s_and_b32 s12, s10, 3
  s_mul_i32 s12, s12, 8
  s_and_b32 s3, s11, 7
  s_add_u32 s12, s12, s3
  s_lshr_b32 s13, s10, 2
  s_mul_i32 s13, s13, 4
  s_lshr_b32 s3, s11, 3
  s_add_u32 s13, s13, s3
  v_and_b32 v1, 63, v0
  v_lshrrev_b32 v2, 6, v0
  v_and_b32 v3, 3, v2
  v_readfirstlane_b32 s14, v2
  s_nop 0
  s_and_b32 s15, s14, 3
  v_lshrrev_b32 v4, 4, v0
  v_and_b32 v5, 15, v0
  v_lshlrev_b32 v7, 11, v4
  v_lshl_add_u32 v7, v5, 4, v7
  v_lshlrev_b32 v8, 5, v5
  s_lshl_b32 s16, s12, 17
  s_lshl_b32 s17, s13, 8
  s_add_u32 s18, s16, s17
  s_waitcnt lgkmcnt(0)
  s_add_u32 s20, s8, s18
  s_addc_u32 s21, s9, 0
  s_mov_b32 s22, 0x20000
  s_mov_b32 s23, 0x20000
  s_add_u32 s24, s4, 0xc00000
  s_addc_u32 s25, s5, 0
  s_add_u32 s24, s24, s18
  s_addc_u32 s25, s25, 0
  s_mov_b32 s26, 0x20000
  s_mov_b32 s27, 0x20000
  s_sub_u32 s22, 131072, s17
  s_sub_u32 s26, 131072, s17
  s_mov_b32 s28, s4
  s_mov_b32 s29, s5
  s_mov_b32 s30, 0x6000
  s_mov_b32 s31, 0x20000
  s_mov_b32 s32, 65536
  buffer_load_dwordx4 v[12:15], v7, s[20:23], 0 offen
  buffer_load_dwordx4 v[16:19], v7, s[20:23], s32 offen
  s_lshl_b32 s33, s13, 9
  s_add_u32 s36, s4, 0x110000
  s_addc_u32 s37, s5, 0
  s_mov_b32 s38, 0x10000
  s_mov_b32 s39, 0x20000
  v_lshrrev_b32 v6, 7, v0
  v_and_b32 v44, 0x7f, v0
  v_lshlrev_b32 v44, 2, v44
  v_lshl_add_u32 v44, v6, 12, v44
  s_add_u32 s40, s33, 0
  buffer_load_dword v46, v44, s[36:39], s40 offen
  s_add_u32 s41, s33, 16384
  buffer_load_dword v47, v44, s[36:39], s41 offen
  s_add_u32 s42, s33, 32768
  buffer_load_dword v48, v44, s[36:39], s42 offen
  s_add_u32 s43, s33, 49152
  buffer_load_dword v49, v44, s[36:39], s43 offen
  s_add_u32 s44, s4, 0x800000
  s_addc_u32 s45, s5, 0
  s_add_u32 s44, s44, s16
  s_addc_u32 s45, s45, 0
  s_mov_b32 s46, 0x20000
  s_mov_b32 s47, 0x20000
  s_add_u32 s48, s6, s17
  s_addc_u32 s49, s7, 0
  s_mov_b32 s50, 0x200000
  s_mov_b32 s51, 0x20000
  s_sub_u32 s50, 2097152, s17
  s_cmp_ge_u32 s14, 4
  s_cbranch_scc1 L_k4_wo_kernel_loader_1
  s_setprio 1
  v_and_b32 v50, 15, v1
  v_bfe_u32 v51, v1, 1, 3
  v_lshrrev_b32 v52, 4, v1
  v_xor_b32 v51, v51, v52
  v_lshlrev_b32 v54, 7, v50
  v_lshl_add_u32 v54, v51, 4, v54
  v_lshrrev_b32 v50, 1, v3
  v_lshl_add_u32 v54, v50, 12, v54
  v_xor_b32 v55, 64, v54
  v_and_b32 v50, 1, v3
  v_lshrrev_b32 v51, 4, v1
  v_lshlrev_b32 v51, 3, v51
  v_bfe_u32 v52, v1, 2, 2
  v_add_u32 v51, v51, v52
  v_and_b32 v52, 3, v51
  v_bfe_u32 v56, v51, 3, 1
  v_lshl_or_b32 v52, v56, 2, v52
  v_lshlrev_b32 v52, 1, v52
  v_bfe_u32 v56, v1, 1, 1
  v_mul_u32_u24 v60, 8, v50
  v_add_u32 v60, v60, v56
  v_xor_b32 v52, v60, v52
  v_mul_u32_u24 v51, 0x100, v51
  v_lshl_add_u32 v51, v52, 4, v51
  v_and_b32 v52, 1, v1
  v_lshl_add_u32 v56, v52, 3, v51
  v_add_u32 v56, 0x2000, v56
  v_lshrrev_b32 v51, 4, v1
  v_lshlrev_b32 v51, 3, v51
  v_bfe_u32 v52, v1, 2, 2
  v_add_u32 v51, v51, v52
  v_and_b32 v52, 3, v51
  v_bfe_u32 v57, v51, 3, 1
  v_lshl_or_b32 v52, v57, 2, v52
  v_lshlrev_b32 v52, 1, v52
  v_bfe_u32 v57, v1, 1, 1
  v_mul_u32_u24 v61, 8, v50
  v_add_u32 v61, v61, v57
  v_add_u32 v61, 2, v61
  v_xor_b32 v52, v61, v52
  v_mul_u32_u24 v51, 0x100, v51
  v_lshl_add_u32 v51, v52, 4, v51
  v_and_b32 v52, 1, v1
  v_lshl_add_u32 v57, v52, 3, v51
  v_add_u32 v57, 0x2000, v57
  v_lshrrev_b32 v51, 4, v1
  v_lshlrev_b32 v51, 3, v51
  v_bfe_u32 v52, v1, 2, 2
  v_add_u32 v51, v51, v52
  v_and_b32 v52, 3, v51
  v_bfe_u32 v58, v51, 3, 1
  v_lshl_or_b32 v52, v58, 2, v52
  v_lshlrev_b32 v52, 1, v52
  v_bfe_u32 v58, v1, 1, 1
  v_mul_u32_u24 v62, 8, v50
  v_add_u32 v62, v62, v58
  v_add_u32 v62, 4, v62
  v_xor_b32 v52, v62, v52
  v_mul_u32_u24 v51, 0x100, v51
  v_lshl_add_u32 v51, v52, 4, v51
  v_and_b32 v52, 1, v1
  v_lshl_add_u32 v58, v52, 3, v51
  v_add_u32 v58, 0x2000, v58
  v_lshrrev_b32 v51, 4, v1
  v_lshlrev_b32 v51, 3, v51
  v_bfe_u32 v52, v1, 2, 2
  v_add_u32 v51, v51, v52
  v_and_b32 v52, 3, v51
  v_bfe_u32 v59, v51, 3, 1
  v_lshl_or_b32 v52, v59, 2, v52
  v_lshlrev_b32 v52, 1, v52
  v_bfe_u32 v59, v1, 1, 1
  v_mul_u32_u24 v63, 8, v50
  v_add_u32 v63, v63, v59
  v_add_u32 v63, 6, v63
  v_xor_b32 v52, v63, v52
  v_mul_u32_u24 v51, 0x100, v51
  v_lshl_add_u32 v51, v52, 4, v51
  v_and_b32 v52, 1, v1
  v_lshl_add_u32 v59, v52, 3, v51
  v_add_u32 v59, 0x2000, v59
  s_waitcnt vmcnt(0)
  v_add_f32 v46, v46, v47
  v_add_f32 v48, v48, v49
  v_add_f32 v46, v46, v48
  v_cvt_pk_bf16_f32 v46, v46, v46
  v_and_b32 v46, 0xffff0000, v46
  s_and_b32 s3, s14, 6
  s_cmp_eq_u32 s3, 4
  s_cbranch_scc0 L_k4_wo_kernel_noadd_3
  v_add_f32 v46, 1.0, v46
  v_cvt_pk_bf16_f32 v46, v46, v46
  v_and_b32 v46, 0xffff0000, v46
L_k4_wo_kernel_noadd_3:
  v_lshlrev_b32 v47, 2, v0
  v_add_u32 v47, 147456, v47
  ds_write_b32 v47, v46
  s_cmp_eq_u32 s12, 0
  s_cbranch_scc0 L_k4_wo_kernel_nomod_4
  s_add_u32 s3, s33, 8192
  buffer_store_dword v46, v44, s[28:31], s3 offen
L_k4_wo_kernel_nomod_4:
  s_waitcnt lgkmcnt(0)
  s_mov_b32 s52, 0
  s_mov_b32 s53, 147456
  v_add_u32 v64, s52, v54
  v_add_u32 v65, s52, v55
  v_add_u32 v66, s52, v56
  v_add_u32 v67, s52, v57
  v_add_u32 v68, s52, v58
  v_add_u32 v69, s52, v59
  v_mov_b32 v72, 0
  v_mov_b32 v73, 0
  v_mov_b32 v74, 0
  v_mov_b32 v75, 0
  v_mov_b32 v76, 0
  v_mov_b32 v77, 0
  v_mov_b32 v78, 0
  v_mov_b32 v79, 0
  v_mov_b32 v80, 0
  v_mov_b32 v81, 0
  v_mov_b32 v82, 0
  v_mov_b32 v83, 0
  v_mov_b32 v84, 0
  v_mov_b32 v85, 0
  v_mov_b32 v86, 0
  v_mov_b32 v87, 0
  v_mov_b32 v88, 0
  v_mov_b32 v89, 0
  v_mov_b32 v90, 0
  v_mov_b32 v91, 0
  v_mov_b32 v92, 0
  v_mov_b32 v93, 0
  v_mov_b32 v94, 0
  v_mov_b32 v95, 0
  v_mov_b32 v96, 0
  v_mov_b32 v97, 0
  v_mov_b32 v98, 0
  v_mov_b32 v99, 0
  v_mov_b32 v100, 0
  v_mov_b32 v101, 0
  v_mov_b32 v102, 0
  v_mov_b32 v103, 0
  s_barrier
  ds_read_b128 v[104:107], v64 offset:0
  ds_read_b128 v[108:111], v64 offset:2048
  ds_read_b64_tr_b16 v[136:137], v66 offset:0
  ds_read_b64_tr_b16 v[138:139], v66 offset:1024
  ds_read_b64_tr_b16 v[140:141], v67 offset:0
  ds_read_b64_tr_b16 v[142:143], v67 offset:1024
  ds_read_b64_tr_b16 v[144:145], v68 offset:0
  ds_read_b64_tr_b16 v[146:147], v68 offset:1024
  ds_read_b64_tr_b16 v[148:149], v69 offset:0
  ds_read_b64_tr_b16 v[150:151], v69 offset:1024
  ds_read_b128 v[112:115], v65 offset:0
  ds_read_b128 v[116:119], v65 offset:2048
  ds_read_b64_tr_b16 v[152:153], v66 offset:8192
  ds_read_b64_tr_b16 v[154:155], v66 offset:9216
  ds_read_b64_tr_b16 v[156:157], v67 offset:8192
  ds_read_b64_tr_b16 v[158:159], v67 offset:9216
  ds_read_b64_tr_b16 v[160:161], v68 offset:8192
  ds_read_b64_tr_b16 v[162:163], v68 offset:9216
  ds_read_b64_tr_b16 v[164:165], v69 offset:8192
  ds_read_b64_tr_b16 v[166:167], v69 offset:9216
  s_mov_b32 s54, 8
L_k4_wo_kernel_cloop_5:
  s_waitcnt lgkmcnt(0)
  s_barrier
  v_mfma_f32_16x16x32_bf16 v[72:75], v[136:139], v[104:107], v[72:75]
  s_add_u32 s52, s52, 24576
  s_cmp_ge_u32 s52, s53
  s_cselect_b32 s3, 147456, 0
  s_sub_u32 s52, s52, s3
  v_mfma_f32_16x16x32_bf16 v[88:91], v[136:139], v[108:111], v[88:91]
  v_add_u32 v64, s52, v54
  v_add_u32 v65, s52, v55
  v_add_u32 v66, s52, v56
  v_mfma_f32_16x16x32_bf16 v[76:79], v[140:143], v[104:107], v[76:79]
  v_add_u32 v67, s52, v57
  v_add_u32 v68, s52, v58
  v_add_u32 v69, s52, v59
  ds_read_b128 v[120:123], v64 offset:0
  v_mfma_f32_16x16x32_bf16 v[92:95], v[140:143], v[108:111], v[92:95]
  ds_read_b128 v[124:127], v64 offset:2048
  ds_read_b64_tr_b16 v[168:169], v66 offset:0
  ds_read_b64_tr_b16 v[170:171], v66 offset:1024
  v_mfma_f32_16x16x32_bf16 v[80:83], v[144:147], v[104:107], v[80:83]
  ds_read_b64_tr_b16 v[172:173], v67 offset:0
  ds_read_b64_tr_b16 v[174:175], v67 offset:1024
  ds_read_b64_tr_b16 v[176:177], v68 offset:0
  ds_read_b64_tr_b16 v[178:179], v68 offset:1024
  v_mfma_f32_16x16x32_bf16 v[96:99], v[144:147], v[108:111], v[96:99]
  ds_read_b64_tr_b16 v[180:181], v69 offset:0
  ds_read_b64_tr_b16 v[182:183], v69 offset:1024
  ds_read_b128 v[128:131], v65 offset:0
  v_mfma_f32_16x16x32_bf16 v[84:87], v[148:151], v[104:107], v[84:87]
  ds_read_b128 v[132:135], v65 offset:2048
  ds_read_b64_tr_b16 v[184:185], v66 offset:8192
  ds_read_b64_tr_b16 v[186:187], v66 offset:9216
  v_mfma_f32_16x16x32_bf16 v[100:103], v[148:151], v[108:111], v[100:103]
  ds_read_b64_tr_b16 v[188:189], v67 offset:8192
  ds_read_b64_tr_b16 v[190:191], v67 offset:9216
  ds_read_b64_tr_b16 v[192:193], v68 offset:8192
  ds_read_b64_tr_b16 v[194:195], v68 offset:9216
  v_mfma_f32_16x16x32_bf16 v[72:75], v[152:155], v[112:115], v[72:75]
  ds_read_b64_tr_b16 v[196:197], v69 offset:8192
  ds_read_b64_tr_b16 v[198:199], v69 offset:9216
  v_mfma_f32_16x16x32_bf16 v[88:91], v[152:155], v[116:119], v[88:91]
  v_mfma_f32_16x16x32_bf16 v[76:79], v[156:159], v[112:115], v[76:79]
  v_mfma_f32_16x16x32_bf16 v[92:95], v[156:159], v[116:119], v[92:95]
  v_mfma_f32_16x16x32_bf16 v[80:83], v[160:163], v[112:115], v[80:83]
  v_mfma_f32_16x16x32_bf16 v[96:99], v[160:163], v[116:119], v[96:99]
  v_mfma_f32_16x16x32_bf16 v[84:87], v[164:167], v[112:115], v[84:87]
  v_mfma_f32_16x16x32_bf16 v[100:103], v[164:167], v[116:119], v[100:103]
  s_waitcnt lgkmcnt(0)
  s_barrier
  v_mfma_f32_16x16x32_bf16 v[72:75], v[168:171], v[120:123], v[72:75]
  s_add_u32 s52, s52, 24576
  s_cmp_ge_u32 s52, s53
  s_cselect_b32 s3, 147456, 0
  s_sub_u32 s52, s52, s3
  v_mfma_f32_16x16x32_bf16 v[88:91], v[168:171], v[124:127], v[88:91]
  v_add_u32 v64, s52, v54
  v_add_u32 v65, s52, v55
  v_add_u32 v66, s52, v56
  v_mfma_f32_16x16x32_bf16 v[76:79], v[172:175], v[120:123], v[76:79]
  v_add_u32 v67, s52, v57
  v_add_u32 v68, s52, v58
  v_add_u32 v69, s52, v59
  ds_read_b128 v[104:107], v64 offset:0
  v_mfma_f32_16x16x32_bf16 v[92:95], v[172:175], v[124:127], v[92:95]
  ds_read_b128 v[108:111], v64 offset:2048
  ds_read_b64_tr_b16 v[136:137], v66 offset:0
  ds_read_b64_tr_b16 v[138:139], v66 offset:1024
  v_mfma_f32_16x16x32_bf16 v[80:83], v[176:179], v[120:123], v[80:83]
  ds_read_b64_tr_b16 v[140:141], v67 offset:0
  ds_read_b64_tr_b16 v[142:143], v67 offset:1024
  ds_read_b64_tr_b16 v[144:145], v68 offset:0
  ds_read_b64_tr_b16 v[146:147], v68 offset:1024
  v_mfma_f32_16x16x32_bf16 v[96:99], v[176:179], v[124:127], v[96:99]
  ds_read_b64_tr_b16 v[148:149], v69 offset:0
  ds_read_b64_tr_b16 v[150:151], v69 offset:1024
  ds_read_b128 v[112:115], v65 offset:0
  v_mfma_f32_16x16x32_bf16 v[84:87], v[180:183], v[120:123], v[84:87]
  ds_read_b128 v[116:119], v65 offset:2048
  ds_read_b64_tr_b16 v[152:153], v66 offset:8192
  ds_read_b64_tr_b16 v[154:155], v66 offset:9216
  v_mfma_f32_16x16x32_bf16 v[100:103], v[180:183], v[124:127], v[100:103]
  ds_read_b64_tr_b16 v[156:157], v67 offset:8192
  ds_read_b64_tr_b16 v[158:159], v67 offset:9216
  ds_read_b64_tr_b16 v[160:161], v68 offset:8192
  ds_read_b64_tr_b16 v[162:163], v68 offset:9216
  v_mfma_f32_16x16x32_bf16 v[72:75], v[184:187], v[128:131], v[72:75]
  ds_read_b64_tr_b16 v[164:165], v69 offset:8192
  ds_read_b64_tr_b16 v[166:167], v69 offset:9216
  v_mfma_f32_16x16x32_bf16 v[88:91], v[184:187], v[132:135], v[88:91]
  v_mfma_f32_16x16x32_bf16 v[76:79], v[188:191], v[128:131], v[76:79]
  v_mfma_f32_16x16x32_bf16 v[92:95], v[188:191], v[132:135], v[92:95]
  v_mfma_f32_16x16x32_bf16 v[80:83], v[192:195], v[128:131], v[80:83]
  v_mfma_f32_16x16x32_bf16 v[96:99], v[192:195], v[132:135], v[96:99]
  v_mfma_f32_16x16x32_bf16 v[84:87], v[196:199], v[128:131], v[84:87]
  v_mfma_f32_16x16x32_bf16 v[100:103], v[196:199], v[132:135], v[100:103]
  s_sub_u32 s54, s54, 1
  s_cmp_lg_u32 s54, 0
  s_cbranch_scc1 L_k4_wo_kernel_cloop_5
  s_waitcnt lgkmcnt(0)
  v_and_b32 v6, 15, v1
  v_lshrrev_b32 v201, 1, v3
  v_lshl_add_u32 v6, v201, 5, v6
  v_mul_u32_u24 v200, 0x210, v6
  v_lshrrev_b32 v6, 4, v1
  v_lshl_add_u32 v200, v6, 4, v200
  v_and_b32 v201, 1, v3
  v_lshl_add_u32 v200, v201, 8, v200
  ds_write_b128 v200, v[72:75] offset:0
  ds_write_b128 v200, v[76:79] offset:64
  ds_write_b128 v200, v[80:83] offset:128
  ds_write_b128 v200, v[84:87] offset:192
  ds_write_b128 v200, v[88:91] offset:8448
  ds_write_b128 v200, v[92:95] offset:8512
  ds_write_b128 v200, v[96:99] offset:8576
  ds_write_b128 v200, v[100:103] offset:8640
  s_waitcnt lgkmcnt(0)
  s_branch L_k4_wo_kernel_epi_2
L_k4_wo_kernel_loader_1:
  v_lshrrev_b32 v50, 3, v1
  v_lshl_add_u32 v50, v3, 3, v50
  v_bfe_u32 v51, v50, 1, 3
  v_and_b32 v52, 7, v1
  v_xor_b32 v51, v52, v51
  v_mul_u32_u24 v50, 0x800, v50
  v_lshl_add_u32 v54, v51, 4, v50
  v_add_u32 v55, 0x10000, v54
  v_lshl_add_u32 v50, v3, 6, v1
  v_lshrrev_b32 v51, 4, v50
  v_and_b32 v52, 15, v50
  v_and_b32 v50, 3, v51
  v_bfe_u32 v56, v51, 3, 1
  v_lshl_or_b32 v50, v56, 2, v50
  v_lshlrev_b32 v50, 1, v50
  v_xor_b32 v52, v52, v50
  v_mul_u32_u24 v51, 0x800, v51
  v_lshl_add_u32 v56, v52, 4, v51
  v_add_u32 v57, 0x8000, v56
  v_add_u32 v58, 0x10000, v56
  v_add_u32 v59, 0x18000, v56
  s_lshl_b32 s57, s15, 10
  s_add_u32 s57, s57, 0
  s_add_u32 s59, s57, 147456
  s_mov_b32 s55, 0
  s_mov_b32 s56, 0
  s_add_u32 m0, s57, 0
  s_nop 0
  buffer_load_dwordx4 v54, s[44:47], s55 offen lds
  s_add_u32 m0, s57, 4096
  s_nop 0
  buffer_load_dwordx4 v55, s[44:47], s55 offen lds
  s_add_u32 m0, s57, 8192
  s_nop 0
  buffer_load_dwordx4 v56, s[48:51], s56 offen lds
  s_add_u32 m0, s57, 12288
  s_nop 0
  buffer_load_dwordx4 v57, s[48:51], s56 offen lds
  s_add_u32 m0, s57, 16384
  s_nop 0
  buffer_load_dwordx4 v58, s[48:51], s56 offen lds
  s_add_u32 m0, s57, 20480
  s_nop 0
  buffer_load_dwordx4 v59, s[48:51], s56 offen lds
  s_add_u32 s55, s55, 128
  s_add_u32 s56, s56, 131072
  s_add_u32 s57, s57, 24576
  s_cmp_ge_u32 s57, s59
  s_cselect_b32 s3, 147456, 0
  s_sub_u32 s57, s57, s3
  s_add_u32 m0, s57, 0
  s_nop 0
  buffer_load_dwordx4 v54, s[44:47], s55 offen lds
  s_add_u32 m0, s57, 4096
  s_nop 0
  buffer_load_dwordx4 v55, s[44:47], s55 offen lds
  s_add_u32 m0, s57, 8192
  s_nop 0
  buffer_load_dwordx4 v56, s[48:51], s56 offen lds
  s_add_u32 m0, s57, 12288
  s_nop 0
  buffer_load_dwordx4 v57, s[48:51], s56 offen lds
  s_add_u32 m0, s57, 16384
  s_nop 0
  buffer_load_dwordx4 v58, s[48:51], s56 offen lds
  s_add_u32 m0, s57, 20480
  s_nop 0
  buffer_load_dwordx4 v59, s[48:51], s56 offen lds
  s_add_u32 s55, s55, 128
  s_add_u32 s56, s56, 131072
  s_add_u32 s57, s57, 24576
  s_cmp_ge_u32 s57, s59
  s_cselect_b32 s3, 147456, 0
  s_sub_u32 s57, s57, s3
  s_add_u32 m0, s57, 0
  s_nop 0
  buffer_load_dwordx4 v54, s[44:47], s55 offen lds
  s_add_u32 m0, s57, 4096
  s_nop 0
  buffer_load_dwordx4 v55, s[44:47], s55 offen lds
  s_add_u32 m0, s57, 8192
  s_nop 0
  buffer_load_dwordx4 v56, s[48:51], s56 offen lds
  s_add_u32 m0, s57, 12288
  s_nop 0
  buffer_load_dwordx4 v57, s[48:51], s56 offen lds
  s_add_u32 m0, s57, 16384
  s_nop 0
  buffer_load_dwordx4 v58, s[48:51], s56 offen lds
  s_add_u32 m0, s57, 20480
  s_nop 0
  buffer_load_dwordx4 v59, s[48:51], s56 offen lds
  s_add_u32 s55, s55, 128
  s_add_u32 s56, s56, 131072
  s_add_u32 s57, s57, 24576
  s_cmp_ge_u32 s57, s59
  s_cselect_b32 s3, 147456, 0
  s_sub_u32 s57, s57, s3
  s_add_u32 m0, s57, 0
  s_nop 0
  buffer_load_dwordx4 v54, s[44:47], s55 offen lds
  s_add_u32 m0, s57, 4096
  s_nop 0
  buffer_load_dwordx4 v55, s[44:47], s55 offen lds
  s_add_u32 m0, s57, 8192
  s_nop 0
  buffer_load_dwordx4 v56, s[48:51], s56 offen lds
  s_add_u32 m0, s57, 12288
  s_nop 0
  buffer_load_dwordx4 v57, s[48:51], s56 offen lds
  s_add_u32 m0, s57, 16384
  s_nop 0
  buffer_load_dwordx4 v58, s[48:51], s56 offen lds
  s_add_u32 m0, s57, 20480
  s_nop 0
  buffer_load_dwordx4 v59, s[48:51], s56 offen lds
  s_add_u32 s55, s55, 128
  s_add_u32 s56, s56, 131072
  s_add_u32 s57, s57, 24576
  s_cmp_ge_u32 s57, s59
  s_cselect_b32 s3, 147456, 0
  s_sub_u32 s57, s57, s3
  s_add_u32 m0, s57, 0
  s_nop 0
  buffer_load_dwordx4 v54, s[44:47], s55 offen lds
  s_add_u32 m0, s57, 4096
  s_nop 0
  buffer_load_dwordx4 v55, s[44:47], s55 offen lds
  s_add_u32 m0, s57, 8192
  s_nop 0
  buffer_load_dwordx4 v56, s[48:51], s56 offen lds
  s_add_u32 m0, s57, 12288
  s_nop 0
  buffer_load_dwordx4 v57, s[48:51], s56 offen lds
  s_add_u32 m0, s57, 16384
  s_nop 0
  buffer_load_dwordx4 v58, s[48:51], s56 offen lds
  s_add_u32 m0, s57, 20480
  s_nop 0
  buffer_load_dwordx4 v59, s[48:51], s56 offen lds
  s_add_u32 s55, s55, 128
  s_add_u32 s56, s56, 131072
  s_add_u32 s57, s57, 24576
  s_cmp_ge_u32 s57, s59
  s_cselect_b32 s3, 147456, 0
  s_sub_u32 s57, s57, s3
  s_add_u32 m0, s57, 0
  s_nop 0
  buffer_load_dwordx4 v54, s[44:47], s55 offen lds
  s_add_u32 m0, s57, 4096
  s_nop 0
  buffer_load_dwordx4 v55, s[44:47], s55 offen lds
  s_add_u32 m0, s57, 8192
  s_nop 0
  buffer_load_dwordx4 v56, s[48:51], s56 offen lds
  s_add_u32 m0, s57, 12288
  s_nop 0
  buffer_load_dwordx4 v57, s[48:51], s56 offen lds
  s_add_u32 m0, s57, 16384
  s_nop 0
  buffer_load_dwordx4 v58, s[48:51], s56 offen lds
  s_add_u32 m0, s57, 20480
  s_nop 0
  buffer_load_dwordx4 v59, s[48:51], s56 offen lds
  s_add_u32 s55, s55, 128
  s_add_u32 s56, s56, 131072
  s_add_u32 s57, s57, 24576
  s_cmp_ge_u32 s57, s59
  s_cselect_b32 s3, 147456, 0
  s_sub_u32 s57, s57, s3
  s_waitcnt vmcnt(36)
  v_add_f32 v46, v46, v47
  v_add_f32 v48, v48, v49
  v_add_f32 v46, v46, v48
  v_cvt_pk_bf16_f32 v46, v46, v46
  v_and_b32 v46, 0xffff0000, v46
  s_and_b32 s3, s14, 6
  s_cmp_eq_u32 s3, 4
  s_cbranch_scc0 L_k4_wo_kernel_noadd_6
  v_add_f32 v46, 1.0, v46
  v_cvt_pk_bf16_f32 v46, v46, v46
  v_and_b32 v46, 0xffff0000, v46
L_k4_wo_kernel_noadd_6:
  v_lshlrev_b32 v47, 2, v0
  v_add_u32 v47, 147456, v47
  ds_write_b32 v47, v46
  s_cmp_eq_u32 s12, 0
  s_cbranch_scc0 L_k4_wo_kernel_nomod_7
  s_add_u32 s3, s33, 8192
  buffer_store_dword v46, v44, s[28:31], s3 offen
L_k4_wo_kernel_nomod_7:
  s_waitcnt lgkmcnt(0)
  s_waitcnt vmcnt(30)
  s_barrier
  s_mov_b32 s60, 10
L_k4_wo_kernel_ldloop_8:
  s_waitcnt vmcnt(24)
  s_barrier
  s_add_u32 m0, s57, 0
  s_nop 0
  buffer_load_dwordx4 v54, s[44:47], s55 offen lds
  s_add_u32 m0, s57, 4096
  s_nop 0
  buffer_load_dwordx4 v55, s[44:47], s55 offen lds
  s_add_u32 m0, s57, 8192
  s_nop 0
  buffer_load_dwordx4 v56, s[48:51], s56 offen lds
  s_add_u32 m0, s57, 12288
  s_nop 0
  buffer_load_dwordx4 v57, s[48:51], s56 offen lds
  s_add_u32 m0, s57, 16384
  s_nop 0
  buffer_load_dwordx4 v58, s[48:51], s56 offen lds
  s_add_u32 m0, s57, 20480
  s_nop 0
  buffer_load_dwordx4 v59, s[48:51], s56 offen lds
  s_add_u32 s55, s55, 128
  s_add_u32 s56, s56, 131072
  s_add_u32 s57, s57, 24576
  s_cmp_ge_u32 s57, s59
  s_cselect_b32 s3, 147456, 0
  s_sub_u32 s57, s57, s3
  s_sub_u32 s60, s60, 1
  s_cmp_lg_u32 s60, 0
  s_cbranch_scc1 L_k4_wo_kernel_ldloop_8
  s_waitcnt vmcnt(24)
  s_barrier
  s_waitcnt vmcnt(18)
  s_barrier
  s_waitcnt vmcnt(12)
  s_barrier
  s_waitcnt vmcnt(6)
  s_barrier
  s_waitcnt vmcnt(0)
  s_barrier
  s_waitcnt vmcnt(0)
  s_barrier
L_k4_wo_kernel_epi_2:
  s_barrier
  v_lshlrev_b32 v50, 5, v5
  v_add_u32 v50, 0x24000, v50
  ds_read_b128 v[20:23], v50 offset:0
  ds_read_b128 v[24:27], v50 offset:16
  ds_read_b128 v[36:39], v50 offset:512
  ds_read_b128 v[40:43], v50 offset:528
  ds_read_b128 v[28:31], v50 offset:1024
  ds_read_b128 v[32:35], v50 offset:1040
  v_mul_u32_u24 v51, 0x210, v4
  v_lshl_add_u32 v51, v5, 5, v51
  ds_read_b128 v[52:55], v51 offset:0
  ds_read_b128 v[56:59], v51 offset:16
  ds_read_b128 v[60:63], v51 offset:16896
  ds_read_b128 v[64:67], v51 offset:16912
  s_waitcnt vmcnt(0)
  v_lshlrev_b32 v68, 16, v12
  v_and_b32 v69, 0xffff0000, v12
  v_lshlrev_b32 v70, 16, v13
  v_and_b32 v71, 0xffff0000, v13
  v_lshlrev_b32 v72, 16, v14
  v_and_b32 v73, 0xffff0000, v14
  v_lshlrev_b32 v74, 16, v15
  v_and_b32 v75, 0xffff0000, v15
  v_lshlrev_b32 v76, 16, v16
  v_and_b32 v77, 0xffff0000, v16
  v_lshlrev_b32 v78, 16, v17
  v_and_b32 v79, 0xffff0000, v17
  v_lshlrev_b32 v80, 16, v18
  v_and_b32 v81, 0xffff0000, v18
  v_lshlrev_b32 v82, 16, v19
  v_and_b32 v83, 0xffff0000, v19
  s_waitcnt lgkmcnt(0)
  v_fma_f32 v52, v52, v20, v68
  v_fma_f32 v53, v53, v21, v69
  v_fma_f32 v54, v54, v22, v70
  v_fma_f32 v55, v55, v23, v71
  v_fma_f32 v56, v56, v24, v72
  v_fma_f32 v57, v57, v25, v73
  v_fma_f32 v58, v58, v26, v74
  v_fma_f32 v59, v59, v27, v75
  v_cvt_pk_bf16_f32 v84, v52, v53
  v_cvt_pk_bf16_f32 v85, v54, v55
  v_cvt_pk_bf16_f32 v86, v56, v57
  v_cvt_pk_bf16_f32 v87, v58, v59
  v_fma_f32 v60, v60, v20, v76
  v_fma_f32 v61, v61, v21, v77
  v_fma_f32 v62, v62, v22, v78
  v_fma_f32 v63, v63, v23, v79
  v_fma_f32 v64, v64, v24, v80
  v_fma_f32 v65, v65, v25, v81
  v_fma_f32 v66, v66, v26, v82
  v_fma_f32 v67, v67, v27, v83
  v_cvt_pk_bf16_f32 v88, v60, v61
  v_cvt_pk_bf16_f32 v89, v62, v63
  v_cvt_pk_bf16_f32 v90, v64, v65
  v_cvt_pk_bf16_f32 v91, v66, v67
  buffer_store_dwordx4 v[84:87], v7, s[24:27], 0 offen sc1
  buffer_store_dwordx4 v[88:91], v7, s[24:27], s32 offen sc1
  s_add_u32 s64, s4, 0x1000000
  s_addc_u32 s65, s5, 0
  s_add_u32 s64, s64, s18
  s_addc_u32 s65, s65, 0
  s_mov_b32 s66, 0x20000
  s_mov_b32 s67, 0x20000
  s_sub_u32 s66, 131072, s17
  v_lshlrev_b32 v68, 16, v84
  v_and_b32 v69, 0xffff0000, v84
  v_lshlrev_b32 v70, 16, v85
  v_and_b32 v71, 0xffff0000, v85
  v_lshlrev_b32 v72, 16, v86
  v_and_b32 v73, 0xffff0000, v86
  v_lshlrev_b32 v74, 16, v87
  v_and_b32 v75, 0xffff0000, v87
  v_mul_f32 v110, v68, v28
  v_mov_b32 v92, v68
  v_mul_f32 v93, v68, v68
  v_mov_b32 v94, v110
  v_mul_f32 v95, v110, v110
  v_mul_f32 v96, v110, v28
  v_mul_f32 v97, v110, v36
  v_mul_f32 v111, v69, v29
  v_add_f32 v92, v92, v69
  v_fmac_f32 v93, v69, v69
  v_add_f32 v94, v94, v111
  v_fmac_f32 v95, v111, v111
  v_fmac_f32 v96, v111, v29
  v_fmac_f32 v97, v111, v37
  v_mul_f32 v112, v70, v30
  v_add_f32 v92, v92, v70
  v_fmac_f32 v93, v70, v70
  v_add_f32 v94, v94, v112
  v_fmac_f32 v95, v112, v112
  v_fmac_f32 v96, v112, v30
  v_fmac_f32 v97, v112, v38
  v_mul_f32 v113, v71, v31
  v_add_f32 v92, v92, v71
  v_fmac_f32 v93, v71, v71
  v_add_f32 v94, v94, v113
  v_fmac_f32 v95, v113, v113
  v_fmac_f32 v96, v113, v31
  v_fmac_f32 v97, v113, v39
  v_mul_f32 v114, v72, v32
  v_add_f32 v92, v92, v72
  v_fmac_f32 v93, v72, v72
  v_add_f32 v94, v94, v114
  v_fmac_f32 v95, v114, v114
  v_fmac_f32 v96, v114, v32
  v_fmac_f32 v97, v114, v40
  v_mul_f32 v115, v73, v33
  v_add_f32 v92, v92, v73
  v_fmac_f32 v93, v73, v73
  v_add_f32 v94, v94, v115
  v_fmac_f32 v95, v115, v115
  v_fmac_f32 v96, v115, v33
  v_fmac_f32 v97, v115, v41
  v_mul_f32 v116, v74, v34
  v_add_f32 v92, v92, v74
  v_fmac_f32 v93, v74, v74
  v_add_f32 v94, v94, v116
  v_fmac_f32 v95, v116, v116
  v_fmac_f32 v96, v116, v34
  v_fmac_f32 v97, v116, v42
  v_mul_f32 v117, v75, v35
  v_add_f32 v92, v92, v75
  v_fmac_f32 v93, v75, v75
  v_add_f32 v94, v94, v117
  v_fmac_f32 v95, v117, v117
  v_fmac_f32 v96, v117, v35
  v_fmac_f32 v97, v117, v43
  v_mov_b32 v98, 0
  v_mov_b32 v99, 0
  v_cvt_pk_bf16_f32 v128, v110, v111
  v_cvt_pk_bf16_f32 v129, v112, v113
  v_cvt_pk_bf16_f32 v130, v114, v115
  v_cvt_pk_bf16_f32 v131, v116, v117
  v_lshlrev_b32 v76, 16, v88
  v_and_b32 v77, 0xffff0000, v88
  v_lshlrev_b32 v78, 16, v89
  v_and_b32 v79, 0xffff0000, v89
  v_lshlrev_b32 v80, 16, v90
  v_and_b32 v81, 0xffff0000, v90
  v_lshlrev_b32 v82, 16, v91
  v_and_b32 v83, 0xffff0000, v91
  v_mul_f32 v118, v76, v28
  v_mov_b32 v100, v76
  v_mul_f32 v101, v76, v76
  v_mov_b32 v102, v118
  v_mul_f32 v103, v118, v118
  v_mul_f32 v104, v118, v28
  v_mul_f32 v105, v118, v36
  v_mul_f32 v119, v77, v29
  v_add_f32 v100, v100, v77
  v_fmac_f32 v101, v77, v77
  v_add_f32 v102, v102, v119
  v_fmac_f32 v103, v119, v119
  v_fmac_f32 v104, v119, v29
  v_fmac_f32 v105, v119, v37
  v_mul_f32 v120, v78, v30
  v_add_f32 v100, v100, v78
  v_fmac_f32 v101, v78, v78
  v_add_f32 v102, v102, v120
  v_fmac_f32 v103, v120, v120
  v_fmac_f32 v104, v120, v30
  v_fmac_f32 v105, v120, v38
  v_mul_f32 v121, v79, v31
  v_add_f32 v100, v100, v79
  v_fmac_f32 v101, v79, v79
  v_add_f32 v102, v102, v121
  v_fmac_f32 v103, v121, v121
  v_fmac_f32 v104, v121, v31
  v_fmac_f32 v105, v121, v39
  v_mul_f32 v122, v80, v32
  v_add_f32 v100, v100, v80
  v_fmac_f32 v101, v80, v80
  v_add_f32 v102, v102, v122
  v_fmac_f32 v103, v122, v122
  v_fmac_f32 v104, v122, v32
  v_fmac_f32 v105, v122, v40
  v_mul_f32 v123, v81, v33
  v_add_f32 v100, v100, v81
  v_fmac_f32 v101, v81, v81
  v_add_f32 v102, v102, v123
  v_fmac_f32 v103, v123, v123
  v_fmac_f32 v104, v123, v33
  v_fmac_f32 v105, v123, v41
  v_mul_f32 v124, v82, v34
  v_add_f32 v100, v100, v82
  v_fmac_f32 v101, v82, v82
  v_add_f32 v102, v102, v124
  v_fmac_f32 v103, v124, v124
  v_fmac_f32 v104, v124, v34
  v_fmac_f32 v105, v124, v42
  v_mul_f32 v125, v83, v35
  v_add_f32 v100, v100, v83
  v_fmac_f32 v101, v83, v83
  v_add_f32 v102, v102, v125
  v_fmac_f32 v103, v125, v125
  v_fmac_f32 v104, v125, v35
  v_fmac_f32 v105, v125, v43
  v_mov_b32 v106, 0
  v_mov_b32 v107, 0
  v_cvt_pk_bf16_f32 v132, v118, v119
  v_cvt_pk_bf16_f32 v133, v120, v121
  v_cvt_pk_bf16_f32 v134, v122, v123
  v_cvt_pk_bf16_f32 v135, v124, v125
  buffer_store_dwordx4 v[128:131], v7, s[64:67], 0 offen sc1
  buffer_store_dwordx4 v[132:135], v7, s[64:67], s32 offen sc1
  v_add_f32_dpp v92, v92, v92 row_ror:8 row_mask:0xf bank_mask:0xf
  v_add_f32_dpp v93, v93, v93 row_ror:8 row_mask:0xf bank_mask:0xf
  v_add_f32_dpp v94, v94, v94 row_ror:8 row_mask:0xf bank_mask:0xf
  v_add_f32_dpp v95, v95, v95 row_ror:8 row_mask:0xf bank_mask:0xf
  v_add_f32_dpp v96, v96, v96 row_ror:8 row_mask:0xf bank_mask:0xf
  v_add_f32_dpp v97, v97, v97 row_ror:8 row_mask:0xf bank_mask:0xf
  v_add_f32_dpp v100, v100, v100 row_ror:8 row_mask:0xf bank_mask:0xf
  v_add_f32_dpp v101, v101, v101 row_ror:8 row_mask:0xf bank_mask:0xf
  v_add_f32_dpp v102, v102, v102 row_ror:8 row_mask:0xf bank_mask:0xf
  v_add_f32_dpp v103, v103, v103 row_ror:8 row_mask:0xf bank_mask:0xf
  v_add_f32_dpp v104, v104, v104 row_ror:8 row_mask:0xf bank_mask:0xf
  v_add_f32_dpp v105, v105, v105 row_ror:8 row_mask:0xf bank_mask:0xf
  v_add_f32_dpp v92, v92, v92 row_ror:4 row_mask:0xf bank_mask:0xf
  v_add_f32_dpp v93, v93, v93 row_ror:4 row_mask:0xf bank_mask:0xf
  v_add_f32_dpp v94, v94, v94 row_ror:4 row_mask:0xf bank_mask:0xf
  v_add_f32_dpp v95, v95, v95 row_ror:4 row_mask:0xf bank_mask:0xf
  v_add_f32_dpp v96, v96, v96 row_ror:4 row_mask:0xf bank_mask:0xf
  v_add_f32_dpp v97, v97, v97 row_ror:4 row_mask:0xf bank_mask:0xf
  v_add_f32_dpp v100, v100, v100 row_ror:4 row_mask:0xf bank_mask:0xf
  v_add_f32_dpp v101, v101, v101 row_ror:4 row_mask:0xf bank_mask:0xf
  v_add_f32_dpp v102, v102, v102 row_ror:4 row_mask:0xf bank_mask:0xf
  v_add_f32_dpp v103, v103, v103 row_ror:4 row_mask:0xf bank_mask:0xf
  v_add_f32_dpp v104, v104, v104 row_ror:4 row_mask:0xf bank_mask:0xf
  v_add_f32_dpp v105, v105, v105 row_ror:4 row_mask:0xf bank_mask:0xf
  v_add_f32_dpp v92, v92, v92 row_ror:2 row_mask:0xf bank_mask:0xf
  v_add_f32_dpp v93, v93, v93 row_ror:2 row_mask:0xf bank_mask:0xf
  v_add_f32_dpp v94, v94, v94 row_ror:2 row_mask:0xf bank_mask:0xf
  v_add_f32_dpp v95, v95, v95 row_ror:2 row_mask:0xf bank_mask:0xf
  v_add_f32_dpp v96, v96, v96 row_ror:2 row_mask:0xf bank_mask:0xf
  v_add_f32_dpp v97, v97, v97 row_ror:2 row_mask:0xf bank_mask:0xf
  v_add_f32_dpp v100, v100, v100 row_ror:2 row_mask:0xf bank_mask:0xf
  v_add_f32_dpp v101, v101, v101 row_ror:2 row_mask:0xf bank_mask:0xf
  v_add_f32_dpp v102, v102, v102 row_ror:2 row_mask:0xf bank_mask:0xf
  v_add_f32_dpp v103, v103, v103 row_ror:2 row_mask:0xf bank_mask:0xf
  v_add_f32_dpp v104, v104, v104 row_ror:2 row_mask:0xf bank_mask:0xf
  v_add_f32_dpp v105, v105, v105 row_ror:2 row_mask:0xf bank_mask:0xf
  v_add_f32_dpp v92, v92, v92 row_ror:1 row_mask:0xf bank_mask:0xf
  v_add_f32_dpp v93, v93, v93 row_ror:1 row_mask:0xf bank_mask:0xf
  v_add_f32_dpp v94, v94, v94 row_ror:1 row_mask:0xf bank_mask:0xf
  v_add_f32_dpp v95, v95, v95 row_ror:1 row_mask:0xf bank_mask:0xf
  v_add_f32_dpp v96, v96, v96 row_ror:1 row_mask:0xf bank_mask:0xf
  v_add_f32_dpp v97, v97, v97 row_ror:1 row_mask:0xf bank_mask:0xf
  v_add_f32_dpp v100, v100, v100 row_ror:1 row_mask:0xf bank_mask:0xf
  v_add_f32_dpp v101, v101, v101 row_ror:1 row_mask:0xf bank_mask:0xf
  v_add_f32_dpp v102, v102, v102 row_ror:1 row_mask:0xf bank_mask:0xf
  v_add_f32_dpp v103, v103, v103 row_ror:1 row_mask:0xf bank_mask:0xf
  v_add_f32_dpp v104, v104, v104 row_ror:1 row_mask:0xf bank_mask:0xf
  v_add_f32_dpp v105, v105, v105 row_ror:1 row_mask:0xf bank_mask:0xf
  s_lshl_b32 s68, s12, 14
  s_lshl_b32 s3, s13, 5
  s_add_u32 s68, s68, s3
  s_add_u32 s72, s4, 0x10000
  s_addc_u32 s73, s5, 0
  s_mov_b32 s74, 0x80100
  s_mov_b32 s75, 0x20000
  v_lshlrev_b32 v136, 8, v4
  v_cmp_eq_u32 vcc, 0, v5
  s_nop 0
  s_and_saveexec_b64 s[76:77], vcc
  s_add_u32 s78, s68, 8192
  buffer_store_dwordx4 v[92:95], v136, s[72:75], s68 offen
  buffer_store_dwordx4 v[96:99], v136, s[72:75], s68 offen offset:16
  buffer_store_dwordx4 v[100:103], v136, s[72:75], s78 offen
  buffer_store_dwordx4 v[104:107], v136, s[72:75], s78 offen offset:16
  s_mov_b64 exec, s[76:77]
  s_cmp_eq_u32 s12, 0
  s_cbranch_scc0 L_k4_wo_kernel_noconst_9
  s_cmp_eq_u32 s14, 0
  s_cbranch_scc0 L_k4_wo_kernel_noconst_9
  v_mov_b32 v140, v28
  v_mul_f32 v141, v28, v28
  v_mul_f32 v142, v28, v36
  v_mov_b32 v143, v36
  v_mul_f32 v144, v36, v36
  v_add_f32 v140, v140, v29
  v_fmac_f32 v141, v29, v29
  v_fmac_f32 v142, v29, v37
  v_add_f32 v143, v143, v37
  v_fmac_f32 v144, v37, v37
  v_add_f32 v140, v140, v30
  v_fmac_f32 v141, v30, v30
  v_fmac_f32 v142, v30, v38
  v_add_f32 v143, v143, v38
  v_fmac_f32 v144, v38, v38
  v_add_f32 v140, v140, v31
  v_fmac_f32 v141, v31, v31
  v_fmac_f32 v142, v31, v39
  v_add_f32 v143, v143, v39
  v_fmac_f32 v144, v39, v39
  v_add_f32 v140, v140, v32
  v_fmac_f32 v141, v32, v32
  v_fmac_f32 v142, v32, v40
  v_add_f32 v143, v143, v40
  v_fmac_f32 v144, v40, v40
  v_add_f32 v140, v140, v33
  v_fmac_f32 v141, v33, v33
  v_fmac_f32 v142, v33, v41
  v_add_f32 v143, v143, v41
  v_fmac_f32 v144, v41, v41
  v_add_f32 v140, v140, v34
  v_fmac_f32 v141, v34, v34
  v_fmac_f32 v142, v34, v42
  v_add_f32 v143, v143, v42
  v_fmac_f32 v144, v42, v42
  v_add_f32 v140, v140, v35
  v_fmac_f32 v141, v35, v35
  v_fmac_f32 v142, v35, v43
  v_add_f32 v143, v143, v43
  v_fmac_f32 v144, v43, v43
  v_mov_b32 v145, 0
  v_mov_b32 v146, 0
  v_mov_b32 v147, 0
  v_add_f32_dpp v140, v140, v140 row_ror:8 row_mask:0xf bank_mask:0xf
  v_add_f32_dpp v141, v141, v141 row_ror:8 row_mask:0xf bank_mask:0xf
  v_add_f32_dpp v142, v142, v142 row_ror:8 row_mask:0xf bank_mask:0xf
  v_add_f32_dpp v143, v143, v143 row_ror:8 row_mask:0xf bank_mask:0xf
  v_add_f32_dpp v144, v144, v144 row_ror:8 row_mask:0xf bank_mask:0xf
  v_add_f32_dpp v140, v140, v140 row_ror:4 row_mask:0xf bank_mask:0xf
  v_add_f32_dpp v141, v141, v141 row_ror:4 row_mask:0xf bank_mask:0xf
  v_add_f32_dpp v142, v142, v142 row_ror:4 row_mask:0xf bank_mask:0xf
  v_add_f32_dpp v143, v143, v143 row_ror:4 row_mask:0xf bank_mask:0xf
  v_add_f32_dpp v144, v144, v144 row_ror:4 row_mask:0xf bank_mask:0xf
  v_add_f32_dpp v140, v140, v140 row_ror:2 row_mask:0xf bank_mask:0xf
  v_add_f32_dpp v141, v141, v141 row_ror:2 row_mask:0xf bank_mask:0xf
  v_add_f32_dpp v142, v142, v142 row_ror:2 row_mask:0xf bank_mask:0xf
  v_add_f32_dpp v143, v143, v143 row_ror:2 row_mask:0xf bank_mask:0xf
  v_add_f32_dpp v144, v144, v144 row_ror:2 row_mask:0xf bank_mask:0xf
  v_add_f32_dpp v140, v140, v140 row_ror:1 row_mask:0xf bank_mask:0xf
  v_add_f32_dpp v141, v141, v141 row_ror:1 row_mask:0xf bank_mask:0xf
  v_add_f32_dpp v142, v142, v142 row_ror:1 row_mask:0xf bank_mask:0xf
  v_add_f32_dpp v143, v143, v143 row_ror:1 row_mask:0xf bank_mask:0xf
  v_add_f32_dpp v144, v144, v144 row_ror:1 row_mask:0xf bank_mask:0xf
  v_cmp_eq_u32 vcc, 0, v0
  s_nop 0
  s_and_saveexec_b64 s[76:77], vcc
  s_cbranch_execz L_k4_wo_kernel_noconst_9
  s_lshl_b32 s79, s13, 5
  s_add_u32 s79, s79, 524288
  v_mov_b32 v148, 0
  buffer_store_dwordx4 v[140:143], v148, s[72:75], s79 offen
  buffer_store_dwordx4 v[144:147], v148, s[72:75], s79 offen offset:16
L_k4_wo_kernel_noconst_9:
  s_mov_b64 exec, s[76:77]
L_k4_wo_kernel_end:
L_k4_wo_kernel_exit:
  s_endpgm
.globl k5_g1_kernel
.p2align 8
.type k5_g1_kernel,@function
k5_g1_kernel:
  s_cmp_ge_u32 s2, 256
  s_cbranch_scc1 L_k5_g1_kernel_exit
  s_load_dwordx2 s[4:5], s[0:1], 112
  s_load_dwordx2 s[6:7], s[0:1], 56
  s_load_dwordx2 s[8:9], s[0:1], 48
  s_and_b32 s10, s2, 7
  s_lshr_b32 s11, s2, 3
  s_and_b32 s12, s10, 1
  s_mul_i32 s12, s12, 8
  s_and_b32 s3, s11, 7
  s_add_u32 s12, s12, s3
  s_lshr_b32 s13, s10, 1
  s_mul_i32 s13, s13, 4
  s_lshr_b32 s3, s11, 3
  s_add_u32 s13, s13, s3
  v_and_b32 v1, 63, v0
  v_lshrrev_b32 v2, 6, v0
  v_and_b32 v3, 3, v2
  v_readfirstlane_b32 s14, v2
  s_nop 0
  s_and_b32 s15, s14, 3
  s_lshl_b32 s16, s12, 18
  s_mul_i32 s17, s13, 448
  s_cmp_ge_u32 s14, 4
  s_cbranch_scc1 L_k5_g1_kernel_loader_1
  s_setprio 1
  v_and_b32 v4, 15, v1
  v_bfe_u32 v5, v1, 1, 3
  v_lshrrev_b32 v6, 4, v1
  v_xor_b32 v5, v5, v6
  v_lshlrev_b32 v8, 7, v4
  v_lshl_add_u32 v8, v5, 4, v8
  v_lshrrev_b32 v4, 1, v3
  v_lshl_add_u32 v8, v4, 13, v8
  v_xor_b32 v9, 64, v8
  v_and_b32 v4, 1, v3
  v_lshrrev_b32 v5, 4, v1
  v_lshlrev_b32 v5, 3, v5
  v_bfe_u32 v6, v1, 2, 2
  v_add_u32 v5, v5, v6
  v_bfe_u32 v6, v5, 3, 1
  v_lshlrev_b32 v6, 1, v6
  v_bfe_u32 v10, v1, 1, 1
  v_mul_u32_u24 v12, 14, v4
  v_add_u32 v12, v12, v10
  v_xor_b32 v6, v12, v6
  v_mul_u32_u24 v5, 0x1c0, v5
  v_lshl_add_u32 v5, v6, 4, v5
  v_and_b32 v6, 1, v1
  v_lshl_add_u32 v10, v6, 3, v5
  v_add_u32 v10, 0x4000, v10
  v_lshrrev_b32 v5, 4, v1
  v_lshlrev_b32 v5, 3, v5
  v_bfe_u32 v6, v1, 2, 2
  v_add_u32 v5, v5, v6
  v_bfe_u32 v6, v5, 3, 1
  v_lshlrev_b32 v6, 1, v6
  v_bfe_u32 v11, v1, 1, 1
  v_mul_u32_u24 v13, 14, v4
  v_add_u32 v13, v13, v11
  v_add_u32 v13, 2, v13
  v_xor_b32 v6, v13, v6
  v_mul_u32_u24 v5, 0x1c0, v5
  v_lshl_add_u32 v5, v6, 4, v5
  v_and_b32 v6, 1, v1
  v_lshl_add_u32 v11, v6, 3, v5
  v_add_u32 v11, 0x4000, v11
  v_and_b32 v221, 15, v1
  v_min_u32 v221, 3, v221
  v_mul_u32_u24 v220, 0x820, v221
  v_lshrrev_b32 v222, 4, v1
  v_lshl_add_u32 v220, v222, 4, v220
  v_add_u32 v220, 0x22600, v220
  s_cmp_ge_u32 s15, 2
  s_cbranch_scc1 L_k5_g1_kernel_wm1_3
  s_mov_b32 s18, 0
  s_mov_b32 s19, 135168
  v_add_u32 v14, s18, v8
  v_add_u32 v15, s18, v9
  v_add_u32 v16, s18, v10
  v_add_u32 v17, s18, v11
  v_mov_b32 v20, 0
  v_mov_b32 v21, 0
  v_mov_b32 v22, 0
  v_mov_b32 v23, 0
  v_mov_b32 v24, 0
  v_mov_b32 v25, 0
  v_mov_b32 v26, 0
  v_mov_b32 v27, 0
  v_mov_b32 v28, 0
  v_mov_b32 v29, 0
  v_mov_b32 v30, 0
  v_mov_b32 v31, 0
  v_mov_b32 v32, 0
  v_mov_b32 v33, 0
  v_mov_b32 v34, 0
  v_mov_b32 v35, 0
  v_mov_b32 v36, 0
  v_mov_b32 v37, 0
  v_mov_b32 v38, 0
  v_mov_b32 v39, 0
  v_mov_b32 v40, 0
  v_mov_b32 v41, 0
  v_mov_b32 v42, 0
  v_mov_b32 v43, 0
  v_mov_b32 v44, 0
  v_mov_b32 v45, 0
  v_mov_b32 v46, 0
  v_mov_b32 v47, 0
  v_mov_b32 v48, 0
  v_mov_b32 v49, 0
  v_mov_b32 v50, 0
  v_mov_b32 v51, 0
  v_mov_b32 v52, 0
  v_mov_b32 v53, 0
  v_mov_b32 v54, 0
  v_mov_b32 v55, 0
  v_mov_b32 v56, 0
  v_mov_b32 v57, 0
  v_mov_b32 v58, 0
  v_mov_b32 v59, 0
  v_mov_b32 v60, 0
  v_mov_b32 v61, 0
  v_mov_b32 v62, 0
  v_mov_b32 v63, 0
  v_mov_b32 v64, 0
  v_mov_b32 v65, 0
  v_mov_b32 v66, 0
  v_mov_b32 v67, 0
  v_mov_b32 v68, 0
  v_mov_b32 v69, 0
  v_mov_b32 v70, 0
  v_mov_b32 v71, 0
  v_mov_b32 v72, 0
  v_mov_b32 v73, 0
  v_mov_b32 v74, 0
  v_mov_b32 v75, 0
  v_mov_b32 v76, 0
  v_mov_b32 v77, 0
  v_mov_b32 v78, 0
  v_mov_b32 v79, 0
  v_mov_b32 v80, 0
  v_mov_b32 v81, 0
  v_mov_b32 v82, 0
  v_mov_b32 v83, 0
  v_mov_b32 v84, 0
  v_mov_b32 v85, 0
  v_mov_b32 v86, 0
  v_mov_b32 v87, 0
  v_mov_b32 v88, 0
  v_mov_b32 v89, 0
  v_mov_b32 v90, 0
  v_mov_b32 v91, 0
  v_mov_b32 v92, 0
  v_mov_b32 v93, 0
  v_mov_b32 v94, 0
  v_mov_b32 v95, 0
  v_mov_b32 v96, 0
  v_mov_b32 v97, 0
  v_mov_b32 v98, 0
  v_mov_b32 v99, 0
  v_mov_b32 v100, 0
  v_mov_b32 v101, 0
  v_mov_b32 v102, 0
  v_mov_b32 v103, 0
  v_mov_b32 v104, 0
  v_mov_b32 v105, 0
  v_mov_b32 v106, 0
  v_mov_b32 v107, 0
  v_mov_b32 v108, 0
  v_mov_b32 v109, 0
  v_mov_b32 v110, 0
  v_mov_b32 v111, 0
  v_mov_b32 v112, 0
  v_mov_b32 v113, 0
  v_mov_b32 v114, 0
  v_mov_b32 v115, 0
  v_mov_b32 v116, 0
  v_mov_b32 v117, 0
  v_mov_b32 v118, 0
  v_mov_b32 v119, 0
  v_mov_b32 v120, 0
  v_mov_b32 v121, 0
  v_mov_b32 v122, 0
  v_mov_b32 v123, 0
  v_mov_b32 v124, 0
  v_mov_b32 v125, 0
  v_mov_b32 v126, 0
  v_mov_b32 v127, 0
  v_mov_b32 v128, 0
  v_mov_b32 v129, 0
  v_mov_b32 v130, 0
  v_mov_b32 v131, 0
  v_mov_b32 v232, 0
  v_mov_b32 v233, 0
  v_mov_b32 v234, 0
  v_mov_b32 v235, 0
  v_mov_b32 v236, 0
  v_mov_b32 v237, 0
  v_mov_b32 v238, 0
  v_mov_b32 v239, 0
  v_mov_b32 v240, 0
  v_mov_b32 v241, 0
  v_mov_b32 v242, 0
  v_mov_b32 v243, 0
  v_mov_b32 v244, 0
  v_mov_b32 v245, 0
  v_mov_b32 v246, 0
  v_mov_b32 v247, 0
  s_barrier
  ds_read_b128 v[132:135], v14 offset:0
  ds_read_b128 v[136:139], v14 offset:2048
  ds_read_b128 v[140:143], v14 offset:4096
  ds_read_b128 v[144:147], v14 offset:6144
  ds_read_b64_tr_b16 v[164:165], v16 offset:0
  ds_read_b64_tr_b16 v[166:167], v16 offset:1792
  ds_read_b64_tr_b16 v[168:169], v17 offset:0
  ds_read_b64_tr_b16 v[170:171], v17 offset:1792
  ds_read_b64_tr_b16 v[172:173], v16 offset:64
  ds_read_b64_tr_b16 v[174:175], v16 offset:1856
  ds_read_b64_tr_b16 v[176:177], v17 offset:64
  ds_read_b64_tr_b16 v[178:179], v17 offset:1856
  ds_read_b64_tr_b16 v[180:181], v16 offset:128
  ds_read_b64_tr_b16 v[182:183], v16 offset:1920
  ds_read_b64_tr_b16 v[184:185], v17 offset:128
  ds_read_b64_tr_b16 v[186:187], v17 offset:1920
  ds_read_b64_tr_b16 v[188:189], v16 offset:192
  ds_read_b64_tr_b16 v[190:191], v16 offset:1984
  ds_read_b128 v[224:227], v220 offset:0
  s_mov_b32 s20, 16
L_k5_g1_kernel_cloop_5:
  s_waitcnt lgkmcnt(0)
  v_mfma_f32_16x16x32_bf16 v[20:23], v[164:167], v[132:135], v[20:23]
  ds_read_b128 v[148:151], v15 offset:0
  v_mfma_f32_16x16x32_bf16 v[48:51], v[164:167], v[136:139], v[48:51]
  ds_read_b128 v[152:155], v15 offset:2048
  v_mfma_f32_16x16x32_bf16 v[76:79], v[164:167], v[140:143], v[76:79]
  ds_read_b128 v[156:159], v15 offset:4096
  v_mfma_f32_16x16x32_bf16 v[104:107], v[164:167], v[144:147], v[104:107]
  v_mfma_f32_16x16x32_bf16 v[232:235], v[164:167], v[224:227], v[232:235]
  ds_read_b128 v[160:163], v15 offset:6144
  v_mfma_f32_16x16x32_bf16 v[24:27], v[168:171], v[132:135], v[24:27]
  ds_read_b64_tr_b16 v[192:193], v16 offset:14336
  v_mfma_f32_16x16x32_bf16 v[52:55], v[168:171], v[136:139], v[52:55]
  ds_read_b64_tr_b16 v[194:195], v16 offset:16128
  v_mfma_f32_16x16x32_bf16 v[80:83], v[168:171], v[140:143], v[80:83]
  v_mfma_f32_16x16x32_bf16 v[108:111], v[168:171], v[144:147], v[108:111]
  ds_read_b64_tr_b16 v[196:197], v17 offset:14336
  v_mfma_f32_16x16x32_bf16 v[236:239], v[168:171], v[224:227], v[236:239]
  ds_read_b64_tr_b16 v[198:199], v17 offset:16128
  v_mfma_f32_16x16x32_bf16 v[28:31], v[172:175], v[132:135], v[28:31]
  ds_read_b64_tr_b16 v[200:201], v16 offset:14400
  v_mfma_f32_16x16x32_bf16 v[56:59], v[172:175], v[136:139], v[56:59]
  v_mfma_f32_16x16x32_bf16 v[84:87], v[172:175], v[140:143], v[84:87]
  ds_read_b64_tr_b16 v[202:203], v16 offset:16192
  v_mfma_f32_16x16x32_bf16 v[112:115], v[172:175], v[144:147], v[112:115]
  ds_read_b64_tr_b16 v[204:205], v17 offset:14400
  v_mfma_f32_16x16x32_bf16 v[240:243], v[172:175], v[224:227], v[240:243]
  ds_read_b64_tr_b16 v[206:207], v17 offset:16192
  v_mfma_f32_16x16x32_bf16 v[32:35], v[176:179], v[132:135], v[32:35]
  v_mfma_f32_16x16x32_bf16 v[60:63], v[176:179], v[136:139], v[60:63]
  ds_read_b64_tr_b16 v[208:209], v16 offset:14464
  v_mfma_f32_16x16x32_bf16 v[88:91], v[176:179], v[140:143], v[88:91]
  ds_read_b64_tr_b16 v[210:211], v16 offset:16256
  v_mfma_f32_16x16x32_bf16 v[116:119], v[176:179], v[144:147], v[116:119]
  ds_read_b64_tr_b16 v[212:213], v17 offset:14464
  v_mfma_f32_16x16x32_bf16 v[244:247], v[176:179], v[224:227], v[244:247]
  v_mfma_f32_16x16x32_bf16 v[36:39], v[180:183], v[132:135], v[36:39]
  ds_read_b64_tr_b16 v[214:215], v17 offset:16256
  v_mfma_f32_16x16x32_bf16 v[64:67], v[180:183], v[136:139], v[64:67]
  ds_read_b64_tr_b16 v[216:217], v16 offset:14528
  v_mfma_f32_16x16x32_bf16 v[92:95], v[180:183], v[140:143], v[92:95]
  ds_read_b64_tr_b16 v[218:219], v16 offset:16320
  v_mfma_f32_16x16x32_bf16 v[120:123], v[180:183], v[144:147], v[120:123]
  v_mfma_f32_16x16x32_bf16 v[40:43], v[184:187], v[132:135], v[40:43]
  ds_read_b128 v[228:231], v220 offset:64
  v_mfma_f32_16x16x32_bf16 v[68:71], v[184:187], v[136:139], v[68:71]
  v_mfma_f32_16x16x32_bf16 v[96:99], v[184:187], v[140:143], v[96:99]
  v_mfma_f32_16x16x32_bf16 v[124:127], v[184:187], v[144:147], v[124:127]
  v_mfma_f32_16x16x32_bf16 v[44:47], v[188:191], v[132:135], v[44:47]
  v_mfma_f32_16x16x32_bf16 v[72:75], v[188:191], v[136:139], v[72:75]
  v_mfma_f32_16x16x32_bf16 v[100:103], v[188:191], v[140:143], v[100:103]
  v_mfma_f32_16x16x32_bf16 v[128:131], v[188:191], v[144:147], v[128:131]
  s_waitcnt lgkmcnt(0)
  s_barrier
  v_mfma_f32_16x16x32_bf16 v[20:23], v[192:195], v[148:151], v[20:23]
  s_add_u32 s18, s18, 45056
  s_cmp_ge_u32 s18, s19
  v_mfma_f32_16x16x32_bf16 v[48:51], v[192:195], v[152:155], v[48:51]
  s_cselect_b32 s3, 135168, 0
  v_mfma_f32_16x16x32_bf16 v[76:79], v[192:195], v[156:159], v[76:79]
  s_sub_u32 s18, s18, s3
  v_mfma_f32_16x16x32_bf16 v[104:107], v[192:195], v[160:163], v[104:107]
  v_add_u32 v14, s18, v8
  v_mfma_f32_16x16x32_bf16 v[232:235], v[192:195], v[228:231], v[232:235]
  v_add_u32 v15, s18, v9
  v_mfma_f32_16x16x32_bf16 v[24:27], v[196:199], v[148:151], v[24:27]
  v_add_u32 v16, s18, v10
  v_mfma_f32_16x16x32_bf16 v[52:55], v[196:199], v[152:155], v[52:55]
  v_add_u32 v17, s18, v11
  v_mfma_f32_16x16x32_bf16 v[80:83], v[196:199], v[156:159], v[80:83]
  v_add_u32 v220, 128, v220
  v_mfma_f32_16x16x32_bf16 v[108:111], v[196:199], v[160:163], v[108:111]
  ds_read_b128 v[132:135], v14 offset:0
  v_mfma_f32_16x16x32_bf16 v[236:239], v[196:199], v[228:231], v[236:239]
  ds_read_b128 v[136:139], v14 offset:2048
  v_mfma_f32_16x16x32_bf16 v[28:31], v[200:203], v[148:151], v[28:31]
  ds_read_b128 v[140:143], v14 offset:4096
  ds_read_b128 v[144:147], v14 offset:6144
  v_mfma_f32_16x16x32_bf16 v[56:59], v[200:203], v[152:155], v[56:59]
  ds_read_b64_tr_b16 v[164:165], v16 offset:0
  v_mfma_f32_16x16x32_bf16 v[84:87], v[200:203], v[156:159], v[84:87]
  ds_read_b64_tr_b16 v[166:167], v16 offset:1792
  v_mfma_f32_16x16x32_bf16 v[112:115], v[200:203], v[160:163], v[112:115]
  ds_read_b64_tr_b16 v[168:169], v17 offset:0
  v_mfma_f32_16x16x32_bf16 v[240:243], v[200:203], v[228:231], v[240:243]
  ds_read_b64_tr_b16 v[170:171], v17 offset:1792
  v_mfma_f32_16x16x32_bf16 v[32:35], v[204:207], v[148:151], v[32:35]
  ds_read_b64_tr_b16 v[172:173], v16 offset:64
  v_mfma_f32_16x16x32_bf16 v[60:63], v[204:207], v[152:155], v[60:63]
  ds_read_b64_tr_b16 v[174:175], v16 offset:1856
  v_mfma_f32_16x16x32_bf16 v[88:91], v[204:207], v[156:159], v[88:91]
  ds_read_b64_tr_b16 v[176:177], v17 offset:64
  v_mfma_f32_16x16x32_bf16 v[116:119], v[204:207], v[160:163], v[116:119]
  ds_read_b64_tr_b16 v[178:179], v17 offset:1856
  v_mfma_f32_16x16x32_bf16 v[244:247], v[204:207], v[228:231], v[244:247]
  ds_read_b64_tr_b16 v[180:181], v16 offset:128
  v_mfma_f32_16x16x32_bf16 v[36:39], v[208:211], v[148:151], v[36:39]
  ds_read_b64_tr_b16 v[182:183], v16 offset:1920
  v_mfma_f32_16x16x32_bf16 v[64:67], v[208:211], v[152:155], v[64:67]
  ds_read_b64_tr_b16 v[184:185], v17 offset:128
  ds_read_b64_tr_b16 v[186:187], v17 offset:1920
  v_mfma_f32_16x16x32_bf16 v[92:95], v[208:211], v[156:159], v[92:95]
  ds_read_b64_tr_b16 v[188:189], v16 offset:192
  v_mfma_f32_16x16x32_bf16 v[120:123], v[208:211], v[160:163], v[120:123]
  ds_read_b64_tr_b16 v[190:191], v16 offset:1984
  v_mfma_f32_16x16x32_bf16 v[40:43], v[212:215], v[148:151], v[40:43]
  ds_read_b128 v[224:227], v220 offset:0
  v_mfma_f32_16x16x32_bf16 v[68:71], v[212:215], v[152:155], v[68:71]
  v_mfma_f32_16x16x32_bf16 v[96:99], v[212:215], v[156:159], v[96:99]
  v_mfma_f32_16x16x32_bf16 v[124:127], v[212:215], v[160:163], v[124:127]
  v_mfma_f32_16x16x32_bf16 v[44:47], v[216:219], v[148:151], v[44:47]
  v_mfma_f32_16x16x32_bf16 v[72:75], v[216:219], v[152:155], v[72:75]
  v_mfma_f32_16x16x32_bf16 v[100:103], v[216:219], v[156:159], v[100:103]
  v_mfma_f32_16x16x32_bf16 v[128:131], v[216:219], v[160:163], v[128:131]
  s_sub_u32 s20, s20, 1
  s_cmp_lg_u32 s20, 0
  s_cbranch_scc1 L_k5_g1_kernel_cloop_5
  s_waitcnt lgkmcnt(0)
  v_and_b32 v221, 15, v1
  v_mul_u32_u24 v248, 0x380, v221
  v_lshrrev_b32 v222, 4, v1
  v_lshl_add_u32 v248, v222, 4, v248
  v_and_b32 v222, 1, v3
  v_mul_u32_u24 v222, 0x1c0, v222
  v_add_u32 v248, v248, v222
  v_add_u32 v248, 0x21800, v248
  v_cmp_gt_u32 vcc, 3, v221
  s_nop 0
  s_and_saveexec_b64 s[22:23], vcc
  ds_write_b128 v248, v[232:235] offset:0
  ds_write_b128 v248, v[236:239] offset:64
  ds_write_b128 v248, v[240:243] offset:128
  ds_write_b128 v248, v[244:247] offset:192
  s_mov_b64 exec, s[22:23]
  s_branch L_k5_g1_kernel_join_4
L_k5_g1_kernel_wm1_3:
  s_mov_b32 s18, 0
  s_mov_b32 s19, 135168
  v_add_u32 v14, s18, v8
  v_add_u32 v15, s18, v9
  v_add_u32 v16, s18, v10
  v_add_u32 v17, s18, v11
  v_mov_b32 v20, 0
  v_mov_b32 v21, 0
  v_mov_b32 v22, 0
  v_mov_b32 v23, 0
  v_mov_b32 v24, 0
  v_mov_b32 v25, 0
  v_mov_b32 v26, 0
  v_mov_b32 v27, 0
  v_mov_b32 v28, 0
  v_mov_b32 v29, 0
  v_mov_b32 v30, 0
  v_mov_b32 v31, 0
  v_mov_b32 v32, 0
  v_mov_b32 v33, 0
  v_mov_b32 v34, 0
  v_mov_b32 v35, 0
  v_mov_b32 v36, 0
  v_mov_b32 v37, 0
  v_mov_b32 v38, 0
  v_mov_b32 v39, 0
  v_mov_b32 v40, 0
  v_mov_b32 v41, 0
  v_mov_b32 v42, 0
  v_mov_b32 v43, 0
  v_mov_b32 v44, 0
  v_mov_b32 v45, 0
  v_mov_b32 v46, 0
  v_mov_b32 v47, 0
  v_mov_b32 v48, 0
  v_mov_b32 v49, 0
  v_mov_b32 v50, 0
  v_mov_b32 v51, 0
  v_mov_b32 v52, 0
  v_mov_b32 v53, 0
  v_mov_b32 v54, 0
  v_mov_b32 v55, 0
  v_mov_b32 v56, 0
  v_mov_b32 v57, 0
  v_mov_b32 v58, 0
  v_mov_b32 v59, 0
  v_mov_b32 v60, 0
  v_mov_b32 v61, 0
  v_mov_b32 v62, 0
  v_mov_b32 v63, 0
  v_mov_b32 v64, 0
  v_mov_b32 v65, 0
  v_mov_b32 v66, 0
  v_mov_b32 v67, 0
  v_mov_b32 v68, 0
  v_mov_b32 v69, 0
  v_mov_b32 v70, 0
  v_mov_b32 v71, 0
  v_mov_b32 v72, 0
  v_mov_b32 v73, 0
  v_mov_b32 v74, 0
  v_mov_b32 v75, 0
  v_mov_b32 v76, 0
  v_mov_b32 v77, 0
  v_mov_b32 v78, 0
  v_mov_b32 v79, 0
  v_mov_b32 v80, 0
  v_mov_b32 v81, 0
  v_mov_b32 v82, 0
  v_mov_b32 v83, 0
  v_mov_b32 v84, 0
  v_mov_b32 v85, 0
  v_mov_b32 v86, 0
  v_mov_b32 v87, 0
  v_mov_b32 v88, 0
  v_mov_b32 v89, 0
  v_mov_b32 v90, 0
  v_mov_b32 v91, 0
  v_mov_b32 v92, 0
  v_mov_b32 v93, 0
  v_mov_b32 v94, 0
  v_mov_b32 v95, 0
  v_mov_b32 v96, 0
  v_mov_b32 v97, 0
  v_mov_b32 v98, 0
  v_mov_b32 v99, 0
  v_mov_b32 v100, 0
  v_mov_b32 v101, 0
  v_mov_b32 v102, 0
  v_mov_b32 v103, 0
  v_mov_b32 v104, 0
  v_mov_b32 v105, 0
  v_mov_b32 v106, 0
  v_mov_b32 v107, 0
  v_mov_b32 v108, 0
  v_mov_b32 v109, 0
  v_mov_b32 v110, 0
  v_mov_b32 v111, 0
  v_mov_b32 v112, 0
  v_mov_b32 v113, 0
  v_mov_b32 v114, 0
  v_mov_b32 v115, 0
  v_mov_b32 v116, 0
  v_mov_b32 v117, 0
  v_mov_b32 v118, 0
  v_mov_b32 v119, 0
  v_mov_b32 v120, 0
  v_mov_b32 v121, 0
  v_mov_b32 v122, 0
  v_mov_b32 v123, 0
  v_mov_b32 v124, 0
  v_mov_b32 v125, 0
  v_mov_b32 v126, 0
  v_mov_b32 v127, 0
  v_mov_b32 v128, 0
  v_mov_b32 v129, 0
  v_mov_b32 v130, 0
  v_mov_b32 v131, 0
  v_mov_b32 v232, 0
  v_mov_b32 v233, 0
  v_mov_b32 v234, 0
  v_mov_b32 v235, 0
  v_mov_b32 v236, 0
  v_mov_b32 v237, 0
  v_mov_b32 v238, 0
  v_mov_b32 v239, 0
  v_mov_b32 v240, 0
  v_mov_b32 v241, 0
  v_mov_b32 v242, 0
  v_mov_b32 v243, 0
  v_mov_b32 v244, 0
  v_mov_b32 v245, 0
  v_mov_b32 v246, 0
  v_mov_b32 v247, 0
  s_barrier
  ds_read_b128 v[132:135], v14 offset:0
  ds_read_b128 v[136:139], v14 offset:2048
  ds_read_b128 v[140:143], v14 offset:4096
  ds_read_b128 v[144:147], v14 offset:6144
  ds_read_b64_tr_b16 v[164:165], v16 offset:0
  ds_read_b64_tr_b16 v[166:167], v16 offset:1792
  ds_read_b64_tr_b16 v[168:169], v17 offset:0
  ds_read_b64_tr_b16 v[170:171], v17 offset:1792
  ds_read_b64_tr_b16 v[172:173], v16 offset:64
  ds_read_b64_tr_b16 v[174:175], v16 offset:1856
  ds_read_b64_tr_b16 v[176:177], v17 offset:64
  ds_read_b64_tr_b16 v[178:179], v17 offset:1856
  ds_read_b64_tr_b16 v[180:181], v16 offset:128
  ds_read_b64_tr_b16 v[182:183], v16 offset:1920
  ds_read_b64_tr_b16 v[184:185], v17 offset:128
  ds_read_b64_tr_b16 v[186:187], v17 offset:1920
  ds_read_b64_tr_b16 v[188:189], v16 offset:192
  ds_read_b64_tr_b16 v[190:191], v16 offset:1984
  ds_read_b128 v[224:227], v220 offset:0
  s_mov_b32 s20, 16
L_k5_g1_kernel_cloop_6:
  s_waitcnt lgkmcnt(0)
  v_mfma_f32_16x16x32_bf16 v[20:23], v[164:167], v[132:135], v[20:23]
  ds_read_b128 v[148:151], v15 offset:0
  v_mfma_f32_16x16x32_bf16 v[48:51], v[164:167], v[136:139], v[48:51]
  ds_read_b128 v[152:155], v15 offset:2048
  v_mfma_f32_16x16x32_bf16 v[76:79], v[164:167], v[140:143], v[76:79]
  ds_read_b128 v[156:159], v15 offset:4096
  v_mfma_f32_16x16x32_bf16 v[104:107], v[164:167], v[144:147], v[104:107]
  ds_read_b128 v[160:163], v15 offset:6144
  v_mfma_f32_16x16x32_bf16 v[24:27], v[168:171], v[132:135], v[24:27]
  v_mfma_f32_16x16x32_bf16 v[52:55], v[168:171], v[136:139], v[52:55]
  ds_read_b64_tr_b16 v[192:193], v16 offset:14336
  v_mfma_f32_16x16x32_bf16 v[80:83], v[168:171], v[140:143], v[80:83]
  ds_read_b64_tr_b16 v[194:195], v16 offset:16128
  v_mfma_f32_16x16x32_bf16 v[108:111], v[168:171], v[144:147], v[108:111]
  ds_read_b64_tr_b16 v[196:197], v17 offset:14336
  v_mfma_f32_16x16x32_bf16 v[28:31], v[172:175], v[132:135], v[28:31]
  v_mfma_f32_16x16x32_bf16 v[56:59], v[172:175], v[136:139], v[56:59]
  ds_read_b64_tr_b16 v[198:199], v17 offset:16128
  v_mfma_f32_16x16x32_bf16 v[84:87], v[172:175], v[140:143], v[84:87]
  ds_read_b64_tr_b16 v[200:201], v16 offset:14400
  v_mfma_f32_16x16x32_bf16 v[112:115], v[172:175], v[144:147], v[112:115]
  ds_read_b64_tr_b16 v[202:203], v16 offset:16192
  v_mfma_f32_16x16x32_bf16 v[32:35], v[176:179], v[132:135], v[32:35]
  v_mfma_f32_16x16x32_bf16 v[60:63], v[176:179], v[136:139], v[60:63]
  ds_read_b64_tr_b16 v[204:205], v17 offset:14400
  v_mfma_f32_16x16x32_bf16 v[88:91], v[176:179], v[140:143], v[88:91]
  ds_read_b64_tr_b16 v[206:207], v17 offset:16192
  v_mfma_f32_16x16x32_bf16 v[116:119], v[176:179], v[144:147], v[116:119]
  ds_read_b64_tr_b16 v[208:209], v16 offset:14464
  v_mfma_f32_16x16x32_bf16 v[36:39], v[180:183], v[132:135], v[36:39]
  ds_read_b64_tr_b16 v[210:211], v16 offset:16256
  v_mfma_f32_16x16x32_bf16 v[64:67], v[180:183], v[136:139], v[64:67]
  v_mfma_f32_16x16x32_bf16 v[92:95], v[180:183], v[140:143], v[92:95]
  ds_read_b64_tr_b16 v[212:213], v17 offset:14464
  v_mfma_f32_16x16x32_bf16 v[120:123], v[180:183], v[144:147], v[120:123]
  ds_read_b64_tr_b16 v[214:215], v17 offset:16256
  v_mfma_f32_16x16x32_bf16 v[232:235], v[180:183], v[224:227], v[232:235]
  ds_read_b64_tr_b16 v[216:217], v16 offset:14528
  v_mfma_f32_16x16x32_bf16 v[40:43], v[184:187], v[132:135], v[40:43]
  v_mfma_f32_16x16x32_bf16 v[68:71], v[184:187], v[136:139], v[68:71]
  ds_read_b64_tr_b16 v[218:219], v16 offset:16320
  v_mfma_f32_16x16x32_bf16 v[96:99], v[184:187], v[140:143], v[96:99]
  ds_read_b128 v[228:231], v220 offset:64
  v_mfma_f32_16x16x32_bf16 v[124:127], v[184:187], v[144:147], v[124:127]
  v_mfma_f32_16x16x32_bf16 v[236:239], v[184:187], v[224:227], v[236:239]
  v_mfma_f32_16x16x32_bf16 v[44:47], v[188:191], v[132:135], v[44:47]
  v_mfma_f32_16x16x32_bf16 v[72:75], v[188:191], v[136:139], v[72:75]
  v_mfma_f32_16x16x32_bf16 v[100:103], v[188:191], v[140:143], v[100:103]
  v_mfma_f32_16x16x32_bf16 v[128:131], v[188:191], v[144:147], v[128:131]
  v_mfma_f32_16x16x32_bf16 v[240:243], v[188:191], v[224:227], v[240:243]
  s_waitcnt lgkmcnt(0)
  s_barrier
  v_mfma_f32_16x16x32_bf16 v[20:23], v[192:195], v[148:151], v[20:23]
  s_add_u32 s18, s18, 45056
  s_cmp_ge_u32 s18, s19
  v_mfma_f32_16x16x32_bf16 v[48:51], v[192:195], v[152:155], v[48:51]
  s_cselect_b32 s3, 135168, 0
  v_mfma_f32_16x16x32_bf16 v[76:79], v[192:195], v[156:159], v[76:79]
  s_sub_u32 s18, s18, s3
  v_mfma_f32_16x16x32_bf16 v[104:107], v[192:195], v[160:163], v[104:107]
  v_add_u32 v14, s18, v8
  v_mfma_f32_16x16x32_bf16 v[24:27], v[196:199], v[148:151], v[24:27]
  v_add_u32 v15, s18, v9
  v_mfma_f32_16x16x32_bf16 v[52:55], v[196:199], v[152:155], v[52:55]
  v_add_u32 v16, s18, v10
  v_mfma_f32_16x16x32_bf16 v[80:83], v[196:199], v[156:159], v[80:83]
  v_add_u32 v17, s18, v11
  v_mfma_f32_16x16x32_bf16 v[108:111], v[196:199], v[160:163], v[108:111]
  v_add_u32 v220, 128, v220
  ds_read_b128 v[132:135], v14 offset:0
  v_mfma_f32_16x16x32_bf16 v[28:31], v[200:203], v[148:151], v[28:31]
  ds_read_b128 v[136:139], v14 offset:2048
  v_mfma_f32_16x16x32_bf16 v[56:59], v[200:203], v[152:155], v[56:59]
  ds_read_b128 v[140:143], v14 offset:4096
  v_mfma_f32_16x16x32_bf16 v[84:87], v[200:203], v[156:159], v[84:87]
  ds_read_b128 v[144:147], v14 offset:6144
  v_mfma_f32_16x16x32_bf16 v[112:115], v[200:203], v[160:163], v[112:115]
  ds_read_b64_tr_b16 v[164:165], v16 offset:0
  v_mfma_f32_16x16x32_bf16 v[32:35], v[204:207], v[148:151], v[32:35]
  ds_read_b64_tr_b16 v[166:167], v16 offset:1792
  v_mfma_f32_16x16x32_bf16 v[60:63], v[204:207], v[152:155], v[60:63]
  ds_read_b64_tr_b16 v[168:169], v17 offset:0
  v_mfma_f32_16x16x32_bf16 v[88:91], v[204:207], v[156:159], v[88:91]
  ds_read_b64_tr_b16 v[170:171], v17 offset:1792
  v_mfma_f32_16x16x32_bf16 v[116:119], v[204:207], v[160:163], v[116:119]
  ds_read_b64_tr_b16 v[172:173], v16 offset:64
  ds_read_b64_tr_b16 v[174:175], v16 offset:1856
  v_mfma_f32_16x16x32_bf16 v[36:39], v[208:211], v[148:151], v[36:39]
  ds_read_b64_tr_b16 v[176:177], v17 offset:64
  v_mfma_f32_16x16x32_bf16 v[64:67], v[208:211], v[152:155], v[64:67]
  ds_read_b64_tr_b16 v[178:179], v17 offset:1856
  v_mfma_f32_16x16x32_bf16 v[92:95], v[208:211], v[156:159], v[92:95]
  ds_read_b64_tr_b16 v[180:181], v16 offset:128
  v_mfma_f32_16x16x32_bf16 v[120:123], v[208:211], v[160:163], v[120:123]
  ds_read_b64_tr_b16 v[182:183], v16 offset:1920
  v_mfma_f32_16x16x32_bf16 v[232:235], v[208:211], v[228:231], v[232:235]
  ds_read_b64_tr_b16 v[184:185], v17 offset:128
  v_mfma_f32_16x16x32_bf16 v[40:43], v[212:215], v[148:151], v[40:43]
  ds_read_b64_tr_b16 v[186:187], v17 offset:1920
  v_mfma_f32_16x16x32_bf16 v[68:71], v[212:215], v[152:155], v[68:71]
  ds_read_b64_tr_b16 v[188:189], v16 offset:192
  v_mfma_f32_16x16x32_bf16 v[96:99], v[212:215], v[156:159], v[96:99]
  ds_read_b64_tr_b16 v[190:191], v16 offset:1984
  ds_read_b128 v[224:227], v220 offset:0
  v_mfma_f32_16x16x32_bf16 v[124:127], v[212:215], v[160:163], v[124:127]
  v_mfma_f32_16x16x32_bf16 v[236:239], v[212:215], v[228:231], v[236:239]
  v_mfma_f32_16x16x32_bf16 v[44:47], v[216:219], v[148:151], v[44:47]
  v_mfma_f32_16x16x32_bf16 v[72:75], v[216:219], v[152:155], v[72:75]
  v_mfma_f32_16x16x32_bf16 v[100:103], v[216:219], v[156:159], v[100:103]
  v_mfma_f32_16x16x32_bf16 v[128:131], v[216:219], v[160:163], v[128:131]
  v_mfma_f32_16x16x32_bf16 v[240:243], v[216:219], v[228:231], v[240:243]
  s_sub_u32 s20, s20, 1
  s_cmp_lg_u32 s20, 0
  s_cbranch_scc1 L_k5_g1_kernel_cloop_6
  s_waitcnt lgkmcnt(0)
  v_and_b32 v221, 15, v1
  v_mul_u32_u24 v248, 0x380, v221
  v_lshrrev_b32 v222, 4, v1
  v_lshl_add_u32 v248, v222, 4, v248
  v_and_b32 v222, 1, v3
  v_mul_u32_u24 v222, 0x1c0, v222
  v_add_u32 v248, v248, v222
  v_add_u32 v248, 0x21800, v248
  v_cmp_gt_u32 vcc, 3, v221
  s_nop 0
  s_and_saveexec_b64 s[24:25], vcc
  ds_write_b128 v248, v[232:235] offset:256
  ds_write_b128 v248, v[236:239] offset:320
  ds_write_b128 v248, v[240:243] offset:384
  s_mov_b64 exec, s[24:25]
L_k5_g1_kernel_join_4:
  s_waitcnt lgkmcnt(0)
  s_barrier
  v_and_b32 v221, 15, v1
  v_lshrrev_b32 v222, 1, v3
  v_lshl_add_u32 v221, v222, 6, v221
  v_lshlrev_b32 v249, 4, v221
  v_add_u32 v249, 0x21000, v249
  v_mul_u32_u24 v251, 0x1d0, v221
  v_lshrrev_b32 v221, 4, v1
  v_and_b32 v222, 1, v3
  v_mul_u32_u24 v222, 0x70, v222
  v_lshl_add_u32 v222, v221, 2, v222
  v_lshlrev_b32 v250, 2, v222
  v_add_u32 v250, 0x21800, v250
  v_lshl_add_u32 v251, v222, 1, v251
  ds_read_b128 v[132:135], v249 offset:0
  ds_read_b128 v[136:139], v249 offset:256
  ds_read_b128 v[140:143], v249 offset:512
  ds_read_b128 v[144:147], v249 offset:768
  s_mov_b32 s28, 0xc0135761
  s_mov_b32 s29, 0xc0135761
  v_mov_b32 v180, 0xbdd2d3e8
  v_mov_b32 v181, 0xbdd2d3e8
  ds_read_b128 v[164:167], v250 offset:0
  ds_read_b128 v[168:171], v250 offset:896
  ds_read_b128 v[172:175], v250 offset:1792
  ds_read_b128 v[176:179], v250 offset:2688
  ds_read_b128 v[192:195], v250 offset:64
  ds_read_b128 v[196:199], v250 offset:960
  ds_read_b128 v[200:203], v250 offset:1856
  ds_read_b128 v[204:207], v250 offset:2752
  s_waitcnt lgkmcnt(4)
  v_pk_fma_f32 v[148:149], v[134:135], v[172:173], v[176:177] op_sel:[1,0,0] op_sel_hi:[1,1,1]
  v_pk_fma_f32 v[150:151], v[134:135], v[174:175], v[178:179] op_sel:[1,0,0] op_sel_hi:[1,1,1]
  v_pk_fma_f32 v[156:157], v[138:139], v[172:173], v[176:177] op_sel:[1,0,0] op_sel_hi:[1,1,1]
  v_pk_fma_f32 v[158:159], v[138:139], v[174:175], v[178:179] op_sel:[1,0,0] op_sel_hi:[1,1,1]
  v_pk_fma_f32 v[148:149], v[134:135], v[168:169], v[148:149] op_sel:[0,0,0] op_sel_hi:[0,1,1]
  v_pk_fma_f32 v[150:151], v[134:135], v[170:171], v[150:151] op_sel:[0,0,0] op_sel_hi:[0,1,1]
  v_pk_fma_f32 v[156:157], v[138:139], v[168:169], v[156:157] op_sel:[0,0,0] op_sel_hi:[0,1,1]
  v_pk_fma_f32 v[158:159], v[138:139], v[170:171], v[158:159] op_sel:[0,0,0] op_sel_hi:[0,1,1]
  v_pk_fma_f32 v[148:149], v[132:133], v[164:165], v[148:149] op_sel:[1,0,0] op_sel_hi:[1,1,1]
  v_pk_fma_f32 v[150:151], v[132:133], v[166:167], v[150:151] op_sel:[1,0,0] op_sel_hi:[1,1,1]
  v_pk_fma_f32 v[156:157], v[136:137], v[164:165], v[156:157] op_sel:[1,0,0] op_sel_hi:[1,1,1]
  v_pk_fma_f32 v[158:159], v[136:137], v[166:167], v[158:159] op_sel:[1,0,0] op_sel_hi:[1,1,1]
  v_pk_fma_f32 v[148:149], v[132:133], v[20:21], v[148:149] op_sel:[0,0,0] op_sel_hi:[0,1,1]
  v_pk_fma_f32 v[150:151], v[132:133], v[22:23], v[150:151] op_sel:[0,0,0] op_sel_hi:[0,1,1]
  v_pk_fma_f32 v[156:157], v[136:137], v[48:49], v[156:157] op_sel:[0,0,0] op_sel_hi:[0,1,1]
  v_pk_fma_f32 v[158:159], v[136:137], v[50:51], v[158:159] op_sel:[0,0,0] op_sel_hi:[0,1,1]
  v_pk_mul_f32 v[152:153], v[148:149], v[148:149]
  v_pk_mul_f32 v[154:155], v[150:151], v[150:151]
  v_pk_mul_f32 v[160:161], v[156:157], v[156:157]
  v_pk_mul_f32 v[162:163], v[158:159], v[158:159]
  v_pk_fma_f32 v[152:153], v[152:153], v[180:181], s[28:29]
  v_pk_fma_f32 v[154:155], v[154:155], v[180:181], s[28:29]
  v_pk_fma_f32 v[160:161], v[160:161], v[180:181], s[28:29]
  v_pk_fma_f32 v[162:163], v[162:163], v[180:181], s[28:29]
  v_pk_mul_f32 v[152:153], v[152:153], v[148:149]
  v_pk_mul_f32 v[154:155], v[154:155], v[150:151]
  v_pk_mul_f32 v[160:161], v[160:161], v[156:157]
  v_pk_mul_f32 v[162:163], v[162:163], v[158:159]
  v_exp_f32 v152, v152
  v_exp_f32 v153, v153
  v_exp_f32 v154, v154
  v_exp_f32 v155, v155
  v_exp_f32 v160, v160
  v_exp_f32 v161, v161
  v_exp_f32 v162, v162
  v_exp_f32 v163, v163
  v_pk_add_f32 v[152:153], v[152:153], 1.0 op_sel_hi:[1,0]
  v_pk_add_f32 v[154:155], v[154:155], 1.0 op_sel_hi:[1,0]
  v_pk_add_f32 v[160:161], v[160:161], 1.0 op_sel_hi:[1,0]
  v_pk_add_f32 v[162:163], v[162:163], 1.0 op_sel_hi:[1,0]
  v_rcp_f32 v152, v152
  v_rcp_f32 v153, v153
  v_rcp_f32 v154, v154
  v_rcp_f32 v155, v155
  v_rcp_f32 v160, v160
  v_rcp_f32 v161, v161
  v_rcp_f32 v162, v162
  v_rcp_f32 v163, v163
  v_pk_mul_f32 v[148:149], v[148:149], v[152:153]
  v_pk_mul_f32 v[150:151], v[150:151], v[154:155]
  v_pk_mul_f32 v[156:157], v[156:157], v[160:161]
  v_pk_mul_f32 v[158:159], v[158:159], v[162:163]
  v_cvt_pk_bf16_f32 v152, v148, v149
  v_cvt_pk_bf16_f32 v153, v150, v151
  v_cvt_pk_bf16_f32 v160, v156, v157
  v_cvt_pk_bf16_f32 v161, v158, v159
  ds_write_b64 v251, v[152:153] offset:0
  ds_write_b64 v251, v[160:161] offset:7424
  v_pk_fma_f32 v[148:149], v[142:143], v[172:173], v[176:177] op_sel:[1,0,0] op_sel_hi:[1,1,1]
  v_pk_fma_f32 v[150:151], v[142:143], v[174:175], v[178:179] op_sel:[1,0,0] op_sel_hi:[1,1,1]
  v_pk_fma_f32 v[156:157], v[146:147], v[172:173], v[176:177] op_sel:[1,0,0] op_sel_hi:[1,1,1]
  v_pk_fma_f32 v[158:159], v[146:147], v[174:175], v[178:179] op_sel:[1,0,0] op_sel_hi:[1,1,1]
  v_pk_fma_f32 v[148:149], v[142:143], v[168:169], v[148:149] op_sel:[0,0,0] op_sel_hi:[0,1,1]
  v_pk_fma_f32 v[150:151], v[142:143], v[170:171], v[150:151] op_sel:[0,0,0] op_sel_hi:[0,1,1]
  v_pk_fma_f32 v[156:157], v[146:147], v[168:169], v[156:157] op_sel:[0,0,0] op_sel_hi:[0,1,1]
  v_pk_fma_f32 v[158:159], v[146:147], v[170:171], v[158:159] op_sel:[0,0,0] op_sel_hi:[0,1,1]
  v_pk_fma_f32 v[148:149], v[140:141], v[164:165], v[148:149] op_sel:[1,0,0] op_sel_hi:[1,1,1]
  v_pk_fma_f32 v[150:151], v[140:141], v[166:167], v[150:151] op_sel:[1,0,0] op_sel_hi:[1,1,1]
  v_pk_fma_f32 v[156:157], v[144:145], v[164:165], v[156:157] op_sel:[1,0,0] op_sel_hi:[1,1,1]
  v_pk_fma_f32 v[158:159], v[144:145], v[166:167], v[158:159] op_sel:[1,0,0] op_sel_hi:[1,1,1]
  v_pk_fma_f32 v[148:149], v[140:141], v[76:77], v[148:149] op_sel:[0,0,0] op_sel_hi:[0,1,1]
  v_pk_fma_f32 v[150:151], v[140:141], v[78:79], v[150:151] op_sel:[0,0,0] op_sel_hi:[0,1,1]
  v_pk_fma_f32 v[156:157], v[144:145], v[104:105], v[156:157] op_sel:[0,0,0] op_sel_hi:[0,1,1]
  v_pk_fma_f32 v[158:159], v[144:145], v[106:107], v[158:159] op_sel:[0,0,0] op_sel_hi:[0,1,1]
  v_pk_mul_f32 v[152:153], v[148:149], v[148:149]
  v_pk_mul_f32 v[154:155], v[150:151], v[150:151]
  v_pk_mul_f32 v[160:161], v[156:157], v[156:157]
  v_pk_mul_f32 v[162:163], v[158:159], v[158:159]
  v_pk_fma_f32 v[152:153], v[152:153], v[180:181], s[28:29]
  v_pk_fma_f32 v[154:155], v[154:155], v[180:181], s[28:29]
  v_pk_fma_f32 v[160:161], v[160:161], v[180:181], s[28:29]
  v_pk_fma_f32 v[162:163], v[162:163], v[180:181], s[28:29]
  v_pk_mul_f32 v[152:153], v[152:153], v[148:149]
  v_pk_mul_f32 v[154:155], v[154:155], v[150:151]
  v_pk_mul_f32 v[160:161], v[160:161], v[156:157]
  v_pk_mul_f32 v[162:163], v[162:163], v[158:159]
  v_exp_f32 v152, v152
  v_exp_f32 v153, v153
  v_exp_f32 v154, v154
  v_exp_f32 v155, v155
  v_exp_f32 v160, v160
  v_exp_f32 v161, v161
  v_exp_f32 v162, v162
  v_exp_f32 v163, v163
  v_pk_add_f32 v[152:153], v[152:153], 1.0 op_sel_hi:[1,0]
  v_pk_add_f32 v[154:155], v[154:155], 1.0 op_sel_hi:[1,0]
  v_pk_add_f32 v[160:161], v[160:161], 1.0 op_sel_hi:[1,0]
  v_pk_add_f32 v[162:163], v[162:163], 1.0 op_sel_hi:[1,0]
  v_rcp_f32 v152, v152
  v_rcp_f32 v153, v153
  v_rcp_f32 v154, v154
  v_rcp_f32 v155, v155
  v_rcp_f32 v160, v160
  v_rcp_f32 v161, v161
  v_rcp_f32 v162, v162
  v_rcp_f32 v163, v163
  v_pk_mul_f32 v[148:149], v[148:149], v[152:153]
  v_pk_mul_f32 v[150:151], v[150:151], v[154:155]
  v_pk_mul_f32 v[156:157], v[156:157], v[160:161]
  v_pk_mul_f32 v[158:159], v[158:159], v[162:163]
  v_cvt_pk_bf16_f32 v152, v148, v149
  v_cvt_pk_bf16_f32 v153, v150, v151
  v_cvt_pk_bf16_f32 v160, v156, v157
  v_cvt_pk_bf16_f32 v161, v158, v159
  ds_write_b64 v251, v[152:153] offset:14848
  ds_write_b64 v251, v[160:161] offset:22272
  ds_read_b128 v[164:167], v250 offset:128
  ds_read_b128 v[168:171], v250 offset:1024
  ds_read_b128 v[172:175], v250 offset:1920
  ds_read_b128 v[176:179], v250 offset:2816
  s_waitcnt lgkmcnt(4)
  v_pk_fma_f32 v[148:149], v[134:135], v[200:201], v[204:205] op_sel:[1,0,0] op_sel_hi:[1,1,1]
  v_pk_fma_f32 v[150:151], v[134:135], v[202:203], v[206:207] op_sel:[1,0,0] op_sel_hi:[1,1,1]
  v_pk_fma_f32 v[156:157], v[138:139], v[200:201], v[204:205] op_sel:[1,0,0] op_sel_hi:[1,1,1]
  v_pk_fma_f32 v[158:159], v[138:139], v[202:203], v[206:207] op_sel:[1,0,0] op_sel_hi:[1,1,1]
  v_pk_fma_f32 v[148:149], v[134:135], v[196:197], v[148:149] op_sel:[0,0,0] op_sel_hi:[0,1,1]
  v_pk_fma_f32 v[150:151], v[134:135], v[198:199], v[150:151] op_sel:[0,0,0] op_sel_hi:[0,1,1]
  v_pk_fma_f32 v[156:157], v[138:139], v[196:197], v[156:157] op_sel:[0,0,0] op_sel_hi:[0,1,1]
  v_pk_fma_f32 v[158:159], v[138:139], v[198:199], v[158:159] op_sel:[0,0,0] op_sel_hi:[0,1,1]
  v_pk_fma_f32 v[148:149], v[132:133], v[192:193], v[148:149] op_sel:[1,0,0] op_sel_hi:[1,1,1]
  v_pk_fma_f32 v[150:151], v[132:133], v[194:195], v[150:151] op_sel:[1,0,0] op_sel_hi:[1,1,1]
  v_pk_fma_f32 v[156:157], v[136:137], v[192:193], v[156:157] op_sel:[1,0,0] op_sel_hi:[1,1,1]
  v_pk_fma_f32 v[158:159], v[136:137], v[194:195], v[158:159] op_sel:[1,0,0] op_sel_hi:[1,1,1]
  v_pk_fma_f32 v[148:149], v[132:133], v[24:25], v[148:149] op_sel:[0,0,0] op_sel_hi:[0,1,1]
  v_pk_fma_f32 v[150:151], v[132:133], v[26:27], v[150:151] op_sel:[0,0,0] op_sel_hi:[0,1,1]
  v_pk_fma_f32 v[156:157], v[136:137], v[52:53], v[156:157] op_sel:[0,0,0] op_sel_hi:[0,1,1]
  v_pk_fma_f32 v[158:159], v[136:137], v[54:55], v[158:159] op_sel:[0,0,0] op_sel_hi:[0,1,1]
  v_pk_mul_f32 v[152:153], v[148:149], v[148:149]
  v_pk_mul_f32 v[154:155], v[150:151], v[150:151]
  v_pk_mul_f32 v[160:161], v[156:157], v[156:157]
  v_pk_mul_f32 v[162:163], v[158:159], v[158:159]
  v_pk_fma_f32 v[152:153], v[152:153], v[180:181], s[28:29]
  v_pk_fma_f32 v[154:155], v[154:155], v[180:181], s[28:29]
  v_pk_fma_f32 v[160:161], v[160:161], v[180:181], s[28:29]
  v_pk_fma_f32 v[162:163], v[162:163], v[180:181], s[28:29]
  v_pk_mul_f32 v[152:153], v[152:153], v[148:149]
  v_pk_mul_f32 v[154:155], v[154:155], v[150:151]
  v_pk_mul_f32 v[160:161], v[160:161], v[156:157]
  v_pk_mul_f32 v[162:163], v[162:163], v[158:159]
  v_exp_f32 v152, v152
  v_exp_f32 v153, v153
  v_exp_f32 v154, v154
  v_exp_f32 v155, v155
  v_exp_f32 v160, v160
  v_exp_f32 v161, v161
  v_exp_f32 v162, v162
  v_exp_f32 v163, v163
  v_pk_add_f32 v[152:153], v[152:153], 1.0 op_sel_hi:[1,0]
  v_pk_add_f32 v[154:155], v[154:155], 1.0 op_sel_hi:[1,0]
  v_pk_add_f32 v[160:161], v[160:161], 1.0 op_sel_hi:[1,0]
  v_pk_add_f32 v[162:163], v[162:163], 1.0 op_sel_hi:[1,0]
  v_rcp_f32 v152, v152
  v_rcp_f32 v153, v153
  v_rcp_f32 v154, v154
  v_rcp_f32 v155, v155
  v_rcp_f32 v160, v160
  v_rcp_f32 v161, v161
  v_rcp_f32 v162, v162
  v_rcp_f32 v163, v163
  v_pk_mul_f32 v[148:149], v[148:149], v[152:153]
  v_pk_mul_f32 v[150:151], v[150:151], v[154:155]
  v_pk_mul_f32 v[156:157], v[156:157], v[160:161]
  v_pk_mul_f32 v[158:159], v[158:159], v[162:163]
  v_cvt_pk_bf16_f32 v152, v148, v149
  v_cvt_pk_bf16_f32 v153, v150, v151
  v_cvt_pk_bf16_f32 v160, v156, v157
  v_cvt_pk_bf16_f32 v161, v158, v159
  ds_write_b64 v251, v[152:153] offset:32
  ds_write_b64 v251, v[160:161] offset:7456
  v_pk_fma_f32 v[148:149], v[142:143], v[200:201], v[204:205] op_sel:[1,0,0] op_sel_hi:[1,1,1]
  v_pk_fma_f32 v[150:151], v[142:143], v[202:203], v[206:207] op_sel:[1,0,0] op_sel_hi:[1,1,1]
  v_pk_fma_f32 v[156:157], v[146:147], v[200:201], v[204:205] op_sel:[1,0,0] op_sel_hi:[1,1,1]
  v_pk_fma_f32 v[158:159], v[146:147], v[202:203], v[206:207] op_sel:[1,0,0] op_sel_hi:[1,1,1]
  v_pk_fma_f32 v[148:149], v[142:143], v[196:197], v[148:149] op_sel:[0,0,0] op_sel_hi:[0,1,1]
  v_pk_fma_f32 v[150:151], v[142:143], v[198:199], v[150:151] op_sel:[0,0,0] op_sel_hi:[0,1,1]
  v_pk_fma_f32 v[156:157], v[146:147], v[196:197], v[156:157] op_sel:[0,0,0] op_sel_hi:[0,1,1]
  v_pk_fma_f32 v[158:159], v[146:147], v[198:199], v[158:159] op_sel:[0,0,0] op_sel_hi:[0,1,1]
  v_pk_fma_f32 v[148:149], v[140:141], v[192:193], v[148:149] op_sel:[1,0,0] op_sel_hi:[1,1,1]
  v_pk_fma_f32 v[150:151], v[140:141], v[194:195], v[150:151] op_sel:[1,0,0] op_sel_hi:[1,1,1]
  v_pk_fma_f32 v[156:157], v[144:145], v[192:193], v[156:157] op_sel:[1,0,0] op_sel_hi:[1,1,1]
  v_pk_fma_f32 v[158:159], v[144:145], v[194:195], v[158:159] op_sel:[1,0,0] op_sel_hi:[1,1,1]
  v_pk_fma_f32 v[148:149], v[140:141], v[80:81], v[148:149] op_sel:[0,0,0] op_sel_hi:[0,1,1]
  v_pk_fma_f32 v[150:151], v[140:141], v[82:83], v[150:151] op_sel:[0,0,0] op_sel_hi:[0,1,1]
  v_pk_fma_f32 v[156:157], v[144:145], v[108:109], v[156:157] op_sel:[0,0,0] op_sel_hi:[0,1,1]
  v_pk_fma_f32 v[158:159], v[144:145], v[110:111], v[158:159] op_sel:[0,0,0] op_sel_hi:[0,1,1]
  v_pk_mul_f32 v[152:153], v[148:149], v[148:149]
  v_pk_mul_f32 v[154:155], v[150:151], v[150:151]
  v_pk_mul_f32 v[160:161], v[156:157], v[156:157]
  v_pk_mul_f32 v[162:163], v[158:159], v[158:159]
  v_pk_fma_f32 v[152:153], v[152:153], v[180:181], s[28:29]
  v_pk_fma_f32 v[154:155], v[154:155], v[180:181], s[28:29]
  v_pk_fma_f32 v[160:161], v[160:161], v[180:181], s[28:29]
  v_pk_fma_f32 v[162:163], v[162:163], v[180:181], s[28:29]
  v_pk_mul_f32 v[152:153], v[152:153], v[148:149]
  v_pk_mul_f32 v[154:155], v[154:155], v[150:151]
  v_pk_mul_f32 v[160:161], v[160:161], v[156:157]
  v_pk_mul_f32 v[162:163], v[162:163], v[158:159]
  v_exp_f32 v152, v152
  v_exp_f32 v153, v153
  v_exp_f32 v154, v154
  v_exp_f32 v155, v155
  v_exp_f32 v160, v160
  v_exp_f32 v161, v161
  v_exp_f32 v162, v162
  v_exp_f32 v163, v163
  v_pk_add_f32 v[152:153], v[152:153], 1.0 op_sel_hi:[1,0]
  v_pk_add_f32 v[154:155], v[154:155], 1.0 op_sel_hi:[1,0]
  v_pk_add_f32 v[160:161], v[160:161], 1.0 op_sel_hi:[1,0]
  v_pk_add_f32 v[162:163], v[162:163], 1.0 op_sel_hi:[1,0]
  v_rcp_f32 v152, v152
  v_rcp_f32 v153, v153
  v_rcp_f32 v154, v154
  v_rcp_f32 v155, v155
  v_rcp_f32 v160, v160
  v_rcp_f32 v161, v161
  v_rcp_f32 v162, v162
  v_rcp_f32 v163, v163
  v_pk_mul_f32 v[148:149], v[148:149], v[152:153]
  v_pk_mul_f32 v[150:151], v[150:151], v[154:155]
  v_pk_mul_f32 v[156:157], v[156:157], v[160:161]
  v_pk_mul_f32 v[158:159], v[158:159], v[162:163]
  v_cvt_pk_bf16_f32 v152, v148, v149
  v_cvt_pk_bf16_f32 v153, v150, v151
  v_cvt_pk_bf16_f32 v160, v156, v157
  v_cvt_pk_bf16_f32 v161, v158, v159
  ds_write_b64 v251, v[152:153] offset:14880
  ds_write_b64 v251, v[160:161] offset:22304
  ds_read_b128 v[192:195], v250 offset:192
  ds_read_b128 v[196:199], v250 offset:1088
  ds_read_b128 v[200:203], v250 offset:1984
  ds_read_b128 v[204:207], v250 offset:2880
  s_waitcnt lgkmcnt(4)
  v_pk_fma_f32 v[148:149], v[134:135], v[172:173], v[176:177] op_sel:[1,0,0] op_sel_hi:[1,1,1]
  v_pk_fma_f32 v[150:151], v[134:135], v[174:175], v[178:179] op_sel:[1,0,0] op_sel_hi:[1,1,1]
  v_pk_fma_f32 v[156:157], v[138:139], v[172:173], v[176:177] op_sel:[1,0,0] op_sel_hi:[1,1,1]
  v_pk_fma_f32 v[158:159], v[138:139], v[174:175], v[178:179] op_sel:[1,0,0] op_sel_hi:[1,1,1]
  v_pk_fma_f32 v[148:149], v[134:135], v[168:169], v[148:149] op_sel:[0,0,0] op_sel_hi:[0,1,1]
  v_pk_fma_f32 v[150:151], v[134:135], v[170:171], v[150:151] op_sel:[0,0,0] op_sel_hi:[0,1,1]
  v_pk_fma_f32 v[156:157], v[138:139], v[168:169], v[156:157] op_sel:[0,0,0] op_sel_hi:[0,1,1]
  v_pk_fma_f32 v[158:159], v[138:139], v[170:171], v[158:159] op_sel:[0,0,0] op_sel_hi:[0,1,1]
  v_pk_fma_f32 v[148:149], v[132:133], v[164:165], v[148:149] op_sel:[1,0,0] op_sel_hi:[1,1,1]
  v_pk_fma_f32 v[150:151], v[132:133], v[166:167], v[150:151] op_sel:[1,0,0] op_sel_hi:[1,1,1]
  v_pk_fma_f32 v[156:157], v[136:137], v[164:165], v[156:157] op_sel:[1,0,0] op_sel_hi:[1,1,1]
  v_pk_fma_f32 v[158:159], v[136:137], v[166:167], v[158:159] op_sel:[1,0,0] op_sel_hi:[1,1,1]
  v_pk_fma_f32 v[148:149], v[132:133], v[28:29], v[148:149] op_sel:[0,0,0] op_sel_hi:[0,1,1]
  v_pk_fma_f32 v[150:151], v[132:133], v[30:31], v[150:151] op_sel:[0,0,0] op_sel_hi:[0,1,1]
  v_pk_fma_f32 v[156:157], v[136:137], v[56:57], v[156:157] op_sel:[0,0,0] op_sel_hi:[0,1,1]
  v_pk_fma_f32 v[158:159], v[136:137], v[58:59], v[158:159] op_sel:[0,0,0] op_sel_hi:[0,1,1]
  v_pk_mul_f32 v[152:153], v[148:149], v[148:149]
  v_pk_mul_f32 v[154:155], v[150:151], v[150:151]
  v_pk_mul_f32 v[160:161], v[156:157], v[156:157]
  v_pk_mul_f32 v[162:163], v[158:159], v[158:159]
  v_pk_fma_f32 v[152:153], v[152:153], v[180:181], s[28:29]
  v_pk_fma_f32 v[154:155], v[154:155], v[180:181], s[28:29]
  v_pk_fma_f32 v[160:161], v[160:161], v[180:181], s[28:29]
  v_pk_fma_f32 v[162:163], v[162:163], v[180:181], s[28:29]
  v_pk_mul_f32 v[152:153], v[152:153], v[148:149]
  v_pk_mul_f32 v[154:155], v[154:155], v[150:151]
  v_pk_mul_f32 v[160:161], v[160:161], v[156:157]
  v_pk_mul_f32 v[162:163], v[162:163], v[158:159]
  v_exp_f32 v152, v152
  v_exp_f32 v153, v153
  v_exp_f32 v154, v154
  v_exp_f32 v155, v155
  v_exp_f32 v160, v160
  v_exp_f32 v161, v161
  v_exp_f32 v162, v162
  v_exp_f32 v163, v163
  v_pk_add_f32 v[152:153], v[152:153], 1.0 op_sel_hi:[1,0]
  v_pk_add_f32 v[154:155], v[154:155], 1.0 op_sel_hi:[1,0]
  v_pk_add_f32 v[160:161], v[160:161], 1.0 op_sel_hi:[1,0]
  v_pk_add_f32 v[162:163], v[162:163], 1.0 op_sel_hi:[1,0]
  v_rcp_f32 v152, v152
  v_rcp_f32 v153, v153
  v_rcp_f32 v154, v154
  v_rcp_f32 v155, v155
  v_rcp_f32 v160, v160
  v_rcp_f32 v161, v161
  v_rcp_f32 v162, v162
  v_rcp_f32 v163, v163
  v_pk_mul_f32 v[148:149], v[148:149], v[152:153]
  v_pk_mul_f32 v[150:151], v[150:151], v[154:155]
  v_pk_mul_f32 v[156:157], v[156:157], v[160:161]
  v_pk_mul_f32 v[158:159], v[158:159], v[162:163]
  v_cvt_pk_bf16_f32 v152, v148, v149
  v_cvt_pk_bf16_f32 v153, v150, v151
  v_cvt_pk_bf16_f32 v160, v156, v157
  v_cvt_pk_bf16_f32 v161, v158, v159
  ds_write_b64 v251, v[152:153] offset:64
  ds_write_b64 v251, v[160:161] offset:7488
  v_pk_fma_f32 v[148:149], v[142:143], v[172:173], v[176:177] op_sel:[1,0,0] op_sel_hi:[1,1,1]
  v_pk_fma_f32 v[150:151], v[142:143], v[174:175], v[178:179] op_sel:[1,0,0] op_sel_hi:[1,1,1]
  v_pk_fma_f32 v[156:157], v[146:147], v[172:173], v[176:177] op_sel:[1,0,0] op_sel_hi:[1,1,1]
  v_pk_fma_f32 v[158:159], v[146:147], v[174:175], v[178:179] op_sel:[1,0,0] op_sel_hi:[1,1,1]
  v_pk_fma_f32 v[148:149], v[142:143], v[168:169], v[148:149] op_sel:[0,0,0] op_sel_hi:[0,1,1]
  v_pk_fma_f32 v[150:151], v[142:143], v[170:171], v[150:151] op_sel:[0,0,0] op_sel_hi:[0,1,1]
  v_pk_fma_f32 v[156:157], v[146:147], v[168:169], v[156:157] op_sel:[0,0,0] op_sel_hi:[0,1,1]
  v_pk_fma_f32 v[158:159], v[146:147], v[170:171], v[158:159] op_sel:[0,0,0] op_sel_hi:[0,1,1]
  v_pk_fma_f32 v[148:149], v[140:141], v[164:165], v[148:149] op_sel:[1,0,0] op_sel_hi:[1,1,1]
  v_pk_fma_f32 v[150:151], v[140:141], v[166:167], v[150:151] op_sel:[1,0,0] op_sel_hi:[1,1,1]
  v_pk_fma_f32 v[156:157], v[144:145], v[164:165], v[156:157] op_sel:[1,0,0] op_sel_hi:[1,1,1]
  v_pk_fma_f32 v[158:159], v[144:145], v[166:167], v[158:159] op_sel:[1,0,0] op_sel_hi:[1,1,1]
  v_pk_fma_f32 v[148:149], v[140:141], v[84:85], v[148:149] op_sel:[0,0,0] op_sel_hi:[0,1,1]
  v_pk_fma_f32 v[150:151], v[140:141], v[86:87], v[150:151] op_sel:[0,0,0] op_sel_hi:[0,1,1]
  v_pk_fma_f32 v[156:157], v[144:145], v[112:113], v[156:157] op_sel:[0,0,0] op_sel_hi:[0,1,1]
  v_pk_fma_f32 v[158:159], v[144:145], v[114:115], v[158:159] op_sel:[0,0,0] op_sel_hi:[0,1,1]
  v_pk_mul_f32 v[152:153], v[148:149], v[148:149]
  v_pk_mul_f32 v[154:155], v[150:151], v[150:151]
  v_pk_mul_f32 v[160:161], v[156:157], v[156:157]
  v_pk_mul_f32 v[162:163], v[158:159], v[158:159]
  v_pk_fma_f32 v[152:153], v[152:153], v[180:181], s[28:29]
  v_pk_fma_f32 v[154:155], v[154:155], v[180:181], s[28:29]
  v_pk_fma_f32 v[160:161], v[160:161], v[180:181], s[28:29]
  v_pk_fma_f32 v[162:163], v[162:163], v[180:181], s[28:29]
  v_pk_mul_f32 v[152:153], v[152:153], v[148:149]
  v_pk_mul_f32 v[154:155], v[154:155], v[150:151]
  v_pk_mul_f32 v[160:161], v[160:161], v[156:157]
  v_pk_mul_f32 v[162:163], v[162:163], v[158:159]
  v_exp_f32 v152, v152
  v_exp_f32 v153, v153
  v_exp_f32 v154, v154
  v_exp_f32 v155, v155
  v_exp_f32 v160, v160
  v_exp_f32 v161, v161
  v_exp_f32 v162, v162
  v_exp_f32 v163, v163
  v_pk_add_f32 v[152:153], v[152:153], 1.0 op_sel_hi:[1,0]
  v_pk_add_f32 v[154:155], v[154:155], 1.0 op_sel_hi:[1,0]
  v_pk_add_f32 v[160:161], v[160:161], 1.0 op_sel_hi:[1,0]
  v_pk_add_f32 v[162:163], v[162:163], 1.0 op_sel_hi:[1,0]
  v_rcp_f32 v152, v152
  v_rcp_f32 v153, v153
  v_rcp_f32 v154, v154
  v_rcp_f32 v155, v155
  v_rcp_f32 v160, v160
  v_rcp_f32 v161, v161
  v_rcp_f32 v162, v162
  v_rcp_f32 v163, v163
  v_pk_mul_f32 v[148:149], v[148:149], v[152:153]
  v_pk_mul_f32 v[150:151], v[150:151], v[154:155]
  v_pk_mul_f32 v[156:157], v[156:157], v[160:161]
  v_pk_mul_f32 v[158:159], v[158:159], v[162:163]
  v_cvt_pk_bf16_f32 v152, v148, v149
  v_cvt_pk_bf16_f32 v153, v150, v151
  v_cvt_pk_bf16_f32 v160, v156, v157
  v_cvt_pk_bf16_f32 v161, v158, v159
  ds_write_b64 v251, v[152:153] offset:14912
  ds_write_b64 v251, v[160:161] offset:22336
  ds_read_b128 v[164:167], v250 offset:256
  ds_read_b128 v[168:171], v250 offset:1152
  ds_read_b128 v[172:175], v250 offset:2048
  ds_read_b128 v[176:179], v250 offset:2944
  s_waitcnt lgkmcnt(4)
  v_pk_fma_f32 v[148:149], v[134:135], v[200:201], v[204:205] op_sel:[1,0,0] op_sel_hi:[1,1,1]
  v_pk_fma_f32 v[150:151], v[134:135], v[202:203], v[206:207] op_sel:[1,0,0] op_sel_hi:[1,1,1]
  v_pk_fma_f32 v[156:157], v[138:139], v[200:201], v[204:205] op_sel:[1,0,0] op_sel_hi:[1,1,1]
  v_pk_fma_f32 v[158:159], v[138:139], v[202:203], v[206:207] op_sel:[1,0,0] op_sel_hi:[1,1,1]
  v_pk_fma_f32 v[148:149], v[134:135], v[196:197], v[148:149] op_sel:[0,0,0] op_sel_hi:[0,1,1]
  v_pk_fma_f32 v[150:151], v[134:135], v[198:199], v[150:151] op_sel:[0,0,0] op_sel_hi:[0,1,1]
  v_pk_fma_f32 v[156:157], v[138:139], v[196:197], v[156:157] op_sel:[0,0,0] op_sel_hi:[0,1,1]
  v_pk_fma_f32 v[158:159], v[138:139], v[198:199], v[158:159] op_sel:[0,0,0] op_sel_hi:[0,1,1]
  v_pk_fma_f32 v[148:149], v[132:133], v[192:193], v[148:149] op_sel:[1,0,0] op_sel_hi:[1,1,1]
  v_pk_fma_f32 v[150:151], v[132:133], v[194:195], v[150:151] op_sel:[1,0,0] op_sel_hi:[1,1,1]
  v_pk_fma_f32 v[156:157], v[136:137], v[192:193], v[156:157] op_sel:[1,0,0] op_sel_hi:[1,1,1]
  v_pk_fma_f32 v[158:159], v[136:137], v[194:195], v[158:159] op_sel:[1,0,0] op_sel_hi:[1,1,1]
  v_pk_fma_f32 v[148:149], v[132:133], v[32:33], v[148:149] op_sel:[0,0,0] op_sel_hi:[0,1,1]
  v_pk_fma_f32 v[150:151], v[132:133], v[34:35], v[150:151] op_sel:[0,0,0] op_sel_hi:[0,1,1]
  v_pk_fma_f32 v[156:157], v[136:137], v[60:61], v[156:157] op_sel:[0,0,0] op_sel_hi:[0,1,1]
  v_pk_fma_f32 v[158:159], v[136:137], v[62:63], v[158:159] op_sel:[0,0,0] op_sel_hi:[0,1,1]
  v_pk_mul_f32 v[152:153], v[148:149], v[148:149]
  v_pk_mul_f32 v[154:155], v[150:151], v[150:151]
  v_pk_mul_f32 v[160:161], v[156:157], v[156:157]
  v_pk_mul_f32 v[162:163], v[158:159], v[158:159]
  v_pk_fma_f32 v[152:153], v[152:153], v[180:181], s[28:29]
  v_pk_fma_f32 v[154:155], v[154:155], v[180:181], s[28:29]
  v_pk_fma_f32 v[160:161], v[160:161], v[180:181], s[28:29]
  v_pk_fma_f32 v[162:163], v[162:163], v[180:181], s[28:29]
  v_pk_mul_f32 v[152:153], v[152:153], v[148:149]
  v_pk_mul_f32 v[154:155], v[154:155], v[150:151]
  v_pk_mul_f32 v[160:161], v[160:161], v[156:157]
  v_pk_mul_f32 v[162:163], v[162:163], v[158:159]
  v_exp_f32 v152, v152
  v_exp_f32 v153, v153
  v_exp_f32 v154, v154
  v_exp_f32 v155, v155
  v_exp_f32 v160, v160
  v_exp_f32 v161, v161
  v_exp_f32 v162, v162
  v_exp_f32 v163, v163
  v_pk_add_f32 v[152:153], v[152:153], 1.0 op_sel_hi:[1,0]
  v_pk_add_f32 v[154:155], v[154:155], 1.0 op_sel_hi:[1,0]
  v_pk_add_f32 v[160:161], v[160:161], 1.0 op_sel_hi:[1,0]
  v_pk_add_f32 v[162:163], v[162:163], 1.0 op_sel_hi:[1,0]
  v_rcp_f32 v152, v152
  v_rcp_f32 v153, v153
  v_rcp_f32 v154, v154
  v_rcp_f32 v155, v155
  v_rcp_f32 v160, v160
  v_rcp_f32 v161, v161
  v_rcp_f32 v162, v162
  v_rcp_f32 v163, v163
  v_pk_mul_f32 v[148:149], v[148:149], v[152:153]
  v_pk_mul_f32 v[150:151], v[150:151], v[154:155]
  v_pk_mul_f32 v[156:157], v[156:157], v[160:161]
  v_pk_mul_f32 v[158:159], v[158:159], v[162:163]
  v_cvt_pk_bf16_f32 v152, v148, v149
  v_cvt_pk_bf16_f32 v153, v150, v151
  v_cvt_pk_bf16_f32 v160, v156, v157
  v_cvt_pk_bf16_f32 v161, v158, v159
  ds_write_b64 v251, v[152:153] offset:96
  ds_write_b64 v251, v[160:161] offset:7520
  v_pk_fma_f32 v[148:149], v[142:143], v[200:201], v[204:205] op_sel:[1,0,0] op_sel_hi:[1,1,1]
  v_pk_fma_f32 v[150:151], v[142:143], v[202:203], v[206:207] op_sel:[1,0,0] op_sel_hi:[1,1,1]
  v_pk_fma_f32 v[156:157], v[146:147], v[200:201], v[204:205] op_sel:[1,0,0] op_sel_hi:[1,1,1]
  v_pk_fma_f32 v[158:159], v[146:147], v[202:203], v[206:207] op_sel:[1,0,0] op_sel_hi:[1,1,1]
  v_pk_fma_f32 v[148:149], v[142:143], v[196:197], v[148:149] op_sel:[0,0,0] op_sel_hi:[0,1,1]
  v_pk_fma_f32 v[150:151], v[142:143], v[198:199], v[150:151] op_sel:[0,0,0] op_sel_hi:[0,1,1]
  v_pk_fma_f32 v[156:157], v[146:147], v[196:197], v[156:157] op_sel:[0,0,0] op_sel_hi:[0,1,1]
  v_pk_fma_f32 v[158:159], v[146:147], v[198:199], v[158:159] op_sel:[0,0,0] op_sel_hi:[0,1,1]
  v_pk_fma_f32 v[148:149], v[140:141], v[192:193], v[148:149] op_sel:[1,0,0] op_sel_hi:[1,1,1]
  v_pk_fma_f32 v[150:151], v[140:141], v[194:195], v[150:151] op_sel:[1,0,0] op_sel_hi:[1,1,1]
  v_pk_fma_f32 v[156:157], v[144:145], v[192:193], v[156:157] op_sel:[1,0,0] op_sel_hi:[1,1,1]
  v_pk_fma_f32 v[158:159], v[144:145], v[194:195], v[158:159] op_sel:[1,0,0] op_sel_hi:[1,1,1]
  v_pk_fma_f32 v[148:149], v[140:141], v[88:89], v[148:149] op_sel:[0,0,0] op_sel_hi:[0,1,1]
  v_pk_fma_f32 v[150:151], v[140:141], v[90:91], v[150:151] op_sel:[0,0,0] op_sel_hi:[0,1,1]
  v_pk_fma_f32 v[156:157], v[144:145], v[116:117], v[156:157] op_sel:[0,0,0] op_sel_hi:[0,1,1]
  v_pk_fma_f32 v[158:159], v[144:145], v[118:119], v[158:159] op_sel:[0,0,0] op_sel_hi:[0,1,1]
  v_pk_mul_f32 v[152:153], v[148:149], v[148:149]
  v_pk_mul_f32 v[154:155], v[150:151], v[150:151]
  v_pk_mul_f32 v[160:161], v[156:157], v[156:157]
  v_pk_mul_f32 v[162:163], v[158:159], v[158:159]
  v_pk_fma_f32 v[152:153], v[152:153], v[180:181], s[28:29]
  v_pk_fma_f32 v[154:155], v[154:155], v[180:181], s[28:29]
  v_pk_fma_f32 v[160:161], v[160:161], v[180:181], s[28:29]
  v_pk_fma_f32 v[162:163], v[162:163], v[180:181], s[28:29]
  v_pk_mul_f32 v[152:153], v[152:153], v[148:149]
  v_pk_mul_f32 v[154:155], v[154:155], v[150:151]
  v_pk_mul_f32 v[160:161], v[160:161], v[156:157]
  v_pk_mul_f32 v[162:163], v[162:163], v[158:159]
  v_exp_f32 v152, v152
  v_exp_f32 v153, v153
  v_exp_f32 v154, v154
  v_exp_f32 v155, v155
  v_exp_f32 v160, v160
  v_exp_f32 v161, v161
  v_exp_f32 v162, v162
  v_exp_f32 v163, v163
  v_pk_add_f32 v[152:153], v[152:153], 1.0 op_sel_hi:[1,0]
  v_pk_add_f32 v[154:155], v[154:155], 1.0 op_sel_hi:[1,0]
  v_pk_add_f32 v[160:161], v[160:161], 1.0 op_sel_hi:[1,0]
  v_pk_add_f32 v[162:163], v[162:163], 1.0 op_sel_hi:[1,0]
  v_rcp_f32 v152, v152
  v_rcp_f32 v153, v153
  v_rcp_f32 v154, v154
  v_rcp_f32 v155, v155
  v_rcp_f32 v160, v160
  v_rcp_f32 v161, v161
  v_rcp_f32 v162, v162
  v_rcp_f32 v163, v163
  v_pk_mul_f32 v[148:149], v[148:149], v[152:153]
  v_pk_mul_f32 v[150:151], v[150:151], v[154:155]
  v_pk_mul_f32 v[156:157], v[156:157], v[160:161]
  v_pk_mul_f32 v[158:159], v[158:159], v[162:163]
  v_cvt_pk_bf16_f32 v152, v148, v149
  v_cvt_pk_bf16_f32 v153, v150, v151
  v_cvt_pk_bf16_f32 v160, v156, v157
  v_cvt_pk_bf16_f32 v161, v158, v159
  ds_write_b64 v251, v[152:153] offset:14944
  ds_write_b64 v251, v[160:161] offset:22368
  ds_read_b128 v[192:195], v250 offset:320
  ds_read_b128 v[196:199], v250 offset:1216
  ds_read_b128 v[200:203], v250 offset:2112
  ds_read_b128 v[204:207], v250 offset:3008
  s_waitcnt lgkmcnt(4)
  v_pk_fma_f32 v[148:149], v[134:135], v[172:173], v[176:177] op_sel:[1,0,0] op_sel_hi:[1,1,1]
  v_pk_fma_f32 v[150:151], v[134:135], v[174:175], v[178:179] op_sel:[1,0,0] op_sel_hi:[1,1,1]
  v_pk_fma_f32 v[156:157], v[138:139], v[172:173], v[176:177] op_sel:[1,0,0] op_sel_hi:[1,1,1]
  v_pk_fma_f32 v[158:159], v[138:139], v[174:175], v[178:179] op_sel:[1,0,0] op_sel_hi:[1,1,1]
  v_pk_fma_f32 v[148:149], v[134:135], v[168:169], v[148:149] op_sel:[0,0,0] op_sel_hi:[0,1,1]
  v_pk_fma_f32 v[150:151], v[134:135], v[170:171], v[150:151] op_sel:[0,0,0] op_sel_hi:[0,1,1]
  v_pk_fma_f32 v[156:157], v[138:139], v[168:169], v[156:157] op_sel:[0,0,0] op_sel_hi:[0,1,1]
  v_pk_fma_f32 v[158:159], v[138:139], v[170:171], v[158:159] op_sel:[0,0,0] op_sel_hi:[0,1,1]
  v_pk_fma_f32 v[148:149], v[132:133], v[164:165], v[148:149] op_sel:[1,0,0] op_sel_hi:[1,1,1]
  v_pk_fma_f32 v[150:151], v[132:133], v[166:167], v[150:151] op_sel:[1,0,0] op_sel_hi:[1,1,1]
  v_pk_fma_f32 v[156:157], v[136:137], v[164:165], v[156:157] op_sel:[1,0,0] op_sel_hi:[1,1,1]
  v_pk_fma_f32 v[158:159], v[136:137], v[166:167], v[158:159] op_sel:[1,0,0] op_sel_hi:[1,1,1]
  v_pk_fma_f32 v[148:149], v[132:133], v[36:37], v[148:149] op_sel:[0,0,0] op_sel_hi:[0,1,1]
  v_pk_fma_f32 v[150:151], v[132:133], v[38:39], v[150:151] op_sel:[0,0,0] op_sel_hi:[0,1,1]
  v_pk_fma_f32 v[156:157], v[136:137], v[64:65], v[156:157] op_sel:[0,0,0] op_sel_hi:[0,1,1]
  v_pk_fma_f32 v[158:159], v[136:137], v[66:67], v[158:159] op_sel:[0,0,0] op_sel_hi:[0,1,1]
  v_pk_mul_f32 v[152:153], v[148:149], v[148:149]
  v_pk_mul_f32 v[154:155], v[150:151], v[150:151]
  v_pk_mul_f32 v[160:161], v[156:157], v[156:157]
  v_pk_mul_f32 v[162:163], v[158:159], v[158:159]
  v_pk_fma_f32 v[152:153], v[152:153], v[180:181], s[28:29]
  v_pk_fma_f32 v[154:155], v[154:155], v[180:181], s[28:29]
  v_pk_fma_f32 v[160:161], v[160:161], v[180:181], s[28:29]
  v_pk_fma_f32 v[162:163], v[162:163], v[180:181], s[28:29]
  v_pk_mul_f32 v[152:153], v[152:153], v[148:149]
  v_pk_mul_f32 v[154:155], v[154:155], v[150:151]
  v_pk_mul_f32 v[160:161], v[160:161], v[156:157]
  v_pk_mul_f32 v[162:163], v[162:163], v[158:159]
  v_exp_f32 v152, v152
  v_exp_f32 v153, v153
  v_exp_f32 v154, v154
  v_exp_f32 v155, v155
  v_exp_f32 v160, v160
  v_exp_f32 v161, v161
  v_exp_f32 v162, v162
  v_exp_f32 v163, v163
  v_pk_add_f32 v[152:153], v[152:153], 1.0 op_sel_hi:[1,0]
  v_pk_add_f32 v[154:155], v[154:155], 1.0 op_sel_hi:[1,0]
  v_pk_add_f32 v[160:161], v[160:161], 1.0 op_sel_hi:[1,0]
  v_pk_add_f32 v[162:163], v[162:163], 1.0 op_sel_hi:[1,0]
  v_rcp_f32 v152, v152
  v_rcp_f32 v153, v153
  v_rcp_f32 v154, v154
  v_rcp_f32 v155, v155
  v_rcp_f32 v160, v160
  v_rcp_f32 v161, v161
  v_rcp_f32 v162, v162
  v_rcp_f32 v163, v163
  v_pk_mul_f32 v[148:149], v[148:149], v[152:153]
  v_pk_mul_f32 v[150:151], v[150:151], v[154:155]
  v_pk_mul_f32 v[156:157], v[156:157], v[160:161]
  v_pk_mul_f32 v[158:159], v[158:159], v[162:163]
  v_cvt_pk_bf16_f32 v152, v148, v149
  v_cvt_pk_bf16_f32 v153, v150, v151
  v_cvt_pk_bf16_f32 v160, v156, v157
  v_cvt_pk_bf16_f32 v161, v158, v159
  ds_write_b64 v251, v[152:153] offset:128
  ds_write_b64 v251, v[160:161] offset:7552
  v_pk_fma_f32 v[148:149], v[142:143], v[172:173], v[176:177] op_sel:[1,0,0] op_sel_hi:[1,1,1]
  v_pk_fma_f32 v[150:151], v[142:143], v[174:175], v[178:179] op_sel:[1,0,0] op_sel_hi:[1,1,1]
  v_pk_fma_f32 v[156:157], v[146:147], v[172:173], v[176:177] op_sel:[1,0,0] op_sel_hi:[1,1,1]
  v_pk_fma_f32 v[158:159], v[146:147], v[174:175], v[178:179] op_sel:[1,0,0] op_sel_hi:[1,1,1]
  v_pk_fma_f32 v[148:149], v[142:143], v[168:169], v[148:149] op_sel:[0,0,0] op_sel_hi:[0,1,1]
  v_pk_fma_f32 v[150:151], v[142:143], v[170:171], v[150:151] op_sel:[0,0,0] op_sel_hi:[0,1,1]
  v_pk_fma_f32 v[156:157], v[146:147], v[168:169], v[156:157] op_sel:[0,0,0] op_sel_hi:[0,1,1]
  v_pk_fma_f32 v[158:159], v[146:147], v[170:171], v[158:159] op_sel:[0,0,0] op_sel_hi:[0,1,1]
  v_pk_fma_f32 v[148:149], v[140:141], v[164:165], v[148:149] op_sel:[1,0,0] op_sel_hi:[1,1,1]
  v_pk_fma_f32 v[150:151], v[140:141], v[166:167], v[150:151] op_sel:[1,0,0] op_sel_hi:[1,1,1]
  v_pk_fma_f32 v[156:157], v[144:145], v[164:165], v[156:157] op_sel:[1,0,0] op_sel_hi:[1,1,1]
  v_pk_fma_f32 v[158:159], v[144:145], v[166:167], v[158:159] op_sel:[1,0,0] op_sel_hi:[1,1,1]
  v_pk_fma_f32 v[148:149], v[140:141], v[92:93], v[148:149] op_sel:[0,0,0] op_sel_hi:[0,1,1]
  v_pk_fma_f32 v[150:151], v[140:141], v[94:95], v[150:151] op_sel:[0,0,0] op_sel_hi:[0,1,1]
  v_pk_fma_f32 v[156:157], v[144:145], v[120:121], v[156:157] op_sel:[0,0,0] op_sel_hi:[0,1,1]
  v_pk_fma_f32 v[158:159], v[144:145], v[122:123], v[158:159] op_sel:[0,0,0] op_sel_hi:[0,1,1]
  v_pk_mul_f32 v[152:153], v[148:149], v[148:149]
  v_pk_mul_f32 v[154:155], v[150:151], v[150:151]
  v_pk_mul_f32 v[160:161], v[156:157], v[156:157]
  v_pk_mul_f32 v[162:163], v[158:159], v[158:159]
  v_pk_fma_f32 v[152:153], v[152:153], v[180:181], s[28:29]
  v_pk_fma_f32 v[154:155], v[154:155], v[180:181], s[28:29]
  v_pk_fma_f32 v[160:161], v[160:161], v[180:181], s[28:29]
  v_pk_fma_f32 v[162:163], v[162:163], v[180:181], s[28:29]
  v_pk_mul_f32 v[152:153], v[152:153], v[148:149]
  v_pk_mul_f32 v[154:155], v[154:155], v[150:151]
  v_pk_mul_f32 v[160:161], v[160:161], v[156:157]
  v_pk_mul_f32 v[162:163], v[162:163], v[158:159]
  v_exp_f32 v152, v152
  v_exp_f32 v153, v153
  v_exp_f32 v154, v154
  v_exp_f32 v155, v155
  v_exp_f32 v160, v160
  v_exp_f32 v161, v161
  v_exp_f32 v162, v162
  v_exp_f32 v163, v163
  v_pk_add_f32 v[152:153], v[152:153], 1.0 op_sel_hi:[1,0]
  v_pk_add_f32 v[154:155], v[154:155], 1.0 op_sel_hi:[1,0]
  v_pk_add_f32 v[160:161], v[160:161], 1.0 op_sel_hi:[1,0]
  v_pk_add_f32 v[162:163], v[162:163], 1.0 op_sel_hi:[1,0]
  v_rcp_f32 v152, v152
  v_rcp_f32 v153, v153
  v_rcp_f32 v154, v154
  v_rcp_f32 v155, v155
  v_rcp_f32 v160, v160
  v_rcp_f32 v161, v161
  v_rcp_f32 v162, v162
  v_rcp_f32 v163, v163
  v_pk_mul_f32 v[148:149], v[148:149], v[152:153]
  v_pk_mul_f32 v[150:151], v[150:151], v[154:155]
  v_pk_mul_f32 v[156:157], v[156:157], v[160:161]
  v_pk_mul_f32 v[158:159], v[158:159], v[162:163]
  v_cvt_pk_bf16_f32 v152, v148, v149
  v_cvt_pk_bf16_f32 v153, v150, v151
  v_cvt_pk_bf16_f32 v160, v156, v157
  v_cvt_pk_bf16_f32 v161, v158, v159
  ds_write_b64 v251, v[152:153] offset:14976
  ds_write_b64 v251, v[160:161] offset:22400
  ds_read_b128 v[164:167], v250 offset:384
  ds_read_b128 v[168:171], v250 offset:1280
  ds_read_b128 v[172:175], v250 offset:2176
  ds_read_b128 v[176:179], v250 offset:3072
  s_waitcnt lgkmcnt(4)
  v_pk_fma_f32 v[148:149], v[134:135], v[200:201], v[204:205] op_sel:[1,0,0] op_sel_hi:[1,1,1]
  v_pk_fma_f32 v[150:151], v[134:135], v[202:203], v[206:207] op_sel:[1,0,0] op_sel_hi:[1,1,1]
  v_pk_fma_f32 v[156:157], v[138:139], v[200:201], v[204:205] op_sel:[1,0,0] op_sel_hi:[1,1,1]
  v_pk_fma_f32 v[158:159], v[138:139], v[202:203], v[206:207] op_sel:[1,0,0] op_sel_hi:[1,1,1]
  v_pk_fma_f32 v[148:149], v[134:135], v[196:197], v[148:149] op_sel:[0,0,0] op_sel_hi:[0,1,1]
  v_pk_fma_f32 v[150:151], v[134:135], v[198:199], v[150:151] op_sel:[0,0,0] op_sel_hi:[0,1,1]
  v_pk_fma_f32 v[156:157], v[138:139], v[196:197], v[156:157] op_sel:[0,0,0] op_sel_hi:[0,1,1]
  v_pk_fma_f32 v[158:159], v[138:139], v[198:199], v[158:159] op_sel:[0,0,0] op_sel_hi:[0,1,1]
  v_pk_fma_f32 v[148:149], v[132:133], v[192:193], v[148:149] op_sel:[1,0,0] op_sel_hi:[1,1,1]
  v_pk_fma_f32 v[150:151], v[132:133], v[194:195], v[150:151] op_sel:[1,0,0] op_sel_hi:[1,1,1]
  v_pk_fma_f32 v[156:157], v[136:137], v[192:193], v[156:157] op_sel:[1,0,0] op_sel_hi:[1,1,1]
  v_pk_fma_f32 v[158:159], v[136:137], v[194:195], v[158:159] op_sel:[1,0,0] op_sel_hi:[1,1,1]
  v_pk_fma_f32 v[148:149], v[132:133], v[40:41], v[148:149] op_sel:[0,0,0] op_sel_hi:[0,1,1]
  v_pk_fma_f32 v[150:151], v[132:133], v[42:43], v[150:151] op_sel:[0,0,0] op_sel_hi:[0,1,1]
  v_pk_fma_f32 v[156:157], v[136:137], v[68:69], v[156:157] op_sel:[0,0,0] op_sel_hi:[0,1,1]
  v_pk_fma_f32 v[158:159], v[136:137], v[70:71], v[158:159] op_sel:[0,0,0] op_sel_hi:[0,1,1]
  v_pk_mul_f32 v[152:153], v[148:149], v[148:149]
  v_pk_mul_f32 v[154:155], v[150:151], v[150:151]
  v_pk_mul_f32 v[160:161], v[156:157], v[156:157]
  v_pk_mul_f32 v[162:163], v[158:159], v[158:159]
  v_pk_fma_f32 v[152:153], v[152:153], v[180:181], s[28:29]
  v_pk_fma_f32 v[154:155], v[154:155], v[180:181], s[28:29]
  v_pk_fma_f32 v[160:161], v[160:161], v[180:181], s[28:29]
  v_pk_fma_f32 v[162:163], v[162:163], v[180:181], s[28:29]
  v_pk_mul_f32 v[152:153], v[152:153], v[148:149]
  v_pk_mul_f32 v[154:155], v[154:155], v[150:151]
  v_pk_mul_f32 v[160:161], v[160:161], v[156:157]
  v_pk_mul_f32 v[162:163], v[162:163], v[158:159]
  v_exp_f32 v152, v152
  v_exp_f32 v153, v153
  v_exp_f32 v154, v154
  v_exp_f32 v155, v155
  v_exp_f32 v160, v160
  v_exp_f32 v161, v161
  v_exp_f32 v162, v162
  v_exp_f32 v163, v163
  v_pk_add_f32 v[152:153], v[152:153], 1.0 op_sel_hi:[1,0]
  v_pk_add_f32 v[154:155], v[154:155], 1.0 op_sel_hi:[1,0]
  v_pk_add_f32 v[160:161], v[160:161], 1.0 op_sel_hi:[1,0]
  v_pk_add_f32 v[162:163], v[162:163], 1.0 op_sel_hi:[1,0]
  v_rcp_f32 v152, v152
  v_rcp_f32 v153, v153
  v_rcp_f32 v154, v154
  v_rcp_f32 v155, v155
  v_rcp_f32 v160, v160
  v_rcp_f32 v161, v161
  v_rcp_f32 v162, v162
  v_rcp_f32 v163, v163
  v_pk_mul_f32 v[148:149], v[148:149], v[152:153]
  v_pk_mul_f32 v[150:151], v[150:151], v[154:155]
  v_pk_mul_f32 v[156:157], v[156:157], v[160:161]
  v_pk_mul_f32 v[158:159], v[158:159], v[162:163]
  v_cvt_pk_bf16_f32 v152, v148, v149
  v_cvt_pk_bf16_f32 v153, v150, v151
  v_cvt_pk_bf16_f32 v160, v156, v157
  v_cvt_pk_bf16_f32 v161, v158, v159
  ds_write_b64 v251, v[152:153] offset:160
  ds_write_b64 v251, v[160:161] offset:7584
  v_pk_fma_f32 v[148:149], v[142:143], v[200:201], v[204:205] op_sel:[1,0,0] op_sel_hi:[1,1,1]
  v_pk_fma_f32 v[150:151], v[142:143], v[202:203], v[206:207] op_sel:[1,0,0] op_sel_hi:[1,1,1]
  v_pk_fma_f32 v[156:157], v[146:147], v[200:201], v[204:205] op_sel:[1,0,0] op_sel_hi:[1,1,1]
  v_pk_fma_f32 v[158:159], v[146:147], v[202:203], v[206:207] op_sel:[1,0,0] op_sel_hi:[1,1,1]
  v_pk_fma_f32 v[148:149], v[142:143], v[196:197], v[148:149] op_sel:[0,0,0] op_sel_hi:[0,1,1]
  v_pk_fma_f32 v[150:151], v[142:143], v[198:199], v[150:151] op_sel:[0,0,0] op_sel_hi:[0,1,1]
  v_pk_fma_f32 v[156:157], v[146:147], v[196:197], v[156:157] op_sel:[0,0,0] op_sel_hi:[0,1,1]
  v_pk_fma_f32 v[158:159], v[146:147], v[198:199], v[158:159] op_sel:[0,0,0] op_sel_hi:[0,1,1]
  v_pk_fma_f32 v[148:149], v[140:141], v[192:193], v[148:149] op_sel:[1,0,0] op_sel_hi:[1,1,1]
  v_pk_fma_f32 v[150:151], v[140:141], v[194:195], v[150:151] op_sel:[1,0,0] op_sel_hi:[1,1,1]
  v_pk_fma_f32 v[156:157], v[144:145], v[192:193], v[156:157] op_sel:[1,0,0] op_sel_hi:[1,1,1]
  v_pk_fma_f32 v[158:159], v[144:145], v[194:195], v[158:159] op_sel:[1,0,0] op_sel_hi:[1,1,1]
  v_pk_fma_f32 v[148:149], v[140:141], v[96:97], v[148:149] op_sel:[0,0,0] op_sel_hi:[0,1,1]
  v_pk_fma_f32 v[150:151], v[140:141], v[98:99], v[150:151] op_sel:[0,0,0] op_sel_hi:[0,1,1]
  v_pk_fma_f32 v[156:157], v[144:145], v[124:125], v[156:157] op_sel:[0,0,0] op_sel_hi:[0,1,1]
  v_pk_fma_f32 v[158:159], v[144:145], v[126:127], v[158:159] op_sel:[0,0,0] op_sel_hi:[0,1,1]
  v_pk_mul_f32 v[152:153], v[148:149], v[148:149]
  v_pk_mul_f32 v[154:155], v[150:151], v[150:151]
  v_pk_mul_f32 v[160:161], v[156:157], v[156:157]
  v_pk_mul_f32 v[162:163], v[158:159], v[158:159]
  v_pk_fma_f32 v[152:153], v[152:153], v[180:181], s[28:29]
  v_pk_fma_f32 v[154:155], v[154:155], v[180:181], s[28:29]
  v_pk_fma_f32 v[160:161], v[160:161], v[180:181], s[28:29]
  v_pk_fma_f32 v[162:163], v[162:163], v[180:181], s[28:29]
  v_pk_mul_f32 v[152:153], v[152:153], v[148:149]
  v_pk_mul_f32 v[154:155], v[154:155], v[150:151]
  v_pk_mul_f32 v[160:161], v[160:161], v[156:157]
  v_pk_mul_f32 v[162:163], v[162:163], v[158:159]
  v_exp_f32 v152, v152
  v_exp_f32 v153, v153
  v_exp_f32 v154, v154
  v_exp_f32 v155, v155
  v_exp_f32 v160, v160
  v_exp_f32 v161, v161
  v_exp_f32 v162, v162
  v_exp_f32 v163, v163
  v_pk_add_f32 v[152:153], v[152:153], 1.0 op_sel_hi:[1,0]
  v_pk_add_f32 v[154:155], v[154:155], 1.0 op_sel_hi:[1,0]
  v_pk_add_f32 v[160:161], v[160:161], 1.0 op_sel_hi:[1,0]
  v_pk_add_f32 v[162:163], v[162:163], 1.0 op_sel_hi:[1,0]
  v_rcp_f32 v152, v152
  v_rcp_f32 v153, v153
  v_rcp_f32 v154, v154
  v_rcp_f32 v155, v155
  v_rcp_f32 v160, v160
  v_rcp_f32 v161, v161
  v_rcp_f32 v162, v162
  v_rcp_f32 v163, v163
  v_pk_mul_f32 v[148:149], v[148:149], v[152:153]
  v_pk_mul_f32 v[150:151], v[150:151], v[154:155]
  v_pk_mul_f32 v[156:157], v[156:157], v[160:161]
  v_pk_mul_f32 v[158:159], v[158:159], v[162:163]
  v_cvt_pk_bf16_f32 v152, v148, v149
  v_cvt_pk_bf16_f32 v153, v150, v151
  v_cvt_pk_bf16_f32 v160, v156, v157
  v_cvt_pk_bf16_f32 v161, v158, v159
  ds_write_b64 v251, v[152:153] offset:15008
  ds_write_b64 v251, v[160:161] offset:22432
  s_waitcnt lgkmcnt(0)
  v_pk_fma_f32 v[148:149], v[134:135], v[172:173], v[176:177] op_sel:[1,0,0] op_sel_hi:[1,1,1]
  v_pk_fma_f32 v[150:151], v[134:135], v[174:175], v[178:179] op_sel:[1,0,0] op_sel_hi:[1,1,1]
  v_pk_fma_f32 v[156:157], v[138:139], v[172:173], v[176:177] op_sel:[1,0,0] op_sel_hi:[1,1,1]
  v_pk_fma_f32 v[158:159], v[138:139], v[174:175], v[178:179] op_sel:[1,0,0] op_sel_hi:[1,1,1]
  v_pk_fma_f32 v[148:149], v[134:135], v[168:169], v[148:149] op_sel:[0,0,0] op_sel_hi:[0,1,1]
  v_pk_fma_f32 v[150:151], v[134:135], v[170:171], v[150:151] op_sel:[0,0,0] op_sel_hi:[0,1,1]
  v_pk_fma_f32 v[156:157], v[138:139], v[168:169], v[156:157] op_sel:[0,0,0] op_sel_hi:[0,1,1]
  v_pk_fma_f32 v[158:159], v[138:139], v[170:171], v[158:159] op_sel:[0,0,0] op_sel_hi:[0,1,1]
  v_pk_fma_f32 v[148:149], v[132:133], v[164:165], v[148:149] op_sel:[1,0,0] op_sel_hi:[1,1,1]
  v_pk_fma_f32 v[150:151], v[132:133], v[166:167], v[150:151] op_sel:[1,0,0] op_sel_hi:[1,1,1]
  v_pk_fma_f32 v[156:157], v[136:137], v[164:165], v[156:157] op_sel:[1,0,0] op_sel_hi:[1,1,1]
  v_pk_fma_f32 v[158:159], v[136:137], v[166:167], v[158:159] op_sel:[1,0,0] op_sel_hi:[1,1,1]
  v_pk_fma_f32 v[148:149], v[132:133], v[44:45], v[148:149] op_sel:[0,0,0] op_sel_hi:[0,1,1]
  v_pk_fma_f32 v[150:151], v[132:133], v[46:47], v[150:151] op_sel:[0,0,0] op_sel_hi:[0,1,1]
  v_pk_fma_f32 v[156:157], v[136:137], v[72:73], v[156:157] op_sel:[0,0,0] op_sel_hi:[0,1,1]
  v_pk_fma_f32 v[158:159], v[136:137], v[74:75], v[158:159] op_sel:[0,0,0] op_sel_hi:[0,1,1]
  v_pk_mul_f32 v[152:153], v[148:149], v[148:149]
  v_pk_mul_f32 v[154:155], v[150:151], v[150:151]
  v_pk_mul_f32 v[160:161], v[156:157], v[156:157]
  v_pk_mul_f32 v[162:163], v[158:159], v[158:159]
  v_pk_fma_f32 v[152:153], v[152:153], v[180:181], s[28:29]
  v_pk_fma_f32 v[154:155], v[154:155], v[180:181], s[28:29]
  v_pk_fma_f32 v[160:161], v[160:161], v[180:181], s[28:29]
  v_pk_fma_f32 v[162:163], v[162:163], v[180:181], s[28:29]
  v_pk_mul_f32 v[152:153], v[152:153], v[148:149]
  v_pk_mul_f32 v[154:155], v[154:155], v[150:151]
  v_pk_mul_f32 v[160:161], v[160:161], v[156:157]
  v_pk_mul_f32 v[162:163], v[162:163], v[158:159]
  v_exp_f32 v152, v152
  v_exp_f32 v153, v153
  v_exp_f32 v154, v154
  v_exp_f32 v155, v155
  v_exp_f32 v160, v160
  v_exp_f32 v161, v161
  v_exp_f32 v162, v162
  v_exp_f32 v163, v163
  v_pk_add_f32 v[152:153], v[152:153], 1.0 op_sel_hi:[1,0]
  v_pk_add_f32 v[154:155], v[154:155], 1.0 op_sel_hi:[1,0]
  v_pk_add_f32 v[160:161], v[160:161], 1.0 op_sel_hi:[1,0]
  v_pk_add_f32 v[162:163], v[162:163], 1.0 op_sel_hi:[1,0]
  v_rcp_f32 v152, v152
  v_rcp_f32 v153, v153
  v_rcp_f32 v154, v154
  v_rcp_f32 v155, v155
  v_rcp_f32 v160, v160
  v_rcp_f32 v161, v161
  v_rcp_f32 v162, v162
  v_rcp_f32 v163, v163
  v_pk_mul_f32 v[148:149], v[148:149], v[152:153]
  v_pk_mul_f32 v[150:151], v[150:151], v[154:155]
  v_pk_mul_f32 v[156:157], v[156:157], v[160:161]
  v_pk_mul_f32 v[158:159], v[158:159], v[162:163]
  v_cvt_pk_bf16_f32 v152, v148, v149
  v_cvt_pk_bf16_f32 v153, v150, v151
  v_cvt_pk_bf16_f32 v160, v156, v157
  v_cvt_pk_bf16_f32 v161, v158, v159
  ds_write_b64 v251, v[152:153] offset:192
  ds_write_b64 v251, v[160:161] offset:7616
  v_pk_fma_f32 v[148:149], v[142:143], v[172:173], v[176:177] op_sel:[1,0,0] op_sel_hi:[1,1,1]
  v_pk_fma_f32 v[150:151], v[142:143], v[174:175], v[178:179] op_sel:[1,0,0] op_sel_hi:[1,1,1]
  v_pk_fma_f32 v[156:157], v[146:147], v[172:173], v[176:177] op_sel:[1,0,0] op_sel_hi:[1,1,1]
  v_pk_fma_f32 v[158:159], v[146:147], v[174:175], v[178:179] op_sel:[1,0,0] op_sel_hi:[1,1,1]
  v_pk_fma_f32 v[148:149], v[142:143], v[168:169], v[148:149] op_sel:[0,0,0] op_sel_hi:[0,1,1]
  v_pk_fma_f32 v[150:151], v[142:143], v[170:171], v[150:151] op_sel:[0,0,0] op_sel_hi:[0,1,1]
  v_pk_fma_f32 v[156:157], v[146:147], v[168:169], v[156:157] op_sel:[0,0,0] op_sel_hi:[0,1,1]
  v_pk_fma_f32 v[158:159], v[146:147], v[170:171], v[158:159] op_sel:[0,0,0] op_sel_hi:[0,1,1]
  v_pk_fma_f32 v[148:149], v[140:141], v[164:165], v[148:149] op_sel:[1,0,0] op_sel_hi:[1,1,1]
  v_pk_fma_f32 v[150:151], v[140:141], v[166:167], v[150:151] op_sel:[1,0,0] op_sel_hi:[1,1,1]
  v_pk_fma_f32 v[156:157], v[144:145], v[164:165], v[156:157] op_sel:[1,0,0] op_sel_hi:[1,1,1]
  v_pk_fma_f32 v[158:159], v[144:145], v[166:167], v[158:159] op_sel:[1,0,0] op_sel_hi:[1,1,1]
  v_pk_fma_f32 v[148:149], v[140:141], v[100:101], v[148:149] op_sel:[0,0,0] op_sel_hi:[0,1,1]
  v_pk_fma_f32 v[150:151], v[140:141], v[102:103], v[150:151] op_sel:[0,0,0] op_sel_hi:[0,1,1]
  v_pk_fma_f32 v[156:157], v[144:145], v[128:129], v[156:157] op_sel:[0,0,0] op_sel_hi:[0,1,1]
  v_pk_fma_f32 v[158:159], v[144:145], v[130:131], v[158:159] op_sel:[0,0,0] op_sel_hi:[0,1,1]
  v_pk_mul_f32 v[152:153], v[148:149], v[148:149]
  v_pk_mul_f32 v[154:155], v[150:151], v[150:151]
  v_pk_mul_f32 v[160:161], v[156:157], v[156:157]
  v_pk_mul_f32 v[162:163], v[158:159], v[158:159]
  v_pk_fma_f32 v[152:153], v[152:153], v[180:181], s[28:29]
  v_pk_fma_f32 v[154:155], v[154:155], v[180:181], s[28:29]
  v_pk_fma_f32 v[160:161], v[160:161], v[180:181], s[28:29]
  v_pk_fma_f32 v[162:163], v[162:163], v[180:181], s[28:29]
  v_pk_mul_f32 v[152:153], v[152:153], v[148:149]
  v_pk_mul_f32 v[154:155], v[154:155], v[150:151]
  v_pk_mul_f32 v[160:161], v[160:161], v[156:157]
  v_pk_mul_f32 v[162:163], v[162:163], v[158:159]
  v_exp_f32 v152, v152
  v_exp_f32 v153, v153
  v_exp_f32 v154, v154
  v_exp_f32 v155, v155
  v_exp_f32 v160, v160
  v_exp_f32 v161, v161
  v_exp_f32 v162, v162
  v_exp_f32 v163, v163
  v_pk_add_f32 v[152:153], v[152:153], 1.0 op_sel_hi:[1,0]
  v_pk_add_f32 v[154:155], v[154:155], 1.0 op_sel_hi:[1,0]
  v_pk_add_f32 v[160:161], v[160:161], 1.0 op_sel_hi:[1,0]
  v_pk_add_f32 v[162:163], v[162:163], 1.0 op_sel_hi:[1,0]
  v_rcp_f32 v152, v152
  v_rcp_f32 v153, v153
  v_rcp_f32 v154, v154
  v_rcp_f32 v155, v155
  v_rcp_f32 v160, v160
  v_rcp_f32 v161, v161
  v_rcp_f32 v162, v162
  v_rcp_f32 v163, v163
  v_pk_mul_f32 v[148:149], v[148:149], v[152:153]
  v_pk_mul_f32 v[150:151], v[150:151], v[154:155]
  v_pk_mul_f32 v[156:157], v[156:157], v[160:161]
  v_pk_mul_f32 v[158:159], v[158:159], v[162:163]
  v_cvt_pk_bf16_f32 v152, v148, v149
  v_cvt_pk_bf16_f32 v153, v150, v151
  v_cvt_pk_bf16_f32 v160, v156, v157
  v_cvt_pk_bf16_f32 v161, v158, v159
  ds_write_b64 v251, v[152:153] offset:15040
  ds_write_b64 v251, v[160:161] offset:22464
  s_waitcnt lgkmcnt(0)
  s_branch L_k5_g1_kernel_epi_2
L_k5_g1_kernel_loader_1:
  v_and_b32 v4, 0xff, v0
  v_mov_b32 v7, v4
  v_lshlrev_b32 v8, 4, v7
  v_lshrrev_b32 v9, 3, v1
  v_lshl_add_u32 v9, v3, 3, v9
  v_bfe_u32 v10, v9, 1, 3
  v_and_b32 v11, 7, v1
  v_xor_b32 v10, v11, v10
  v_mul_u32_u24 v9, 0x800, v9
  v_lshl_add_u32 v12, v10, 4, v9
  v_add_u32 v13, 0x10000, v12
  v_add_u32 v14, 0x20000, v12
  v_add_u32 v15, 0x30000, v12
  v_lshl_add_u32 v9, v3, 6, v1
  v_mul_u32_u24 v10, 0x925, v9
  v_lshrrev_b32 v10, 16, v10
  v_mul_u32_u24 v11, 28, v10
  v_sub_u32 v11, v9, v11
  v_bfe_u32 v9, v10, 3, 1
  v_lshlrev_b32 v9, 1, v9
  v_xor_b32 v11, v11, v9
  v_mul_u32_u24 v10, 0x1c00, v10
  v_lshl_add_u32 v16, v11, 4, v10
  v_lshl_add_u32 v9, v3, 6, v1
  v_add_u32 v9, 0x100, v9
  v_mul_u32_u24 v10, 0x925, v9
  v_lshrrev_b32 v10, 16, v10
  v_mul_u32_u24 v11, 28, v10
  v_sub_u32 v11, v9, v11
  v_bfe_u32 v9, v10, 3, 1
  v_lshlrev_b32 v9, 1, v9
  v_xor_b32 v11, v11, v9
  v_mul_u32_u24 v10, 0x1c00, v10
  v_lshl_add_u32 v17, v11, 4, v10
  v_lshl_add_u32 v9, v3, 6, v1
  v_add_u32 v9, 0x200, v9
  v_mul_u32_u24 v10, 0x925, v9
  v_lshrrev_b32 v10, 16, v10
  v_mul_u32_u24 v11, 28, v10
  v_sub_u32 v11, v9, v11
  v_bfe_u32 v9, v10, 3, 1
  v_lshlrev_b32 v9, 1, v9
  v_xor_b32 v11, v11, v9
  v_mul_u32_u24 v10, 0x1c00, v10
  v_lshl_add_u32 v18, v11, 4, v10
  v_lshl_add_u32 v9, v3, 6, v1
  v_add_u32 v9, 0x300, v9
  v_mul_u32_u24 v10, 0x925, v9
  v_lshrrev_b32 v10, 16, v10
  v_mul_u32_u24 v11, 28, v10
  v_sub_u32 v11, v9, v11
  v_bfe_u32 v9, v10, 3, 1
  v_lshlrev_b32 v9, 1, v9
  v_xor_b32 v11, v11, v9
  v_mul_u32_u24 v10, 0x1c00, v10
  v_lshl_add_u32 v19, v11, 4, v10
  v_lshl_add_u32 v9, v3, 6, v1
  v_add_u32 v9, 0x400, v9
  v_mul_u32_u24 v10, 0x925, v9
  v_lshrrev_b32 v10, 16, v10
  v_mul_u32_u24 v11, 28, v10
  v_sub_u32 v11, v9, v11
  v_bfe_u32 v9, v10, 3, 1
  v_lshlrev_b32 v9, 1, v9
  v_xor_b32 v11, v11, v9
  v_mul_u32_u24 v10, 0x1c00, v10
  v_lshl_add_u32 v20, v11, 4, v10
  v_lshl_add_u32 v9, v3, 6, v1
  v_add_u32 v9, 0x500, v9
  v_mul_u32_u24 v10, 0x925, v9
  v_lshrrev_b32 v10, 16, v10
  v_mul_u32_u24 v11, 28, v10
  v_sub_u32 v11, v9, v11
  v_bfe_u32 v9, v10, 3, 1
  v_lshlrev_b32 v9, 1, v9
  v_xor_b32 v11, v11, v9
  v_mul_u32_u24 v10, 0x1c00, v10
  v_lshl_add_u32 v21, v11, 4, v10
  v_lshl_add_u32 v9, v3, 6, v1
  v_add_u32 v9, 0x600, v9
  v_mul_u32_u24 v10, 0x925, v9
  v_lshrrev_b32 v10, 16, v10
  v_mul_u32_u24 v11, 28, v10
  v_sub_u32 v11, v9, v11
  v_bfe_u32 v9, v10, 3, 1
  v_lshlrev_b32 v9, 1, v9
  v_xor_b32 v11, v11, v9
  v_mul_u32_u24 v10, 0x1c00, v10
  v_lshl_add_u32 v22, v11, 4, v10
  s_waitcnt lgkmcnt(0)
  s_add_u32 s36, s4, 0x1000000
  s_addc_u32 s37, s5, 0
  s_add_u32 s36, s36, s16
  s_addc_u32 s37, s37, 0
  s_mov_b32 s38, 0x40000
  s_mov_b32 s39, 0x20000
  s_add_u32 s40, s8, s17
  s_addc_u32 s41, s9, 0
  s_mov_b32 s42, 0x700000
  s_mov_b32 s43, 0x20000
  s_sub_u32 s42, 7340032, s17
  s_mov_b32 s44, s4
  s_mov_b32 s45, s5
  s_mov_b32 s46, 0x6000
  s_mov_b32 s47, 0x20000
  s_mov_b32 s48, 16384
  s_mov_b32 s49, 12288
  s_add_u32 s52, s4, 0x10000
  s_addc_u32 s53, s5, 0
  s_mov_b32 s54, 0x80100
  s_mov_b32 s55, 0x20000
  s_lshl_b32 s56, s12, 15
  v_lshlrev_b32 v32, 7, v7
  v_lshlrev_b32 v68, 2, v1
  s_mov_b32 s57, 524288
  s_mov_b32 s60, s6
  s_mov_b32 s61, s7
  s_mov_b32 s62, 0x1c00
  s_mov_b32 s63, 0x20000
  v_lshlrev_b32 v72, 3, v7
  s_lshl_b32 s34, s15, 10
  s_add_u32 s34, s34, 0
  s_add_u32 s64, s34, 135168
  s_mov_b32 s32, 0
  s_mov_b32 s33, 0
  buffer_load_dwordx4 v[24:27], v8, s[44:47], s48 offen
  buffer_load_dwordx4 v[28:31], v8, s[44:47], s49 offen
  s_add_u32 m0, s34, 0
  s_nop 0
  buffer_load_dwordx4 v12, s[36:39], s32 offen lds
  s_add_u32 m0, s34, 4096
  s_nop 0
  buffer_load_dwordx4 v13, s[36:39], s32 offen lds
  s_add_u32 m0, s34, 8192
  s_nop 0
  buffer_load_dwordx4 v14, s[36:39], s32 offen lds
  s_add_u32 m0, s34, 12288
  s_nop 0
  buffer_load_dwordx4 v15, s[36:39], s32 offen lds
  s_add_u32 m0, s34, 16384
  s_nop 0
  buffer_load_dwordx4 v16, s[40:43], s33 offen lds
  s_add_u32 m0, s34, 20480
  s_nop 0
  buffer_load_dwordx4 v17, s[40:43], s33 offen lds
  s_add_u32 m0, s34, 24576
  s_nop 0
  buffer_load_dwordx4 v18, s[40:43], s33 offen lds
  s_add_u32 m0, s34, 28672
  s_nop 0
  buffer_load_dwordx4 v19, s[40:43], s33 offen lds
  s_add_u32 m0, s34, 32768
  s_nop 0
  buffer_load_dwordx4 v20, s[40:43], s33 offen lds
  s_add_u32 m0, s34, 36864
  s_nop 0
  buffer_load_dwordx4 v21, s[40:43], s33 offen lds
  s_add_u32 m0, s34, 40960
  s_nop 0
  buffer_load_dwordx4 v22, s[40:43], s33 offen lds
  s_add_u32 s32, s32, 128
  s_add_u32 s33, s33, 458752
  s_add_u32 s34, s34, 45056
  s_cmp_ge_u32 s34, s64
  s_cselect_b32 s3, 135168, 0
  s_sub_u32 s34, s34, s3
  s_add_u32 m0, s34, 0
  s_nop 0
  buffer_load_dwordx4 v12, s[36:39], s32 offen lds
  s_add_u32 m0, s34, 4096
  s_nop 0
  buffer_load_dwordx4 v13, s[36:39], s32 offen lds
  s_add_u32 m0, s34, 8192
  s_nop 0
  buffer_load_dwordx4 v14, s[36:39], s32 offen lds
  s_add_u32 m0, s34, 12288
  s_nop 0
  buffer_load_dwordx4 v15, s[36:39], s32 offen lds
  s_add_u32 m0, s34, 16384
  s_nop 0
  buffer_load_dwordx4 v16, s[40:43], s33 offen lds
  s_add_u32 m0, s34, 20480
  s_nop 0
  buffer_load_dwordx4 v17, s[40:43], s33 offen lds
  s_add_u32 m0, s34, 24576
  s_nop 0
  buffer_load_dwordx4 v18, s[40:43], s33 offen lds
  s_add_u32 m0, s34, 28672
  s_nop 0
  buffer_load_dwordx4 v19, s[40:43], s33 offen lds
  s_add_u32 m0, s34, 32768
  s_nop 0
  buffer_load_dwordx4 v20, s[40:43], s33 offen lds
  s_add_u32 m0, s34, 36864
  s_nop 0
  buffer_load_dwordx4 v21, s[40:43], s33 offen lds
  s_add_u32 m0, s34, 40960
  s_nop 0
  buffer_load_dwordx4 v22, s[40:43], s33 offen lds
  s_add_u32 s32, s32, 128
  s_add_u32 s33, s33, 458752
  s_add_u32 s34, s34, 45056
  s_cmp_ge_u32 s34, s64
  s_cselect_b32 s3, 135168, 0
  s_sub_u32 s34, s34, s3
  s_add_u32 m0, s34, 0
  s_nop 0
  buffer_load_dwordx4 v12, s[36:39], s32 offen lds
  s_add_u32 m0, s34, 4096
  s_nop 0
  buffer_load_dwordx4 v13, s[36:39], s32 offen lds
  s_add_u32 m0, s34, 8192
  s_nop 0
  buffer_load_dwordx4 v14, s[36:39], s32 offen lds
  s_add_u32 m0, s34, 12288
  s_nop 0
  buffer_load_dwordx4 v15, s[36:39], s32 offen lds
  s_add_u32 m0, s34, 16384
  s_nop 0
  buffer_load_dwordx4 v16, s[40:43], s33 offen lds
  s_add_u32 m0, s34, 20480
  s_nop 0
  buffer_load_dwordx4 v17, s[40:43], s33 offen lds
  s_add_u32 m0, s34, 24576
  s_nop 0
  buffer_load_dwordx4 v18, s[40:43], s33 offen lds
  s_add_u32 m0, s34, 28672
  s_nop 0
  buffer_load_dwordx4 v19, s[40:43], s33 offen lds
  s_add_u32 m0, s34, 32768
  s_nop 0
  buffer_load_dwordx4 v20, s[40:43], s33 offen lds
  s_add_u32 m0, s34, 36864
  s_nop 0
  buffer_load_dwordx4 v21, s[40:43], s33 offen lds
  s_add_u32 m0, s34, 40960
  s_nop 0
  buffer_load_dwordx4 v22, s[40:43], s33 offen lds
  s_add_u32 s32, s32, 128
  s_add_u32 s33, s33, 458752
  s_add_u32 s34, s34, 45056
  s_cmp_ge_u32 s34, s64
  s_cselect_b32 s3, 135168, 0
  s_sub_u32 s34, s34, s3
  s_waitcnt vmcnt(33)
  v_cvt_pk_bf16_f32 v76, v24, v25
  v_cvt_pk_bf16_f32 v77, v26, v27
  v_cvt_pk_bf16_f32 v78, v28, v29
  v_cvt_pk_bf16_f32 v79, v30, v31
  v_mov_b32 v80, 0x3f803f80
  v_mov_b32 v81, 0x3f803f80
  v_mov_b32 v82, 0
  v_mov_b32 v83, 0
  v_lshlrev_b32 v84, 3, v7
  v_add_u32 v84, 0x22600, v84
  ds_write_b64 v84, v[76:77] offset:0
  ds_write_b64 v84, v[78:79] offset:2080
  ds_write_b64 v84, v[80:81] offset:4160
  ds_write_b64 v84, v[82:83] offset:6240
  s_waitcnt lgkmcnt(0)
  s_waitcnt vmcnt(22)
  s_barrier
  buffer_load_dwordx4 v[36:39], v32, s[52:55], s56 offen offset:0
  buffer_load_dwordx4 v[40:43], v32, s[52:55], s56 offen offset:16
  buffer_load_dwordx4 v[44:47], v32, s[52:55], s56 offen offset:32
  buffer_load_dwordx4 v[48:51], v32, s[52:55], s56 offen offset:48
  buffer_load_dwordx4 v[52:55], v32, s[52:55], s56 offen offset:64
  buffer_load_dwordx4 v[56:59], v32, s[52:55], s56 offen offset:80
  buffer_load_dwordx4 v[60:63], v32, s[52:55], s56 offen offset:96
  buffer_load_dwordx4 v[64:67], v32, s[52:55], s56 offen offset:112
  buffer_load_dword v70, v68, s[52:55], s57 offen
  buffer_load_dwordx2 v[74:75], v72, s[60:63], s17 offen
  s_mov_b32 s65, 4
L_k5_g1_kernel_ldloop_7:
  s_waitcnt vmcnt(11)
  s_barrier
  s_add_u32 m0, s34, 0
  s_nop 0
  buffer_load_dwordx4 v12, s[36:39], s32 offen lds
  s_add_u32 m0, s34, 4096
  s_nop 0
  buffer_load_dwordx4 v13, s[36:39], s32 offen lds
  s_add_u32 m0, s34, 8192
  s_nop 0
  buffer_load_dwordx4 v14, s[36:39], s32 offen lds
  s_add_u32 m0, s34, 12288
  s_nop 0
  buffer_load_dwordx4 v15, s[36:39], s32 offen lds
  s_add_u32 m0, s34, 16384
  s_nop 0
  buffer_load_dwordx4 v16, s[40:43], s33 offen lds
  s_add_u32 m0, s34, 20480
  s_nop 0
  buffer_load_dwordx4 v17, s[40:43], s33 offen lds
  s_add_u32 m0, s34, 24576
  s_nop 0
  buffer_load_dwordx4 v18, s[40:43], s33 offen lds
  s_add_u32 m0, s34, 28672
  s_nop 0
  buffer_load_dwordx4 v19, s[40:43], s33 offen lds
  s_add_u32 m0, s34, 32768
  s_nop 0
  buffer_load_dwordx4 v20, s[40:43], s33 offen lds
  s_add_u32 m0, s34, 36864
  s_nop 0
  buffer_load_dwordx4 v21, s[40:43], s33 offen lds
  s_add_u32 m0, s34, 40960
  s_nop 0
  buffer_load_dwordx4 v22, s[40:43], s33 offen lds
  s_add_u32 s32, s32, 128
  s_add_u32 s33, s33, 458752
  s_add_u32 s34, s34, 45056
  s_cmp_ge_u32 s34, s64
  s_cselect_b32 s3, 135168, 0
  s_sub_u32 s34, s34, s3
  s_sub_u32 s65, s65, 1
  s_cmp_lg_u32 s65, 0
  s_cbranch_scc1 L_k5_g1_kernel_ldloop_7
  v_lshlrev_b32 v88, 16, v74
  v_and_b32 v89, 0xffff0000, v74
  v_lshlrev_b32 v90, 16, v75
  v_and_b32 v91, 0xffff0000, v75
  v_lshlrev_b32 v92, 4, v7
  v_add_u32 v92, 0x22280, v92
  v_cmp_gt_u32 vcc, 56, v7
  s_nop 0
  s_and_saveexec_b64 s[66:67], vcc
  s_cbranch_execz L_k5_g1_kernel_nob1_8
  ds_write_b128 v92, v[88:91]
L_k5_g1_kernel_nob1_8:
  s_mov_b64 exec, s[66:67]
  v_add_f32_dpp v70, v70, v70 row_ror:8 row_mask:0xf bank_mask:0xf
  v_mov_b32 v71, v70
  s_nop 1
  v_permlane16_swap_b32 v70, v71
  v_add_f32 v70, v70, v71
  v_mov_b32 v71, v70
  s_nop 1
  v_permlane32_swap_b32 v70, v71
  v_add_f32 v70, v70, v71
  v_mul_f32 v70, 0x3a800000, v70
  s_nop 0
  v_readlane_b32 s68, v70, 0
  v_readlane_b32 s69, v70, 1
  v_readlane_b32 s70, v70, 2
  v_readlane_b32 s71, v70, 3
  v_readlane_b32 s72, v70, 4
  v_add_f32 v36, v36, v52
  v_add_f32 v37, v37, v53
  v_add_f32 v38, v38, v54
  v_add_f32 v39, v39, v55
  v_add_f32 v40, v40, v56
  v_add_f32 v41, v41, v57
  v_add_f32 v44, v44, v60
  v_add_f32 v45, v45, v61
  v_add_f32 v46, v46, v62
  v_add_f32 v47, v47, v63
  v_add_f32 v48, v48, v64
  v_add_f32 v49, v49, v65
  v_add_f32 v36, v36, v44
  v_add_f32 v37, v37, v45
  v_add_f32 v38, v38, v46
  v_add_f32 v39, v39, v47
  v_add_f32 v40, v40, v48
  v_add_f32 v41, v41, v49
  v_add_f32_dpp v36, v36, v36 quad_perm:[1,0,3,2] row_mask:0xf bank_mask:0xf
  v_add_f32_dpp v37, v37, v37 quad_perm:[1,0,3,2] row_mask:0xf bank_mask:0xf
  v_add_f32_dpp v38, v38, v38 quad_perm:[1,0,3,2] row_mask:0xf bank_mask:0xf
  v_add_f32_dpp v39, v39, v39 quad_perm:[1,0,3,2] row_mask:0xf bank_mask:0xf
  v_add_f32_dpp v40, v40, v40 quad_perm:[1,0,3,2] row_mask:0xf bank_mask:0xf
  v_add_f32_dpp v41, v41, v41 quad_perm:[1,0,3,2] row_mask:0xf bank_mask:0xf
  v_mul_f32 v36, 0x3a800000, v36
  v_mul_f32 v37, 0x3a800000, v37
  v_mul_f32 v38, 0x3a800000, v38
  v_mul_f32 v39, 0x3a800000, v39
  v_mul_f32 v40, 0x3a800000, v40
  v_mul_f32 v41, 0x3a800000, v41
  v_fma_f32 v44, -v36, v36, v37
  v_max_f32 v44, 0, v44
  v_add_f32 v44, 0x3727c5ac, v44
  v_rsq_f32 v48, v44
  v_fma_f32 v45, -v36, s68, v38
  v_fma_f32 v50, v48, v45, s71
  v_mul_f32 v45, s69, v36
  v_fma_f32 v45, -2.0, v40, v45
  v_fma_f32 v45, v45, v36, v39
  v_mul_f32 v45, v45, v48
  v_fma_f32 v46, -v36, s70, v41
  v_fma_f32 v45, 2.0, v46, v45
  v_fma_f32 v45, v45, v48, s72
  v_fma_f32 v45, -v50, v50, v45
  v_max_f32 v45, 0, v45
  v_add_f32 v45, 0x3727c5ac, v45
  v_rsq_f32 v49, v45
  s_nop 0
  v_mul_f32 v52, v48, v49
  v_mul_f32 v53, v36, v52
  v_sub_f32 v53, 0, v53
  v_mov_b32 v54, v49
  v_mul_f32 v55, v50, v49
  v_sub_f32 v55, 0, v55
  v_lshrrev_b32 v93, 1, v7
  v_lshlrev_b32 v93, 4, v93
  v_add_u32 v93, 0x21000, v93
  v_and_b32 v4, 1, v7
  v_cmp_eq_u32 vcc, 0, v4
  s_nop 0
  s_and_saveexec_b64 s[66:67], vcc
  ds_write_b128 v93, v[52:55]
  s_mov_b64 exec, s[66:67]
  s_mov_b32 s65, 9
L_k5_g1_kernel_ldloop_9:
  s_waitcnt vmcnt(11)
  s_barrier
  s_add_u32 m0, s34, 0
  s_nop 0
  buffer_load_dwordx4 v12, s[36:39], s32 offen lds
  s_add_u32 m0, s34, 4096
  s_nop 0
  buffer_load_dwordx4 v13, s[36:39], s32 offen lds
  s_add_u32 m0, s34, 8192
  s_nop 0
  buffer_load_dwordx4 v14, s[36:39], s32 offen lds
  s_add_u32 m0, s34, 12288
  s_nop 0
  buffer_load_dwordx4 v15, s[36:39], s32 offen lds
  s_add_u32 m0, s34, 16384
  s_nop 0
  buffer_load_dwordx4 v16, s[40:43], s33 offen lds
  s_add_u32 m0, s34, 20480
  s_nop 0
  buffer_load_dwordx4 v17, s[40:43], s33 offen lds
  s_add_u32 m0, s34, 24576
  s_nop 0
  buffer_load_dwordx4 v18, s[40:43], s33 offen lds
  s_add_u32 m0, s34, 28672
  s_nop 0
  buffer_load_dwordx4 v19, s[40:43], s33 offen lds
  s_add_u32 m0, s34, 32768
  s_nop 0
  buffer_load_dwordx4 v20, s[40:43], s33 offen lds
  s_add_u32 m0, s34, 36864
  s_nop 0
  buffer_load_dwordx4 v21, s[40:43], s33 offen lds
  s_add_u32 m0, s34, 40960
  s_nop 0
  buffer_load_dwordx4 v22, s[40:43], s33 offen lds
  s_add_u32 s32, s32, 128
  s_add_u32 s33, s33, 458752
  s_add_u32 s34, s34, 45056
  s_cmp_ge_u32 s34, s64
  s_cselect_b32 s3, 135168, 0
  s_sub_u32 s34, s34, s3
  s_sub_u32 s65, s65, 1
  s_cmp_lg_u32 s65, 0
  s_cbranch_scc1 L_k5_g1_kernel_ldloop_9
  s_waitcnt vmcnt(11)
  s_barrier
  s_waitcnt vmcnt(0)
  s_barrier
  s_waitcnt vmcnt(0)
  s_barrier
  s_waitcnt lgkmcnt(0)
  s_barrier
L_k5_g1_kernel_epi_2:
  s_barrier
  s_mul_i32 s73, s12, 917504
  s_add_u32 s73, s73, s17
  s_add_u32 s76, s4, 0x2000000
  s_addc_u32 s77, s5, 0
  s_add_u32 s76, s76, s73
  s_addc_u32 s77, s77, 0
  s_mov_b32 s78, 0xe0000
  s_mov_b32 s79, 0x20000
  s_sub_u32 s78, 917504, s17
  v_mov_b32 v4, v0
  v_mul_u32_u24 v5, 0x2493, v4
  v_lshrrev_b32 v5, 18, v5
  v_mul_u32_u24 v6, 28, v5
  v_sub_u32 v6, v4, v6
  v_mul_u32_u24 v8, 0x1d0, v5
  v_lshl_add_u32 v8, v6, 4, v8
  v_mul_u32_u24 v16, 0x1c00, v5
  v_lshl_add_u32 v16, v6, 4, v16
  ds_read_b128 v[24:27], v8
  v_add_u32 v4, 0x200, v0
  v_mul_u32_u24 v5, 0x2493, v4
  v_lshrrev_b32 v5, 18, v5
  v_mul_u32_u24 v6, 28, v5
  v_sub_u32 v6, v4, v6
  v_mul_u32_u24 v9, 0x1d0, v5
  v_lshl_add_u32 v9, v6, 4, v9
  v_mul_u32_u24 v17, 0x1c00, v5
  v_lshl_add_u32 v17, v6, 4, v17
  ds_read_b128 v[28:31], v9
  v_add_u32 v4, 0x400, v0
  v_mul_u32_u24 v5, 0x2493, v4
  v_lshrrev_b32 v5, 18, v5
  v_mul_u32_u24 v6, 28, v5
  v_sub_u32 v6, v4, v6
  v_mul_u32_u24 v10, 0x1d0, v5
  v_lshl_add_u32 v10, v6, 4, v10
  v_mul_u32_u24 v18, 0x1c00, v5
  v_lshl_add_u32 v18, v6, 4, v18
  ds_read_b128 v[32:35], v10
  v_add_u32 v4, 0x600, v0
  v_mul_u32_u24 v5, 0x2493, v4
  v_lshrrev_b32 v5, 18, v5
  v_mul_u32_u24 v6, 28, v5
  v_sub_u32 v6, v4, v6
  v_mul_u32_u24 v11, 0x1d0, v5
  v_lshl_add_u32 v11, v6, 4, v11
  v_mul_u32_u24 v19, 0x1c00, v5
  v_lshl_add_u32 v19, v6, 4, v19
  ds_read_b128 v[36:39], v11
  v_add_u32 v4, 0x800, v0
  v_mul_u32_u24 v5, 0x2493, v4
  v_lshrrev_b32 v5, 18, v5
  v_mul_u32_u24 v6, 28, v5
  v_sub_u32 v6, v4, v6
  v_mul_u32_u24 v12, 0x1d0, v5
  v_lshl_add_u32 v12, v6, 4, v12
  v_mul_u32_u24 v20, 0x1c00, v5
  v_lshl_add_u32 v20, v6, 4, v20
  ds_read_b128 v[40:43], v12
  v_add_u32 v4, 0xa00, v0
  v_mul_u32_u24 v5, 0x2493, v4
  v_lshrrev_b32 v5, 18, v5
  v_mul_u32_u24 v6, 28, v5
  v_sub_u32 v6, v4, v6
  v_mul_u32_u24 v13, 0x1d0, v5
  v_lshl_add_u32 v13, v6, 4, v13
  v_mul_u32_u24 v21, 0x1c00, v5
  v_lshl_add_u32 v21, v6, 4, v21
  ds_read_b128 v[44:47], v13
  v_add_u32 v4, 0xc00, v0
  v_mul_u32_u24 v5, 0x2493, v4
  v_lshrrev_b32 v5, 18, v5
  v_mul_u32_u24 v6, 28, v5
  v_sub_u32 v6, v4, v6
  v_mul_u32_u24 v14, 0x1d0, v5
  v_lshl_add_u32 v14, v6, 4, v14
  v_mul_u32_u24 v22, 0x1c00, v5
  v_lshl_add_u32 v22, v6, 4, v22
  ds_read_b128 v[48:51], v14
  s_waitcnt lgkmcnt(6)
  buffer_store_dwordx4 v[24:27], v16, s[76:79], 0 offen sc1
  s_waitcnt lgkmcnt(5)
  buffer_store_dwordx4 v[28:31], v17, s[76:79], 0 offen sc1
  s_waitcnt lgkmcnt(4)
  buffer_store_dwordx4 v[32:35], v18, s[76:79], 0 offen sc1
  s_waitcnt lgkmcnt(3)
  buffer_store_dwordx4 v[36:39], v19, s[76:79], 0 offen sc1
  s_waitcnt lgkmcnt(2)
  buffer_store_dwordx4 v[40:43], v20, s[76:79], 0 offen sc1
  s_waitcnt lgkmcnt(1)
  buffer_store_dwordx4 v[44:47], v21, s[76:79], 0 offen sc1
  s_waitcnt lgkmcnt(0)
  buffer_store_dwordx4 v[48:51], v22, s[76:79], 0 offen sc1
L_k5_g1_kernel_end:
L_k5_g1_kernel_exit:
  s_endpgm
.globl k6_g2_kernel
.p2align 8
.type k6_g2_kernel,@function
k6_g2_kernel:
  s_cmp_ge_u32 s2, 256
  s_cbranch_scc1 L_k6_g2_kernel_exit
  s_load_dwordx2 s[4:5], s[0:1], 112
  s_load_dwordx2 s[6:7], s[0:1], 64
  s_load_dwordx2 s[8:9], s[0:1], 96
  s_load_dwordx2 s[10:11], s[0:1], 72
  s_and_b32 s14, s2, 1
  s_lshr_b32 s15, s2, 3
  s_bfe_u32 s12, s2, 131073
  s_lshl_b32 s12, s12, 2
  s_and_b32 s3, s15, 3
  s_add_u32 s12, s12, s3
  s_lshr_b32 s13, s15, 2
  v_and_b32 v1, 63, v0
  v_lshrrev_b32 v2, 6, v0
  v_and_b32 v3, 3, v2
  v_readfirstlane_b32 s16, v2
  s_nop 0
  s_and_b32 s17, s16, 3
  v_lshrrev_b32 v4, 3, v0
  v_and_b32 v5, 7, v0
  v_lshlrev_b32 v7, 11, v4
  v_lshl_add_u32 v7, v5, 4, v7
  v_lshlrev_b32 v8, 5, v5
  s_lshl_b32 s18, s12, 18
  s_lshl_b32 s19, s13, 8
  s_lshl_b32 s3, s14, 7
  s_add_u32 s21, s19, s3
  s_add_u32 s20, s18, s21
  s_waitcnt lgkmcnt(0)
  s_add_u32 s24, s4, 0xc00000
  s_addc_u32 s25, s5, 0
  s_add_u32 s24, s24, s20
  s_addc_u32 s25, s25, 0
  s_mov_b32 s26, 0x40000
  s_mov_b32 s27, 0x20000
  s_add_u32 s28, s8, s20
  s_addc_u32 s29, s9, 0
  s_mov_b32 s30, 0x40000
  s_mov_b32 s31, 0x20000
  s_sub_u32 s26, 262144, s21
  s_sub_u32 s30, 262144, s21
  s_mov_b32 s32, s4
  s_mov_b32 s33, s5
  s_mov_b32 s34, 0x6000
  s_mov_b32 s35, 0x20000
  s_mov_b32 s36, 131072
  s_mul_i32 s37, s12, 917504
  s_mul_i32 s3, s14, 3584
  s_add_u32 s37, s37, s3
  s_add_u32 s40, s4, 0x2000000
  s_addc_u32 s41, s5, 0
  s_add_u32 s40, s40, s37
  s_addc_u32 s41, s41, 0
  s_mov_b32 s42, 0xe0000
  s_mov_b32 s43, 0x20000
  s_mul_i32 s3, s14, 3584
  s_sub_u32 s42, 917504, s3
  s_mul_i32 s44, s14, 3670016
  s_add_u32 s44, s44, s19
  s_add_u32 s48, s6, s44
  s_addc_u32 s49, s7, 0
  s_mov_b32 s50, 0x700000
  s_mov_b32 s51, 0x20000
  s_sub_u32 s50, 7340032, s44
  s_lshl_b32 s52, s12, 3
  s_add_u32 s52, s52, s13
  s_add_u32 s56, s4, 0x2f00000
  s_addc_u32 s57, s5, 0
  s_mov_b32 s58, 0x800000
  s_mov_b32 s59, 0x20000
  s_add_u32 s60, s4, 0x130000
  s_addc_u32 s61, s5, 0
  s_mov_b32 s62, 0x8000
  s_mov_b32 s63, 0x20000
  s_lshl_b32 s64, s52, 1
  s_add_u32 s66, s64, s14
  s_xor_b32 s3, s14, 1
  s_add_u32 s67, s64, s3
  s_lshl_b32 s64, s66, 14
  s_lshl_b32 s65, s67, 14
  s_lshl_b32 s66, s66, 7
  s_lshl_b32 s67, s67, 7
  s_cmp_ge_u32 s16, 4
  s_cbranch_scc1 L_k6_g2_kernel_loader_1
  s_setprio 1
  buffer_load_dwordx4 v[12:15], v7, s[24:27], 0 offen
  buffer_load_dwordx4 v[16:19], v7, s[24:27], s36 offen
  s_lshl_b32 s68, s21, 1
  s_add_u32 s68, s68, 20480
  buffer_load_dwordx4 v[20:23], v8, s[32:35], s68 offen
  buffer_load_dwordx4 v[24:27], v8, s[32:35], s68 offen offset:16
  s_mov_b32 s72, s10
  s_mov_b32 s73, s11
  s_mov_b32 s74, 0x800
  s_mov_b32 s75, 0x20000
  v_lshlrev_b32 v32, 4, v5
  buffer_load_dwordx4 v[28:31], v32, s[72:75], s21 offen
  v_and_b32 v33, 15, v1
  v_bfe_u32 v34, v1, 1, 3
  v_lshrrev_b32 v35, 4, v1
  v_xor_b32 v34, v34, v35
  v_lshlrev_b32 v36, 7, v33
  v_lshl_add_u32 v36, v34, 4, v36
  v_lshrrev_b32 v33, 1, v3
  v_lshl_add_u32 v36, v33, 13, v36
  v_xor_b32 v37, 64, v36
  v_and_b32 v33, 1, v3
  v_lshrrev_b32 v34, 4, v1
  v_lshlrev_b32 v34, 3, v34
  v_bfe_u32 v35, v1, 2, 2
  v_add_u32 v34, v34, v35
  v_and_b32 v35, 3, v34
  v_bfe_u32 v38, v34, 3, 1
  v_lshl_or_b32 v35, v38, 2, v35
  v_lshlrev_b32 v35, 1, v35
  v_bfe_u32 v38, v1, 1, 1
  v_mul_u32_u24 v42, 8, v33
  v_add_u32 v42, v42, v38
  v_xor_b32 v35, v42, v35
  v_mul_u32_u24 v34, 0x100, v34
  v_lshl_add_u32 v34, v35, 4, v34
  v_and_b32 v35, 1, v1
  v_lshl_add_u32 v38, v35, 3, v34
  v_add_u32 v38, 0x4000, v38
  v_lshrrev_b32 v34, 4, v1
  v_lshlrev_b32 v34, 3, v34
  v_bfe_u32 v35, v1, 2, 2
  v_add_u32 v34, v34, v35
  v_and_b32 v35, 3, v34
  v_bfe_u32 v39, v34, 3, 1
  v_lshl_or_b32 v35, v39, 2, v35
  v_lshlrev_b32 v35, 1, v35
  v_bfe_u32 v39, v1, 1, 1
  v_mul_u32_u24 v43, 8, v33
  v_add_u32 v43, v43, v39
  v_add_u32 v43, 2, v43
  v_xor_b32 v35, v43, v35
  v_mul_u32_u24 v34, 0x100, v34
  v_lshl_add_u32 v34, v35, 4, v34
  v_and_b32 v35, 1, v1
  v_lshl_add_u32 v39, v35, 3, v34
  v_add_u32 v39, 0x4000, v39
  v_lshrrev_b32 v34, 4, v1
  v_lshlrev_b32 v34, 3, v34
  v_bfe_u32 v35, v1, 2, 2
  v_add_u32 v34, v34, v35
  v_and_b32 v35, 3, v34
  v_bfe_u32 v40, v34, 3, 1
  v_lshl_or_b32 v35, v40, 2, v35
  v_lshlrev_b32 v35, 1, v35
  v_bfe_u32 v40, v1, 1, 1
  v_mul_u32_u24 v44, 8, v33
  v_add_u32 v44, v44, v40
  v_add_u32 v44, 4, v44
  v_xor_b32 v35, v44, v35
  v_mul_u32_u24 v34, 0x100, v34
  v_lshl_add_u32 v34, v35, 4, v34
  v_and_b32 v35, 1, v1
  v_lshl_add_u32 v40, v35, 3, v34
  v_add_u32 v40, 0x4000, v40
  v_lshrrev_b32 v34, 4, v1
  v_lshlrev_b32 v34, 3, v34
  v_bfe_u32 v35, v1, 2, 2
  v_add_u32 v34, v34, v35
  v_and_b32 v35, 3, v34
  v_bfe_u32 v41, v34, 3, 1
  v_lshl_or_b32 v35, v41, 2, v35
  v_lshlrev_b32 v35, 1, v35
  v_bfe_u32 v41, v1, 1, 1
  v_mul_u32_u24 v45, 8, v33
  v_add_u32 v45, v45, v41
  v_add_u32 v45, 6, v45
  v_xor_b32 v35, v45, v35
  v_mul_u32_u24 v34, 0x100, v34
  v_lshl_add_u32 v34, v35, 4, v34
  v_and_b32 v35, 1, v1
  v_lshl_add_u32 v41, v35, 3, v34
  v_add_u32 v41, 0x4000, v41
  s_mov_b32 s76, 0
  s_mov_b32 s77, 131072
  v_add_u32 v46, s76, v36
  v_add_u32 v47, s76, v37
  v_add_u32 v48, s76, v38
  v_add_u32 v49, s76, v39
  v_add_u32 v50, s76, v40
  v_add_u32 v51, s76, v41
  v_mov_b32 v52, 0
  v_mov_b32 v53, 0
  v_mov_b32 v54, 0
  v_mov_b32 v55, 0
  v_mov_b32 v56, 0
  v_mov_b32 v57, 0
  v_mov_b32 v58, 0
  v_mov_b32 v59, 0
  v_mov_b32 v60, 0
  v_mov_b32 v61, 0
  v_mov_b32 v62, 0
  v_mov_b32 v63, 0
  v_mov_b32 v64, 0
  v_mov_b32 v65, 0
  v_mov_b32 v66, 0
  v_mov_b32 v67, 0
  v_mov_b32 v68, 0
  v_mov_b32 v69, 0
  v_mov_b32 v70, 0
  v_mov_b32 v71, 0
  v_mov_b32 v72, 0
  v_mov_b32 v73, 0
  v_mov_b32 v74, 0
  v_mov_b32 v75, 0
  v_mov_b32 v76, 0
  v_mov_b32 v77, 0
  v_mov_b32 v78, 0
  v_mov_b32 v79, 0
  v_mov_b32 v80, 0
  v_mov_b32 v81, 0
  v_mov_b32 v82, 0
  v_mov_b32 v83, 0
  v_mov_b32 v84, 0
  v_mov_b32 v85, 0
  v_mov_b32 v86, 0
  v_mov_b32 v87, 0
  v_mov_b32 v88, 0
  v_mov_b32 v89, 0
  v_mov_b32 v90, 0
  v_mov_b32 v91, 0
  v_mov_b32 v92, 0
  v_mov_b32 v93, 0
  v_mov_b32 v94, 0
  v_mov_b32 v95, 0
  v_mov_b32 v96, 0
  v_mov_b32 v97, 0
  v_mov_b32 v98, 0
  v_mov_b32 v99, 0
  v_mov_b32 v100, 0
  v_mov_b32 v101, 0
  v_mov_b32 v102, 0
  v_mov_b32 v103, 0
  v_mov_b32 v104, 0
  v_mov_b32 v105, 0
  v_mov_b32 v106, 0
  v_mov_b32 v107, 0
  v_mov_b32 v108, 0
  v_mov_b32 v109, 0
  v_mov_b32 v110, 0
  v_mov_b32 v111, 0
  v_mov_b32 v112, 0
  v_mov_b32 v113, 0
  v_mov_b32 v114, 0
  v_mov_b32 v115, 0
  s_barrier
  ds_read_b128 v[116:119], v46 offset:0
  ds_read_b128 v[120:123], v46 offset:2048
  ds_read_b128 v[124:127], v46 offset:4096
  ds_read_b128 v[128:131], v46 offset:6144
  ds_read_b64_tr_b16 v[180:181], v48 offset:0
  ds_read_b64_tr_b16 v[182:183], v48 offset:1024
  ds_read_b64_tr_b16 v[184:185], v49 offset:0
  ds_read_b64_tr_b16 v[186:187], v49 offset:1024
  ds_read_b64_tr_b16 v[188:189], v50 offset:0
  ds_read_b64_tr_b16 v[190:191], v50 offset:1024
  ds_read_b64_tr_b16 v[192:193], v51 offset:0
  ds_read_b64_tr_b16 v[194:195], v51 offset:1024
  ds_read_b128 v[132:135], v47 offset:0
  ds_read_b128 v[136:139], v47 offset:2048
  ds_read_b128 v[140:143], v47 offset:4096
  ds_read_b128 v[144:147], v47 offset:6144
  ds_read_b64_tr_b16 v[196:197], v48 offset:8192
  ds_read_b64_tr_b16 v[198:199], v48 offset:9216
  ds_read_b64_tr_b16 v[200:201], v49 offset:8192
  ds_read_b64_tr_b16 v[202:203], v49 offset:9216
  ds_read_b64_tr_b16 v[204:205], v50 offset:8192
  ds_read_b64_tr_b16 v[206:207], v50 offset:9216
  ds_read_b64_tr_b16 v[208:209], v51 offset:8192
  ds_read_b64_tr_b16 v[210:211], v51 offset:9216
  s_mov_b32 s78, 14
L_k6_g2_kernel_cloop_3:
  s_waitcnt lgkmcnt(0)
  s_barrier
  v_mfma_f32_16x16x32_bf16 v[52:55], v[180:183], v[116:119], v[52:55]
  s_add_u32 s76, s76, 32768
  s_cmp_ge_u32 s76, s77
  v_mfma_f32_16x16x32_bf16 v[68:71], v[180:183], v[120:123], v[68:71]
  s_cselect_b32 s3, 131072, 0
  s_sub_u32 s76, s76, s3
  v_mfma_f32_16x16x32_bf16 v[84:87], v[180:183], v[124:127], v[84:87]
  v_add_u32 v46, s76, v36
  v_add_u32 v47, s76, v37
  v_mfma_f32_16x16x32_bf16 v[100:103], v[180:183], v[128:131], v[100:103]
  v_add_u32 v48, s76, v38
  v_add_u32 v49, s76, v39
  v_mfma_f32_16x16x32_bf16 v[56:59], v[184:187], v[116:119], v[56:59]
  v_add_u32 v50, s76, v40
  v_add_u32 v51, s76, v41
  v_mfma_f32_16x16x32_bf16 v[72:75], v[184:187], v[120:123], v[72:75]
  ds_read_b128 v[148:151], v46 offset:0
  ds_read_b128 v[152:155], v46 offset:2048
  v_mfma_f32_16x16x32_bf16 v[88:91], v[184:187], v[124:127], v[88:91]
  ds_read_b128 v[156:159], v46 offset:4096
  ds_read_b128 v[160:163], v46 offset:6144
  v_mfma_f32_16x16x32_bf16 v[104:107], v[184:187], v[128:131], v[104:107]
  ds_read_b64_tr_b16 v[212:213], v48 offset:0
  ds_read_b64_tr_b16 v[214:215], v48 offset:1024
  v_mfma_f32_16x16x32_bf16 v[60:63], v[188:191], v[116:119], v[60:63]
  ds_read_b64_tr_b16 v[216:217], v49 offset:0
  ds_read_b64_tr_b16 v[218:219], v49 offset:1024
  v_mfma_f32_16x16x32_bf16 v[76:79], v[188:191], v[120:123], v[76:79]
  ds_read_b64_tr_b16 v[220:221], v50 offset:0
  ds_read_b64_tr_b16 v[222:223], v50 offset:1024
  v_mfma_f32_16x16x32_bf16 v[92:95], v[188:191], v[124:127], v[92:95]
  ds_read_b64_tr_b16 v[224:225], v51 offset:0
  ds_read_b64_tr_b16 v[226:227], v51 offset:1024
  v_mfma_f32_16x16x32_bf16 v[108:111], v[188:191], v[128:131], v[108:111]
  ds_read_b128 v[164:167], v47 offset:0
  ds_read_b128 v[168:171], v47 offset:2048
  v_mfma_f32_16x16x32_bf16 v[64:67], v[192:195], v[116:119], v[64:67]
  ds_read_b128 v[172:175], v47 offset:4096
  ds_read_b128 v[176:179], v47 offset:6144
  v_mfma_f32_16x16x32_bf16 v[80:83], v[192:195], v[120:123], v[80:83]
  ds_read_b64_tr_b16 v[228:229], v48 offset:8192
  ds_read_b64_tr_b16 v[230:231], v48 offset:9216
  v_mfma_f32_16x16x32_bf16 v[96:99], v[192:195], v[124:127], v[96:99]
  ds_read_b64_tr_b16 v[232:233], v49 offset:8192
  v_mfma_f32_16x16x32_bf16 v[112:115], v[192:195], v[128:131], v[112:115]
  ds_read_b64_tr_b16 v[234:235], v49 offset:9216
  ds_read_b64_tr_b16 v[236:237], v50 offset:8192
  v_mfma_f32_16x16x32_bf16 v[52:55], v[196:199], v[132:135], v[52:55]
  ds_read_b64_tr_b16 v[238:239], v50 offset:9216
  ds_read_b64_tr_b16 v[240:241], v51 offset:8192
  v_mfma_f32_16x16x32_bf16 v[68:71], v[196:199], v[136:139], v[68:71]
  ds_read_b64_tr_b16 v[242:243], v51 offset:9216
  v_mfma_f32_16x16x32_bf16 v[84:87], v[196:199], v[140:143], v[84:87]
  v_mfma_f32_16x16x32_bf16 v[100:103], v[196:199], v[144:147], v[100:103]
  v_mfma_f32_16x16x32_bf16 v[56:59], v[200:203], v[132:135], v[56:59]
  v_mfma_f32_16x16x32_bf16 v[72:75], v[200:203], v[136:139], v[72:75]
  v_mfma_f32_16x16x32_bf16 v[88:91], v[200:203], v[140:143], v[88:91]
  v_mfma_f32_16x16x32_bf16 v[104:107], v[200:203], v[144:147], v[104:107]
  v_mfma_f32_16x16x32_bf16 v[60:63], v[204:207], v[132:135], v[60:63]
  v_mfma_f32_16x16x32_bf16 v[76:79], v[204:207], v[136:139], v[76:79]
  v_mfma_f32_16x16x32_bf16 v[92:95], v[204:207], v[140:143], v[92:95]
  v_mfma_f32_16x16x32_bf16 v[108:111], v[204:207], v[144:147], v[108:111]
  v_mfma_f32_16x16x32_bf16 v[64:67], v[208:211], v[132:135], v[64:67]
  v_mfma_f32_16x16x32_bf16 v[80:83], v[208:211], v[136:139], v[80:83]
  v_mfma_f32_16x16x32_bf16 v[96:99], v[208:211], v[140:143], v[96:99]
  v_mfma_f32_16x16x32_bf16 v[112:115], v[208:211], v[144:147], v[112:115]
  s_waitcnt lgkmcnt(0)
  s_barrier
  v_mfma_f32_16x16x32_bf16 v[52:55], v[212:215], v[148:151], v[52:55]
  s_add_u32 s76, s76, 32768
  s_cmp_ge_u32 s76, s77
  v_mfma_f32_16x16x32_bf16 v[68:71], v[212:215], v[152:155], v[68:71]
  s_cselect_b32 s3, 131072, 0
  s_sub_u32 s76, s76, s3
  v_mfma_f32_16x16x32_bf16 v[84:87], v[212:215], v[156:159], v[84:87]
  v_add_u32 v46, s76, v36
  v_add_u32 v47, s76, v37
  v_mfma_f32_16x16x32_bf16 v[100:103], v[212:215], v[160:163], v[100:103]
  v_add_u32 v48, s76, v38
  v_add_u32 v49, s76, v39
  v_mfma_f32_16x16x32_bf16 v[56:59], v[216:219], v[148:151], v[56:59]
  v_add_u32 v50, s76, v40
  v_add_u32 v51, s76, v41
  v_mfma_f32_16x16x32_bf16 v[72:75], v[216:219], v[152:155], v[72:75]
  ds_read_b128 v[116:119], v46 offset:0
  ds_read_b128 v[120:123], v46 offset:2048
  v_mfma_f32_16x16x32_bf16 v[88:91], v[216:219], v[156:159], v[88:91]
  ds_read_b128 v[124:127], v46 offset:4096
  ds_read_b128 v[128:131], v46 offset:6144
  v_mfma_f32_16x16x32_bf16 v[104:107], v[216:219], v[160:163], v[104:107]
  ds_read_b64_tr_b16 v[180:181], v48 offset:0
  ds_read_b64_tr_b16 v[182:183], v48 offset:1024
  v_mfma_f32_16x16x32_bf16 v[60:63], v[220:223], v[148:151], v[60:63]
  ds_read_b64_tr_b16 v[184:185], v49 offset:0
  ds_read_b64_tr_b16 v[186:187], v49 offset:1024
  v_mfma_f32_16x16x32_bf16 v[76:79], v[220:223], v[152:155], v[76:79]
  ds_read_b64_tr_b16 v[188:189], v50 offset:0
  ds_read_b64_tr_b16 v[190:191], v50 offset:1024
  v_mfma_f32_16x16x32_bf16 v[92:95], v[220:223], v[156:159], v[92:95]
  ds_read_b64_tr_b16 v[192:193], v51 offset:0
  ds_read_b64_tr_b16 v[194:195], v51 offset:1024
  v_mfma_f32_16x16x32_bf16 v[108:111], v[220:223], v[160:163], v[108:111]
  ds_read_b128 v[132:135], v47 offset:0
  ds_read_b128 v[136:139], v47 offset:2048
  v_mfma_f32_16x16x32_bf16 v[64:67], v[224:227], v[148:151], v[64:67]
  ds_read_b128 v[140:143], v47 offset:4096
  ds_read_b128 v[144:147], v47 offset:6144
  v_mfma_f32_16x16x32_bf16 v[80:83], v[224:227], v[152:155], v[80:83]
  ds_read_b64_tr_b16 v[196:197], v48 offset:8192
  ds_read_b64_tr_b16 v[198:199], v48 offset:9216
  v_mfma_f32_16x16x32_bf16 v[96:99], v[224:227], v[156:159], v[96:99]
  ds_read_b64_tr_b16 v[200:201], v49 offset:8192
  v_mfma_f32_16x16x32_bf16 v[112:115], v[224:227], v[160:163], v[112:115]
  ds_read_b64_tr_b16 v[202:203], v49 offset:9216
  ds_read_b64_tr_b16 v[204:205], v50 offset:8192
  v_mfma_f32_16x16x32_bf16 v[52:55], v[228:231], v[164:167], v[52:55]
  ds_read_b64_tr_b16 v[206:207], v50 offset:9216
  ds_read_b64_tr_b16 v[208:209], v51 offset:8192
  v_mfma_f32_16x16x32_bf16 v[68:71], v[228:231], v[168:171], v[68:71]
  ds_read_b64_tr_b16 v[210:211], v51 offset:9216
  v_mfma_f32_16x16x32_bf16 v[84:87], v[228:231], v[172:175], v[84:87]
  v_mfma_f32_16x16x32_bf16 v[100:103], v[228:231], v[176:179], v[100:103]
  v_mfma_f32_16x16x32_bf16 v[56:59], v[232:235], v[164:167], v[56:59]
  v_mfma_f32_16x16x32_bf16 v[72:75], v[232:235], v[168:171], v[72:75]
  v_mfma_f32_16x16x32_bf16 v[88:91], v[232:235], v[172:175], v[88:91]
  v_mfma_f32_16x16x32_bf16 v[104:107], v[232:235], v[176:179], v[104:107]
  v_mfma_f32_16x16x32_bf16 v[60:63], v[236:239], v[164:167], v[60:63]
  v_mfma_f32_16x16x32_bf16 v[76:79], v[236:239], v[168:171], v[76:79]
  v_mfma_f32_16x16x32_bf16 v[92:95], v[236:239], v[172:175], v[92:95]
  v_mfma_f32_16x16x32_bf16 v[108:111], v[236:239], v[176:179], v[108:111]
  v_mfma_f32_16x16x32_bf16 v[64:67], v[240:243], v[164:167], v[64:67]
  v_mfma_f32_16x16x32_bf16 v[80:83], v[240:243], v[168:171], v[80:83]
  v_mfma_f32_16x16x32_bf16 v[96:99], v[240:243], v[172:175], v[96:99]
  v_mfma_f32_16x16x32_bf16 v[112:115], v[240:243], v[176:179], v[112:115]
  s_sub_u32 s78, s78, 1
  s_cmp_lg_u32 s78, 0
  s_cbranch_scc1 L_k6_g2_kernel_cloop_3
  s_waitcnt lgkmcnt(0)
  s_and_b32 s79, s17, 1
  v_and_b32 v6, 15, v1
  v_lshrrev_b32 v245, 1, v3
  v_lshl_add_u32 v6, v245, 6, v6
  v_mul_u32_u24 v244, 0x110, v6
  v_lshrrev_b32 v6, 4, v1
  v_lshl_add_u32 v244, v6, 4, v244
  v_lshlrev_b32 v246, 4, v1
  s_lshr_b32 s80, s17, 1
  s_lshl_b32 s80, s80, 13
  s_cmp_eq_u32 s79, s14
  s_cbranch_scc1 L_k6_g2_kernel_keep_4
  s_add_u32 s80, s80, s64
  v_cvt_pk_bf16_f32 v116, v52, v53
  v_cvt_pk_bf16_f32 v117, v54, v55
  v_cvt_pk_bf16_f32 v118, v56, v57
  v_cvt_pk_bf16_f32 v119, v58, v59
  buffer_store_dwordx4 v[116:119], v246, s[56:59], s80 offen offset:0 sc1
  v_cvt_pk_bf16_f32 v120, v60, v61
  v_cvt_pk_bf16_f32 v121, v62, v63
  v_cvt_pk_bf16_f32 v122, v64, v65
  v_cvt_pk_bf16_f32 v123, v66, v67
  buffer_store_dwordx4 v[120:123], v246, s[56:59], s80 offen offset:1024 sc1
  v_cvt_pk_bf16_f32 v124, v68, v69
  v_cvt_pk_bf16_f32 v125, v70, v71
  v_cvt_pk_bf16_f32 v126, v72, v73
  v_cvt_pk_bf16_f32 v127, v74, v75
  buffer_store_dwordx4 v[124:127], v246, s[56:59], s80 offen offset:2048 sc1
  v_cvt_pk_bf16_f32 v128, v76, v77
  v_cvt_pk_bf16_f32 v129, v78, v79
  v_cvt_pk_bf16_f32 v130, v80, v81
  v_cvt_pk_bf16_f32 v131, v82, v83
  buffer_store_dwordx4 v[128:131], v246, s[56:59], s80 offen offset:3072 sc1
  s_add_u32 s80, s80, 4096
  v_cvt_pk_bf16_f32 v132, v84, v85
  v_cvt_pk_bf16_f32 v133, v86, v87
  v_cvt_pk_bf16_f32 v134, v88, v89
  v_cvt_pk_bf16_f32 v135, v90, v91
  buffer_store_dwordx4 v[132:135], v246, s[56:59], s80 offen offset:0 sc1
  v_cvt_pk_bf16_f32 v136, v92, v93
  v_cvt_pk_bf16_f32 v137, v94, v95
  v_cvt_pk_bf16_f32 v138, v96, v97
  v_cvt_pk_bf16_f32 v139, v98, v99
  buffer_store_dwordx4 v[136:139], v246, s[56:59], s80 offen offset:1024 sc1
  v_cvt_pk_bf16_f32 v140, v100, v101
  v_cvt_pk_bf16_f32 v141, v102, v103
  v_cvt_pk_bf16_f32 v142, v104, v105
  v_cvt_pk_bf16_f32 v143, v106, v107
  buffer_store_dwordx4 v[140:143], v246, s[56:59], s80 offen offset:2048 sc1
  v_cvt_pk_bf16_f32 v144, v108, v109
  v_cvt_pk_bf16_f32 v145, v110, v111
  v_cvt_pk_bf16_f32 v146, v112, v113
  v_cvt_pk_bf16_f32 v147, v114, v115
  buffer_store_dwordx4 v[144:147], v246, s[56:59], s80 offen offset:3072 sc1
  s_waitcnt vmcnt(0)
L_k6_g2_kernel_keep_4:
  s_barrier
  s_barrier
  s_cmp_eq_u32 s79, s14
  s_cbranch_scc0 L_k6_g2_kernel_keep2_5
  s_lshr_b32 s80, s17, 1
  s_lshl_b32 s80, s80, 13
  s_add_u32 s80, s80, s65
  buffer_load_dwordx4 v[116:119], v246, s[56:59], s80 offen offset:0 sc1
  buffer_load_dwordx4 v[120:123], v246, s[56:59], s80 offen offset:1024 sc1
  buffer_load_dwordx4 v[124:127], v246, s[56:59], s80 offen offset:2048 sc1
  buffer_load_dwordx4 v[128:131], v246, s[56:59], s80 offen offset:3072 sc1
  s_add_u32 s80, s80, 4096
  buffer_load_dwordx4 v[132:135], v246, s[56:59], s80 offen offset:0 sc1
  buffer_load_dwordx4 v[136:139], v246, s[56:59], s80 offen offset:1024 sc1
  buffer_load_dwordx4 v[140:143], v246, s[56:59], s80 offen offset:2048 sc1
  buffer_load_dwordx4 v[144:147], v246, s[56:59], s80 offen offset:3072 sc1
  s_waitcnt vmcnt(7)
  v_lshlrev_b32 v247, 16, v116
  v_and_b32 v248, 0xffff0000, v116
  v_add_f32 v52, v52, v247
  v_add_f32 v53, v53, v248
  v_lshlrev_b32 v247, 16, v117
  v_and_b32 v248, 0xffff0000, v117
  v_add_f32 v54, v54, v247
  v_add_f32 v55, v55, v248
  v_lshlrev_b32 v247, 16, v118
  v_and_b32 v248, 0xffff0000, v118
  v_add_f32 v56, v56, v247
  v_add_f32 v57, v57, v248
  v_lshlrev_b32 v247, 16, v119
  v_and_b32 v248, 0xffff0000, v119
  v_add_f32 v58, v58, v247
  v_add_f32 v59, v59, v248
  ds_write_b128 v244, v[52:55] offset:0
  ds_write_b128 v244, v[56:59] offset:64
  s_waitcnt vmcnt(6)
  v_lshlrev_b32 v247, 16, v120
  v_and_b32 v248, 0xffff0000, v120
  v_add_f32 v60, v60, v247
  v_add_f32 v61, v61, v248
  v_lshlrev_b32 v247, 16, v121
  v_and_b32 v248, 0xffff0000, v121
  v_add_f32 v62, v62, v247
  v_add_f32 v63, v63, v248
  v_lshlrev_b32 v247, 16, v122
  v_and_b32 v248, 0xffff0000, v122
  v_add_f32 v64, v64, v247
  v_add_f32 v65, v65, v248
  v_lshlrev_b32 v247, 16, v123
  v_and_b32 v248, 0xffff0000, v123
  v_add_f32 v66, v66, v247
  v_add_f32 v67, v67, v248
  ds_write_b128 v244, v[60:63] offset:128
  ds_write_b128 v244, v[64:67] offset:192
  s_waitcnt vmcnt(5)
  v_lshlrev_b32 v247, 16, v124
  v_and_b32 v248, 0xffff0000, v124
  v_add_f32 v68, v68, v247
  v_add_f32 v69, v69, v248
  v_lshlrev_b32 v247, 16, v125
  v_and_b32 v248, 0xffff0000, v125
  v_add_f32 v70, v70, v247
  v_add_f32 v71, v71, v248
  v_lshlrev_b32 v247, 16, v126
  v_and_b32 v248, 0xffff0000, v126
  v_add_f32 v72, v72, v247
  v_add_f32 v73, v73, v248
  v_lshlrev_b32 v247, 16, v127
  v_and_b32 v248, 0xffff0000, v127
  v_add_f32 v74, v74, v247
  v_add_f32 v75, v75, v248
  ds_write_b128 v244, v[68:71] offset:4352
  ds_write_b128 v244, v[72:75] offset:4416
  s_waitcnt vmcnt(4)
  v_lshlrev_b32 v247, 16, v128
  v_and_b32 v248, 0xffff0000, v128
  v_add_f32 v76, v76, v247
  v_add_f32 v77, v77, v248
  v_lshlrev_b32 v247, 16, v129
  v_and_b32 v248, 0xffff0000, v129
  v_add_f32 v78, v78, v247
  v_add_f32 v79, v79, v248
  v_lshlrev_b32 v247, 16, v130
  v_and_b32 v248, 0xffff0000, v130
  v_add_f32 v80, v80, v247
  v_add_f32 v81, v81, v248
  v_lshlrev_b32 v247, 16, v131
  v_and_b32 v248, 0xffff0000, v131
  v_add_f32 v82, v82, v247
  v_add_f32 v83, v83, v248
  ds_write_b128 v244, v[76:79] offset:4480
  ds_write_b128 v244, v[80:83] offset:4544
  s_waitcnt vmcnt(3)
  v_lshlrev_b32 v247, 16, v132
  v_and_b32 v248, 0xffff0000, v132
  v_add_f32 v84, v84, v247
  v_add_f32 v85, v85, v248
  v_lshlrev_b32 v247, 16, v133
  v_and_b32 v248, 0xffff0000, v133
  v_add_f32 v86, v86, v247
  v_add_f32 v87, v87, v248
  v_lshlrev_b32 v247, 16, v134
  v_and_b32 v248, 0xffff0000, v134
  v_add_f32 v88, v88, v247
  v_add_f32 v89, v89, v248
  v_lshlrev_b32 v247, 16, v135
  v_and_b32 v248, 0xffff0000, v135
  v_add_f32 v90, v90, v247
  v_add_f32 v91, v91, v248
  ds_write_b128 v244, v[84:87] offset:8704
  ds_write_b128 v244, v[88:91] offset:8768
  s_waitcnt vmcnt(2)
  v_lshlrev_b32 v247, 16, v136
  v_and_b32 v248, 0xffff0000, v136
  v_add_f32 v92, v92, v247
  v_add_f32 v93, v93, v248
  v_lshlrev_b32 v247, 16, v137
  v_and_b32 v248, 0xffff0000, v137
  v_add_f32 v94, v94, v247
  v_add_f32 v95, v95, v248
  v_lshlrev_b32 v247, 16, v138
  v_and_b32 v248, 0xffff0000, v138
  v_add_f32 v96, v96, v247
  v_add_f32 v97, v97, v248
  v_lshlrev_b32 v247, 16, v139
  v_and_b32 v248, 0xffff0000, v139
  v_add_f32 v98, v98, v247
  v_add_f32 v99, v99, v248
  ds_write_b128 v244, v[92:95] offset:8832
  ds_write_b128 v244, v[96:99] offset:8896
  s_waitcnt vmcnt(1)
  v_lshlrev_b32 v247, 16, v140
  v_and_b32 v248, 0xffff0000, v140
  v_add_f32 v100, v100, v247
  v_add_f32 v101, v101, v248
  v_lshlrev_b32 v247, 16, v141
  v_and_b32 v248, 0xffff0000, v141
  v_add_f32 v102, v102, v247
  v_add_f32 v103, v103, v248
  v_lshlrev_b32 v247, 16, v142
  v_and_b32 v248, 0xffff0000, v142
  v_add_f32 v104, v104, v247
  v_add_f32 v105, v105, v248
  v_lshlrev_b32 v247, 16, v143
  v_and_b32 v248, 0xffff0000, v143
  v_add_f32 v106, v106, v247
  v_add_f32 v107, v107, v248
  ds_write_b128 v244, v[100:103] offset:13056
  ds_write_b128 v244, v[104:107] offset:13120
  s_waitcnt vmcnt(0)
  v_lshlrev_b32 v247, 16, v144
  v_and_b32 v248, 0xffff0000, v144
  v_add_f32 v108, v108, v247
  v_add_f32 v109, v109, v248
  v_lshlrev_b32 v247, 16, v145
  v_and_b32 v248, 0xffff0000, v145
  v_add_f32 v110, v110, v247
  v_add_f32 v111, v111, v248
  v_lshlrev_b32 v247, 16, v146
  v_and_b32 v248, 0xffff0000, v146
  v_add_f32 v112, v112, v247
  v_add_f32 v113, v113, v248
  v_lshlrev_b32 v247, 16, v147
  v_and_b32 v248, 0xffff0000, v147
  v_add_f32 v114, v114, v247
  v_add_f32 v115, v115, v248
  ds_write_b128 v244, v[108:111] offset:13184
  ds_write_b128 v244, v[112:115] offset:13248
  s_waitcnt lgkmcnt(0)
L_k6_g2_kernel_keep2_5:
  s_branch L_k6_g2_kernel_epi_2
L_k6_g2_kernel_loader_1:
  v_lshrrev_b32 v32, 3, v1
  v_lshl_add_u32 v32, v3, 3, v32
  v_bfe_u32 v33, v32, 1, 3
  v_and_b32 v34, 7, v1
  v_xor_b32 v33, v34, v33
  v_mul_u32_u24 v32, 0x1c00, v32
  v_lshl_add_u32 v36, v33, 4, v32
  v_add_u32 v37, 0x38000, v36
  v_add_u32 v38, 0x70000, v36
  v_add_u32 v39, 0xa8000, v36
  v_lshl_add_u32 v32, v3, 6, v1
  v_lshrrev_b32 v33, 4, v32
  v_and_b32 v34, 15, v32
  v_and_b32 v32, 3, v33
  v_bfe_u32 v40, v33, 3, 1
  v_lshl_or_b32 v32, v40, 2, v32
  v_lshlrev_b32 v32, 1, v32
  v_xor_b32 v34, v34, v32
  v_mul_u32_u24 v33, 0x800, v33
  v_lshl_add_u32 v40, v34, 4, v33
  v_add_u32 v41, 0x8000, v40
  v_add_u32 v42, 0x10000, v40
  v_add_u32 v43, 0x18000, v40
  s_lshl_b32 s70, s17, 10
  s_add_u32 s70, s70, 0
  s_add_u32 s72, s70, 131072
  s_mov_b32 s68, 0
  s_mov_b32 s69, 0
  s_add_u32 m0, s70, 0
  s_nop 0
  buffer_load_dwordx4 v36, s[40:43], s68 offen lds
  s_add_u32 m0, s70, 4096
  s_nop 0
  buffer_load_dwordx4 v37, s[40:43], s68 offen lds
  s_add_u32 m0, s70, 8192
  s_nop 0
  buffer_load_dwordx4 v38, s[40:43], s68 offen lds
  s_add_u32 m0, s70, 12288
  s_nop 0
  buffer_load_dwordx4 v39, s[40:43], s68 offen lds
  s_add_u32 m0, s70, 16384
  s_nop 0
  buffer_load_dwordx4 v40, s[48:51], s69 offen lds
  s_add_u32 m0, s70, 20480
  s_nop 0
  buffer_load_dwordx4 v41, s[48:51], s69 offen lds
  s_add_u32 m0, s70, 24576
  s_nop 0
  buffer_load_dwordx4 v42, s[48:51], s69 offen lds
  s_add_u32 m0, s70, 28672
  s_nop 0
  buffer_load_dwordx4 v43, s[48:51], s69 offen lds
  s_add_u32 s68, s68, 128
  s_add_u32 s69, s69, 131072
  s_add_u32 s70, s70, 32768
  s_cmp_ge_u32 s70, s72
  s_cselect_b32 s3, 131072, 0
  s_sub_u32 s70, s70, s3
  s_add_u32 m0, s70, 0
  s_nop 0
  buffer_load_dwordx4 v36, s[40:43], s68 offen lds
  s_add_u32 m0, s70, 4096
  s_nop 0
  buffer_load_dwordx4 v37, s[40:43], s68 offen lds
  s_add_u32 m0, s70, 8192
  s_nop 0
  buffer_load_dwordx4 v38, s[40:43], s68 offen lds
  s_add_u32 m0, s70, 12288
  s_nop 0
  buffer_load_dwordx4 v39, s[40:43], s68 offen lds
  s_add_u32 m0, s70, 16384
  s_nop 0
  buffer_load_dwordx4 v40, s[48:51], s69 offen lds
  s_add_u32 m0, s70, 20480
  s_nop 0
  buffer_load_dwordx4 v41, s[48:51], s69 offen lds
  s_add_u32 m0, s70, 24576
  s_nop 0
  buffer_load_dwordx4 v42, s[48:51], s69 offen lds
  s_add_u32 m0, s70, 28672
  s_nop 0
  buffer_load_dwordx4 v43, s[48:51], s69 offen lds
  s_add_u32 s68, s68, 128
  s_add_u32 s69, s69, 131072
  s_add_u32 s70, s70, 32768
  s_cmp_ge_u32 s70, s72
  s_cselect_b32 s3, 131072, 0
  s_sub_u32 s70, s70, s3
  s_add_u32 m0, s70, 0
  s_nop 0
  buffer_load_dwordx4 v36, s[40:43], s68 offen lds
  s_add_u32 m0, s70, 4096
  s_nop 0
  buffer_load_dwordx4 v37, s[40:43], s68 offen lds
  s_add_u32 m0, s70, 8192
  s_nop 0
  buffer_load_dwordx4 v38, s[40:43], s68 offen lds
  s_add_u32 m0, s70, 12288
  s_nop 0
  buffer_load_dwordx4 v39, s[40:43], s68 offen lds
  s_add_u32 m0, s70, 16384
  s_nop 0
  buffer_load_dwordx4 v40, s[48:51], s69 offen lds
  s_add_u32 m0, s70, 20480
  s_nop 0
  buffer_load_dwordx4 v41, s[48:51], s69 offen lds
  s_add_u32 m0, s70, 24576
  s_nop 0
  buffer_load_dwordx4 v42, s[48:51], s69 offen lds
  s_add_u32 m0, s70, 28672
  s_nop 0
  buffer_load_dwordx4 v43, s[48:51], s69 offen lds
  s_add_u32 s68, s68, 128
  s_add_u32 s69, s69, 131072
  s_add_u32 s70, s70, 32768
  s_cmp_ge_u32 s70, s72
  s_cselect_b32 s3, 131072, 0
  s_sub_u32 s70, s70, s3
  s_add_u32 m0, s70, 0
  s_nop 0
  buffer_load_dwordx4 v36, s[40:43], s68 offen lds
  s_add_u32 m0, s70, 4096
  s_nop 0
  buffer_load_dwordx4 v37, s[40:43], s68 offen lds
  s_add_u32 m0, s70, 8192
  s_nop 0
  buffer_load_dwordx4 v38, s[40:43], s68 offen lds
  s_add_u32 m0, s70, 12288
  s_nop 0
  buffer_load_dwordx4 v39, s[40:43], s68 offen lds
  s_add_u32 m0, s70, 16384
  s_nop 0
  buffer_load_dwordx4 v40, s[48:51], s69 offen lds
  s_add_u32 m0, s70, 20480
  s_nop 0
  buffer_load_dwordx4 v41, s[48:51], s69 offen lds
  s_add_u32 m0, s70, 24576
  s_nop 0
  buffer_load_dwordx4 v42, s[48:51], s69 offen lds
  s_add_u32 m0, s70, 28672
  s_nop 0
  buffer_load_dwordx4 v43, s[48:51], s69 offen lds
  s_add_u32 s68, s68, 128
  s_add_u32 s69, s69, 131072
  s_add_u32 s70, s70, 32768
  s_cmp_ge_u32 s70, s72
  s_cselect_b32 s3, 131072, 0
  s_sub_u32 s70, s70, s3
  s_waitcnt vmcnt(24)
  s_barrier
  buffer_load_dwordx4 v[12:15], v7, s[24:27], 0 offen
  buffer_load_dwordx4 v[16:19], v7, s[24:27], s36 offen
  s_lshl_b32 s73, s21, 1
  s_add_u32 s73, s73, 20480
  buffer_load_dwordx4 v[20:23], v8, s[32:35], s73 offen
  buffer_load_dwordx4 v[24:27], v8, s[32:35], s73 offen offset:16
  s_mov_b32 s76, s10
  s_mov_b32 s77, s11
  s_mov_b32 s78, 0x800
  s_mov_b32 s79, 0x20000
  v_lshlrev_b32 v44, 4, v5
  buffer_load_dwordx4 v[28:31], v44, s[76:79], s21 offen
  s_mov_b32 s80, 24
L_k6_g2_kernel_ldloop_6:
  s_waitcnt vmcnt(16)
  s_barrier
  s_add_u32 m0, s70, 0
  s_nop 0
  buffer_load_dwordx4 v36, s[40:43], s68 offen lds
  s_add_u32 m0, s70, 4096
  s_nop 0
  buffer_load_dwordx4 v37, s[40:43], s68 offen lds
  s_add_u32 m0, s70, 8192
  s_nop 0
  buffer_load_dwordx4 v38, s[40:43], s68 offen lds
  s_add_u32 m0, s70, 12288
  s_nop 0
  buffer_load_dwordx4 v39, s[40:43], s68 offen lds
  s_add_u32 m0, s70, 16384
  s_nop 0
  buffer_load_dwordx4 v40, s[48:51], s69 offen lds
  s_add_u32 m0, s70, 20480
  s_nop 0
  buffer_load_dwordx4 v41, s[48:51], s69 offen lds
  s_add_u32 m0, s70, 24576
  s_nop 0
  buffer_load_dwordx4 v42, s[48:51], s69 offen lds
  s_add_u32 m0, s70, 28672
  s_nop 0
  buffer_load_dwordx4 v43, s[48:51], s69 offen lds
  s_add_u32 s68, s68, 128
  s_add_u32 s69, s69, 131072
  s_add_u32 s70, s70, 32768
  s_cmp_ge_u32 s70, s72
  s_cselect_b32 s3, 131072, 0
  s_sub_u32 s70, s70, s3
  s_sub_u32 s80, s80, 1
  s_cmp_lg_u32 s80, 0
  s_cbranch_scc1 L_k6_g2_kernel_ldloop_6
  s_waitcnt vmcnt(16)
  s_barrier
  s_waitcnt vmcnt(8)
  s_barrier
  s_waitcnt vmcnt(0)
  s_barrier
  s_waitcnt vmcnt(0)
  s_barrier
  s_barrier
  s_cmp_eq_u32 s16, 4
  s_cbranch_scc0 L_k6_g2_kernel_nopoll_7
  v_mov_b32 v46, 0
  v_mov_b32 v45, 1
  s_mov_b64 exec, 1
  buffer_store_dword v45, v46, s[60:63], s66 offen sc1
  s_mov_b32 s81, 200000
L_k6_g2_kernel_poll_8:
  buffer_load_dword v45, v46, s[60:63], s67 offen sc1
  s_waitcnt vmcnt(0)
  v_readfirstlane_b32 s82, v45
  s_nop 0
  s_cmp_eq_u32 s82, 1
  s_cbranch_scc1 L_k6_g2_kernel_got_9
  s_sleep 1
  s_sub_u32 s81, s81, 1
  s_cmp_lg_u32 s81, 0
  s_cbranch_scc1 L_k6_g2_kernel_poll_8
L_k6_g2_kernel_got_9:
  s_mov_b64 exec, -1
L_k6_g2_kernel_nopoll_7:
  s_barrier
L_k6_g2_kernel_epi_2:
  s_barrier
  v_mul_u32_u24 v32, 0x110, v4
  v_lshl_add_u32 v32, v5, 5, v32
  ds_read_b128 v[36:39], v32 offset:0
  ds_read_b128 v[40:43], v32 offset:16
  ds_read_b128 v[44:47], v32 offset:17408
  ds_read_b128 v[48:51], v32 offset:17424
  s_waitcnt vmcnt(0)
  v_lshlrev_b32 v52, 16, v12
  v_and_b32 v53, 0xffff0000, v12
  v_lshlrev_b32 v54, 16, v13
  v_and_b32 v55, 0xffff0000, v13
  v_lshlrev_b32 v56, 16, v14
  v_and_b32 v57, 0xffff0000, v14
  v_lshlrev_b32 v58, 16, v15
  v_and_b32 v59, 0xffff0000, v15
  v_lshlrev_b32 v60, 16, v16
  v_and_b32 v61, 0xffff0000, v16
  v_lshlrev_b32 v62, 16, v17
  v_and_b32 v63, 0xffff0000, v17
  v_lshlrev_b32 v64, 16, v18
  v_and_b32 v65, 0xffff0000, v18
  v_lshlrev_b32 v66, 16, v19
  v_and_b32 v67, 0xffff0000, v19
  v_lshlrev_b32 v68, 16, v28
  v_and_b32 v69, 0xffff0000, v28
  v_lshlrev_b32 v70, 16, v29
  v_and_b32 v71, 0xffff0000, v29
  v_lshlrev_b32 v72, 16, v30
  v_and_b32 v73, 0xffff0000, v30
  v_lshlrev_b32 v74, 16, v31
  v_and_b32 v75, 0xffff0000, v31
  s_waitcnt vmcnt(0) lgkmcnt(0)
  v_add_f32 v36, v36, v68
  v_fma_f32 v36, v36, v20, v52
  v_add_f32 v37, v37, v69
  v_fma_f32 v37, v37, v21, v53
  v_add_f32 v38, v38, v70
  v_fma_f32 v38, v38, v22, v54
  v_add_f32 v39, v39, v71
  v_fma_f32 v39, v39, v23, v55
  v_add_f32 v40, v40, v72
  v_fma_f32 v40, v40, v24, v56
  v_add_f32 v41, v41, v73
  v_fma_f32 v41, v41, v25, v57
  v_add_f32 v42, v42, v74
  v_fma_f32 v42, v42, v26, v58
  v_add_f32 v43, v43, v75
  v_fma_f32 v43, v43, v27, v59
  v_cvt_pk_bf16_f32 v76, v36, v37
  v_cvt_pk_bf16_f32 v77, v38, v39
  v_cvt_pk_bf16_f32 v78, v40, v41
  v_cvt_pk_bf16_f32 v79, v42, v43
  v_add_f32 v44, v44, v68
  v_fma_f32 v44, v44, v20, v60
  v_add_f32 v45, v45, v69
  v_fma_f32 v45, v45, v21, v61
  v_add_f32 v46, v46, v70
  v_fma_f32 v46, v46, v22, v62
  v_add_f32 v47, v47, v71
  v_fma_f32 v47, v47, v23, v63
  v_add_f32 v48, v48, v72
  v_fma_f32 v48, v48, v24, v64
  v_add_f32 v49, v49, v73
  v_fma_f32 v49, v49, v25, v65
  v_add_f32 v50, v50, v74
  v_fma_f32 v50, v50, v26, v66
  v_add_f32 v51, v51, v75
  v_fma_f32 v51, v51, v27, v67
  v_cvt_pk_bf16_f32 v80, v44, v45
  v_cvt_pk_bf16_f32 v81, v46, v47
  v_cvt_pk_bf16_f32 v82, v48, v49
  v_cvt_pk_bf16_f32 v83, v50, v51
  buffer_store_dwordx4 v[76:79], v7, s[28:31], 0 offen
  buffer_store_dwordx4 v[80:83], v7, s[28:31], s36 offen
L_k6_g2_kernel_end:
L_k6_g2_kernel_exit:
  s_endpgm
CODE_END:
  s_endpgm
.section .rodata,"a"
.p2align 6
.amdhsa_kernel k1_mod_kernel
  .amdhsa_next_free_vgpr 104
  .amdhsa_next_free_sgpr 69
  .amdhsa_accum_offset 104
  .amdhsa_group_segment_fixed_size 0
  .amdhsa_kernarg_size 120
  .amdhsa_user_sgpr_count 2
  .amdhsa_user_sgpr_kernarg_segment_ptr 1
  .amdhsa_system_sgpr_workgroup_id_x 1
  .amdhsa_float_denorm_mode_32 3
  .amdhsa_float_denorm_mode_16_64 3
.end_amdhsa_kernel
.p2align 6
.amdhsa_kernel k2_ln_kv_kernel
  .amdhsa_next_free_vgpr 136
  .amdhsa_next_free_sgpr 56
  .amdhsa_accum_offset 136
  .amdhsa_group_segment_fixed_size 0
  .amdhsa_kernarg_size 120
  .amdhsa_user_sgpr_count 2
  .amdhsa_user_sgpr_kernarg_segment_ptr 1
  .amdhsa_system_sgpr_workgroup_id_x 1
  .amdhsa_float_denorm_mode_32 3
  .amdhsa_float_denorm_mode_16_64 3
.end_amdhsa_kernel
.p2align 6
.amdhsa_kernel k3_attn_kernel
  .amdhsa_next_free_vgpr 184
  .amdhsa_next_free_sgpr 78
  .amdhsa_accum_offset 184
  .amdhsa_group_segment_fixed_size 0
  .amdhsa_kernarg_size 120
  .amdhsa_user_sgpr_count 2
  .amdhsa_user_sgpr_kernarg_segment_ptr 1
  .amdhsa_system_sgpr_workgroup_id_x 1
  .amdhsa_float_denorm_mode_32 3
  .amdhsa_float_denorm_mode_16_64 3
.end_amdhsa_kernel
.p2align 6
.amdhsa_kernel k4_wo_kernel
  .amdhsa_next_free_vgpr 208
  .amdhsa_next_free_sgpr 80
  .amdhsa_accum_offset 208
  .amdhsa_group_segment_fixed_size 0
  .amdhsa_kernarg_size 120
  .amdhsa_user_sgpr_count 2
  .amdhsa_user_sgpr_kernarg_segment_ptr 1
  .amdhsa_system_sgpr_workgroup_id_x 1
  .amdhsa_float_denorm_mode_32 3
  .amdhsa_float_denorm_mode_16_64 3
.end_amdhsa_kernel
.p2align 6
.amdhsa_kernel k5_g1_kernel
  .amdhsa_next_free_vgpr 256
  .amdhsa_next_free_sgpr 80
  .amdhsa_accum_offset 256
  .amdhsa_group_segment_fixed_size 0
  .amdhsa_kernarg_size 120
  .amdhsa_user_sgpr_count 2
  .amdhsa_user_sgpr_kernarg_segment_ptr 1
  .amdhsa_system_sgpr_workgroup_id_x 1
  .amdhsa_float_denorm_mode_32 3
  .amdhsa_float_denorm_mode_16_64 3
.end_amdhsa_kernel
.p2align 6
.amdhsa_kernel k6_g2_kernel
  .amdhsa_next_free_vgpr 256
  .amdhsa_next_free_sgpr 83
  .amdhsa_accum_offset 256
  .amdhsa_group_segment_fixed_size 0
  .amdhsa_kernarg_size 120
  .amdhsa_user_sgpr_count 2
  .amdhsa_user_sgpr_kernarg_segment_ptr 1
  .amdhsa_system_sgpr_workgroup_id_x 1
  .amdhsa_float_denorm_mode_32 3
  .amdhsa_float_denorm_mode_16_64 3
.end_amdhsa_kernel
```
